```python
import torch

def _softmax(x, axis=-1):
    return torch.softmax(x, dim=axis)
def _gelu(x):
    return torch.nn.functional.gelu(x, approximate="tanh")
def _silu(x):
    return torch.nn.functional.silu(x)
def _sigmoid(x):
    return torch.sigmoid(x)
def _layernorm(x, axis=-1, eps=1e-5):
    m = x.mean(dim=axis, keepdim=True)
    v = x.var(dim=axis, keepdim=True, unbiased=False)
    return (x - m) / torch.sqrt(v + eps)
def _scatter_add(tgt, idx, src, axis=0):
    return tgt.clone().index_add_(axis, idx, src)
def _segment_sum(src, seg, n):
    out = torch.zeros((n,) + src.shape[1:], dtype=src.dtype)
    return out.index_add_(0, seg, src)
def _pad(x, pw):
    flat = tuple(v for pair in reversed(pw) for v in pair)
    return torch.nn.functional.pad(x, flat)

kernel_name = 'sequential_preLN__ssm_conv_h3__mixer_channel_mlp__prompt'

def setup_inputs():

    _w = (lambda a: (lambda t: t.to(torch.bfloat16) if t.is_floating_point() else t)(torch.as_tensor(a)))
    def _A_setup():
        B, S, D = 1, 2048, 640
        ks = 4
        return {
            "q": _w((lambda *s: torch.randn(*s, dtype=torch.bfloat16) * 0.05)(B, S, D)),
            "k": _w((lambda *s: torch.randn(*s, dtype=torch.bfloat16) * 0.2)(B, S, D)),
            "v": _w((lambda *s: torch.randn(*s, dtype=torch.bfloat16) * 0.2)(B, S, D)),
            "shift_k": _w((lambda *s: torch.randn(*s, dtype=torch.bfloat16) * 0.2)(D, ks) * 0.5),
            "ssm_k": _w((lambda *s: torch.randn(*s, dtype=torch.bfloat16) * 0.8)(D, S) * (1.0 / S ** 0.5)),
            "ssm_D": _w((lambda *s: torch.randn(*s, dtype=torch.bfloat16) * 0.2)(D)),
        }
    _A_in = _A_setup()

    def _B_setup():
        B, S, D, F = 1, 2048, 640, 1728
        return {
            "x": _w((lambda *s: torch.randn(*s, dtype=torch.bfloat16) * 0.05)(B, S, D)),
            "w1": _w((lambda *s: torch.randn(*s, dtype=torch.bfloat16) * 0.8)(D, F) * (D ** -0.5)),
            "b1": _w((lambda *s: torch.randn(*s, dtype=torch.bfloat16) * 0.4)(F)),
            "w2": _w((lambda *s: torch.randn(*s, dtype=torch.bfloat16) * 0.05)(F, D) * (F ** -0.5)),
            "b2": _w((lambda *s: torch.randn(*s, dtype=torch.bfloat16) * 0.05)(D)),
        }
    _B_in = _B_setup()

    return {
        "A_q": _A_in["q"],
        "A_k": _A_in["k"],
        "A_v": _A_in["v"],
        "A_shift_k": _A_in["shift_k"],
        "A_ssm_k": _A_in["ssm_k"],
        "A_ssm_D": _A_in["ssm_D"],
        "B_x": _B_in["x"],
        "B_w1": _B_in["w1"],
        "B_b1": _B_in["b1"],
        "B_w2": _B_in["w2"],
        "B_b2": _B_in["b2"],
    }

def reference(A_q, A_k, A_v, A_shift_k, A_ssm_k, A_ssm_D, B_x, B_w1, B_b1, B_w2, B_b2):
    def _A_ref(q, k, v, shift_k, ssm_k, ssm_D):
        B, S, D = q.shape
        ks = shift_k.shape[-1]
        k_pad = _pad(k, ((0, 0), (ks - 1, 0), (0, 0)))
        k_shift = torch.zeros_like(k)
        for t in range(ks):
            k_shift = k_shift + k_pad[:, t:t + S, :] * shift_k[:, ks - 1 - t][None, None, :]
        kv = k_shift * v
        L = 2 * S
        kv_pad = _pad(kv, ((0, 0), (0, S), (0, 0)))
        kf_pad = _pad(ssm_k, ((0, 0), (0, S)))
        kv_f = (lambda x, axes=(-2,-1): torch.fft.rfft2(x.float(), dim=axes))(kv_pad[:, None, :, :], axes=(1, 2))
        kf_f = (lambda x, axes=(-2,-1): torch.fft.rfft2(x.float(), dim=axes))(kf_pad[:, None, :], axes=(1, 2))
        kf_f = (lambda x, *d: x.permute(*d))(kf_f, 1, 2, 0)
        y_f = kv_f * kf_f[None, :, :, :]
        y = (lambda x, s, axes=(-2,-1): torch.fft.irfft2(x, s=s, dim=axes).to(torch.bfloat16))(y_f, (1, L), axes=(1, 2))[:, 0, :S, :]
        y = y + kv * ssm_D[None, None, :]
        return q * y

    def _B_ref(x, w1, b1, w2, b2):
        y = _layernorm(x, axis=-1)
        h = _gelu(torch.einsum("bsd,df->bsf", y, w1) + b1)
        return torch.einsum("bsf,fd->bsd", h, w2) + b2

    x = A_q
    h = x + _A_ref(_layernorm(x, axis=-1), A_k, A_v, A_shift_k, A_ssm_k, A_ssm_D)
    h2 = h + _B_ref(_layernorm(h, axis=-1), B_w1, B_b1, B_w2, B_b2)
    return h2
```

```asm
; @launch grid=(256,1,1) block=(256,1,1) lds=163840
.amdgcn_target "amdgcn-amd-amdhsa--gfx950"
.text
.globl sequential_preLN__ssm_conv_h3__mixer_channel_mlp__prompt_kernel
.p2align 8
.type sequential_preLN__ssm_conv_h3__mixer_channel_mlp__prompt_kernel,@function
sequential_preLN__ssm_conv_h3__mixer_channel_mlp__prompt_kernel:
    s_load_dwordx2 s[4:5], s[0:1], 0
    s_load_dwordx2 s[32:33], s[0:1], 104
    s_lshr_b32 s58, s2, 3
    s_getpc_b64 s[76:77]
L_pc:
    s_lshl_b32 s65, s58, 12
    v_lshl_add_u32 v251, v0, 4, s65
    v_min_u32 v251, L_code_end-L_pc-16, v251
    v_mad_u64_u32 v[252:253], vcc, v251, 1, s[76:77]
    global_load_dwordx4 a[252:255], v[252:253], off
    s_cmp_ge_u32 s58, 24
    s_nop 1
    s_cbranch_scc1 L_prep0
    s_cmp_ge_u32 s58, 20
    s_cbranch_scc1 L_stats
    s_load_dwordx2 s[8:9], s[0:1], 8
    s_load_dwordx2 s[12:13], s[0:1], 16
    s_load_dwordx2 s[36:37], s[0:1], 24
    v_and_b32 v1, 63, v0
    v_lshrrev_b32 v2, 6, v0
    s_mov_b32 s10, 2621440
    s_mov_b32 s11, 0x20000
    s_mov_b64 s[14:15], s[10:11]
    s_mov_b32 s38, 5120
    s_mov_b32 s39, s11
    v_readfirstlane_b32 s56, v2
    s_and_b32 s57, s2, 7
    s_mul_i32 s59, s57, 20
    s_add_u32 s59, s59, s58
    v_lshrrev_b32 v213, 3, v1
    v_mul_u32_u24 v213, 1280, v213
    v_and_b32 v208, 7, v1
    v_lshl_add_u32 v208, v208, 4, v213
    s_lshr_b32 s68, s59, 4
    s_and_b32 s69, s59, 15
    s_mul_i32 s65, s69, 163840
    s_lshl_b32 s66, s68, 7
    s_add_u32 s65, s65, s66
    s_sub_u32 s66, s65, 10240
    v_add_u32 v209, s66, v208
    s_mul_i32 s66, s56, 40960
    s_add_u32 s65, s65, s66
    s_mul_i32 s67, s56, 4160
    v_lshrrev_b32 v213, 4, v0
    v_lshlrev_b32 v211, 5, v213
    s_lshl_b32 s70, s68, 9
    s_mov_b32 m0, 66560
    s_waitcnt lgkmcnt(0)
    s_cmp_lg_u32 s56, 0
    s_cbranch_scc1 L_nohalo
    s_mov_b32 exec_lo, 0
    buffer_load_dwordx4 v209, s[8:11], 0 offen lds
    s_mov_b32 exec_lo, -1
L_nohalo:
    buffer_load_dwordx4 v[32:35], v211, s[36:39], s70 offen
    buffer_load_dwordx4 v[36:39], v211, s[36:39], s70 offen offset:16
    s_add_u32 m0, s67, 67600
    s_add_u32 s66, s65, 0
    buffer_load_dwordx4 v208, s[8:11], s66 offen lds
    s_add_u32 m0, s67, 68640
    s_add_u32 s66, s65, 10240
    buffer_load_dwordx4 v208, s[8:11], s66 offen lds
    s_add_u32 m0, s67, 69680
    s_add_u32 s66, s65, 20480
    buffer_load_dwordx4 v208, s[8:11], s66 offen lds
    s_add_u32 m0, s67, 70720
    s_add_u32 s66, s65, 30720
    buffer_load_dwordx4 v208, s[8:11], s66 offen lds
    s_add_u32 m0, s67, 84240
    s_add_u32 s66, s65, 0
    buffer_load_dwordx4 v208, s[12:15], s66 offen lds
    s_add_u32 m0, s67, 85280
    s_add_u32 s66, s65, 10240
    buffer_load_dwordx4 v208, s[12:15], s66 offen lds
    s_add_u32 m0, s67, 86320
    s_add_u32 s66, s65, 20480
    buffer_load_dwordx4 v208, s[12:15], s66 offen lds
    s_add_u32 m0, s67, 87360
    s_add_u32 s66, s65, 30720
    buffer_load_dwordx4 v208, s[12:15], s66 offen lds
    s_load_dwordx2 s[16:17], s[0:1], 32
    s_load_dwordx2 s[40:41], s[0:1], 40
    s_mov_b64 s[18:19], s[10:11]
    s_mov_b32 s42, 1280
    s_mov_b32 s43, s11
    v_lshlrev_b32 v4, 4, v1
    s_lshl_b32 s67, s59, 2
    s_add_u32 s67, s67, s56
    s_lshl_b32 s66, s67, 12
    s_waitcnt lgkmcnt(0)
    buffer_load_dwordx4 v[232:235], v4, s[16:19], s66 offen offset:0
    buffer_load_dwordx4 v[236:239], v4, s[16:19], s66 offen offset:1024
    buffer_load_dwordx4 v[240:243], v4, s[16:19], s66 offen offset:2048
    buffer_load_dwordx4 v[244:247], v4, s[16:19], s66 offen offset:3072
    s_lshl_b32 s66, s67, 1
    buffer_load_ushort v248, off, s[40:43], s66
    s_mov_b32 s3, 0
L_addr:
    s_load_dwordx2 s[28:29], s[0:1], 88
    s_load_dwordx2 s[52:53], s[0:1], 96
    s_load_dwordx2 s[44:45], s[0:1], 64
    s_mov_b32 s34, 20971520
    s_mov_b32 s35, s11
    s_mov_b64 s[30:31], s[10:11]
    s_mov_b32 s54, 256
    s_mov_b32 s55, s11
    s_mov_b32 s46, 3456
    s_mov_b32 s47, s11
    s_cmp_eq_u32 s56, 0
    s_cselect_b32 s100, 1, 0
    s_cselect_b32 s101, 0, 4096
    s_lshr_b32 s60, s57, 1
    s_lshl_b32 s60, s60, 2
    s_and_b32 s62, s58, 3
    s_add_u32 s60, s60, s62
    s_lshl_b32 s62, s62, 1
    s_lshr_b32 s61, s58, 2
    s_add_u32 s61, s61, s62
    s_and_b32 s61, s61, 7
    s_and_b32 s63, s57, 1
    s_lshl_b32 s62, s63, 3
    s_add_u32 s62, s62, s61
    s_mov_b32 s64, 0x20000
    s_mov_b32 s73, 0xffff0000
    s_mov_b32 s74, 0x05040100
    s_mov_b32 s75, 0x07060302
    v_lshlrev_b32 v4, 4, v1
    v_lshlrev_b32 v9, 3, v1
    s_cmp_eq_u32 s56, 3
    s_nop 0
    s_cbranch_scc1 L_addr3
    s_mul_i32 s94, s62, 3
    s_add_u32 s94, s94, s56
    s_mul_i32 s94, s94, 40960
    s_add_u32 s94, s94, 18350080
    v_mov_b32 v20, v4
    v_and_b32 v30, 3, v1
    v_lshlrev_b32 v30, 3, v30
    v_bfe_u32 v29, v1, 4, 1
    s_mul_i32 s91, s60, 458752
    s_add_u32 s91, s91, 7864320
    s_lshr_b32 s68, s62, 2
    s_lshl_b32 s89, s60, 11
    s_add_u32 s89, s89, 17563648
    s_lshl_b32 s69, s68, 7
    s_add_u32 s88, s89, s69
    s_lshl_b32 s69, s56, 7
    s_add_u32 s89, s89, s69
    s_mul_i32 s68, s68, 14336
    s_add_u32 s90, s91, s68
    s_and_b32 s68, s62, 3
    s_mul_i32 s68, s68, 3
    s_add_u32 s68, s68, s56
    s_lshl_b32 s68, s68, 10
    s_add_u32 s90, s90, s68
    v_lshrrev_b32 v28, 5, v1
    v_bfe_u32 v2, v1, 2, 2
    v_lshl_add_u32 v2, v28, 3, v2
    v_lshl_add_u32 v2, v2, 6, v30
    v_lshl_add_u32 v2, v29, 5, v2
    v_xor_b32 v3, 0x120, v2
    v_mul_u32_u24 v5, 57344, v29
    v_lshl_add_u32 v5, v28, 8, v5
    v_and_b32 v28, 15, v1
    v_lshl_add_u32 v5, v28, 4, v5
    v_and_b32 v6, 31, v1
    v_lshlrev_b32 v6, 5, v6
    v_add_u32 v6, 158720, v6
    s_mul_i32 s68, s61, 5
    s_add_u32 s68, s68, s56
    s_lshl_b32 s68, s68, 10
    v_lshrrev_b32 v7, 2, v1
    v_lshl_add_u32 v7, v7, 6, v30
    v_xor_b32 v29, s63, v29
    v_lshl_add_u32 v7, v29, 5, v7
    v_add_u32 v7, s68, v7
    v_mul_u32_u24 v8, 160, v28
    v_lshrrev_b32 v29, 4, v1
    v_lshl_add_u32 v8, v29, 3, v8
    s_lshl_b32 s68, s56, 5
    s_add_u32 s68, s68, 81920
    v_add_u32 v8, s68, v8
    v_add_u32 v2, 117760, v2
    v_add_u32 v3, 117760, v3
    v_add_u32 v7, 117760, v7
    s_nop 2
L_addr_c:
    s_mul_i32 s86, s56, 10240
    s_lshl_b32 s87, s61, 2
    s_add_u32 s87, s87, s56
    s_mul_i32 s87, s87, 71680
    s_add_u32 s87, s87, 15204352
    s_and_b32 s69, s57, 1
    s_lshl_b32 s95, s69, 10
    v_and_b32 v254, 3, v1
    v_lshlrev_b32 v254, 8, v254
    s_lshl_b32 s93, s69, 2
    s_add_u32 s93, s93, s56
    s_lshl_b32 s93, s93, 8
    s_lshl_b32 s68, s69, 11
    v_and_b32 v17, 7, v1
    v_lshl_add_u32 v17, v17, 8, s68
    s_mov_b32 s12, 1
    s_mov_b32 s13, 17596416
    s_lshl_b32 s14, s93, 1
    s_add_u32 s14, s14, 17596416
    s_add_u32 s18, s93, 17563648
    s_lshl_b32 s43, s58, 2
    s_add_u32 s43, s43, s56
    s_lshl_b32 s42, s57, 8
    s_add_u32 s42, s42, 17563648
    s_lshl_b32 s68, s63, 2
    s_add_u32 s68, s68, s56
    s_mul_i32 s68, s68, 14336
    s_add_u32 s91, s91, s68
    s_mul_i32 s85, s60, 163840
    s_add_u32 s85, s85, s86
    s_add_u32 s85, s85, 5242880
    s_mul_i32 s10, s56, 13312
    s_mul_i32 s11, s56, 3072
    s_add_u32 s11, s11, s85
    v_and_b32 v28, 15, v1
    v_mul_u32_u24 v12, 336, v28
    v_lshrrev_b32 v28, 4, v1
    v_lshl_add_u32 v12, v28, 4, v12
    s_mul_i32 s68, s56, 5376
    v_add_u32 v12, s68, v12
    v_min_u32 v30, 159, v0
    v_mul_u32_u24 v28, 6554, v30
    v_lshrrev_b32 v28, 16, v28
    v_mul_u32_u24 v29, 10, v28
    v_sub_u32 v29, v30, v29
    v_mul_u32_u24 v13, 336, v28
    v_lshl_add_u32 v13, v29, 5, v13
    v_lshlrev_b32 v14, 4, v30
    v_add_u32 v14, 81920, v14
    v_bfe_u32 v30, v28, 2, 1
    v_lshlrev_b32 v15, 8, v30
    v_lshrrev_b32 v30, 3, v28
    v_lshl_add_u32 v15, v30, 4, v15
    v_and_b32 v30, 3, v28
    v_add_u32 v15, v30, v15
    v_mul_u32_u24 v15, 1280, v15
    v_lshl_add_u32 v15, v29, 4, v15
    v_mov_b32 v30, 1073741824
    v_cmp_gt_u32 vcc, 160, v0
    s_nop 1
    v_cndmask_b32 v15, v30, v15, vcc
    s_and_b32 s69, s60, 3
    s_lshl_b32 s69, s69, 1
    s_add_u32 s69, s69, s63
    s_lshl_b32 s69, s69, 5
    s_and_b32 s92, s60, 12
    s_add_u32 s92, s92, s69
    s_mul_i32 s92, s92, 1280
    s_mul_i32 s68, s61, 160
    s_add_u32 s92, s92, s68
    s_waitcnt lgkmcnt(0)
    s_cmp_eq_u32 s3, 1
    s_cbranch_scc1 L_addr_r1
    s_cmp_eq_u32 s3, 2
    s_cbranch_scc1 L_addr_r2
    v_and_b32 v28, 15, v1
    v_lshrrev_b32 v29, 4, v1
    v_sub_u32 v30, 15, v28
    v_and_b32 v21, 3, v30
    v_mul_u32_u24 v21, 4160, v21
    v_lshl_add_u32 v21, v29, 4, v21
    v_lshrrev_b32 v30, 2, v30
    v_lshlrev_b32 v30, 3, v30
    v_sub_u32 v21, v21, v30
    s_mul_i32 s65, s56, 16640
    s_add_u32 s65, s65, 32
    v_add_u32 v21, s65, v21
    s_mul_i32 s67, s56, 4608
    s_add_u32 s65, s67, 67040
    v_lshl_add_u32 v22, v29, 4, s65
    v_lshlrev_b32 v30, 5, v28
    v_sub_u32 v22, v22, v30
    v_lshrrev_b32 v30, 3, v1
    v_add_u32 v23, s56, v30
    v_and_b32 v23, 3, v23
    v_lshl_add_u32 v23, v30, 2, v23
    v_and_b32 v30, 7, v1
    v_lshl_add_u32 v23, v23, 3, v30
    v_lshlrev_b32 v23, 3, v23
    v_add_u32 v23, 84992, v23
    v_add_u32 v24, 101376, v4
    s_and_b32 s65, s59, 1
    s_lshl_b32 s65, s65, 1
    v_and_b32 v30, 3, v1
    v_xor_b32 v30, s65, v30
    v_lshrrev_b32 v25, 2, v1
    v_mul_u32_u24 v25, 163840, v25
    v_lshl_add_u32 v25, v30, 4, v25
    s_lshl_b32 s70, s59, 2
    s_add_u32 s70, s70, s56
    s_lshl_b32 s84, s70, 6
    s_add_u32 s84, s84, 5242880
    s_and_b32 s65, s59, 7
    s_lshl_b32 s13, s56, 3
    s_add_u32 s13, s13, s65
    s_lshl_b32 s13, s13, 8
    s_add_u32 s13, s13, 17596416
    s_lshr_b32 s68, s59, 4
    s_and_b32 s69, s59, 15
    v_and_b32 v209, 15, v1
    v_mul_u32_u24 v210, 1040, v209
    v_lshl_add_u32 v210, v213, 3, v210
    v_add_u32 v210, 66560, v210
    v_lshlrev_b32 v209, 4, v209
    v_sub_u32 v209, 240, v209
    v_lshl_add_u32 v211, v213, 14, v209
    s_lshl_b32 s66, s68, 8
    s_add_u32 s66, s66, 17661952
    s_mov_b32 s15, s66
    s_mov_b32 s24, s66
    s_add_u32 s65, s95, 17667072
    v_add_u32 v27, s65, v254
    v_writelane_b32 v27, s66, 0
    s_lshl_b32 s65, s68, 18
    s_lshl_b32 s66, s69, 8
    s_sub_u32 s65, s65, s66
    s_waitcnt vmcnt(14)
    v_lshlrev_b32 v40, 16, v32
    v_and_b32 v42, s73, v32
    v_lshlrev_b32 v44, 16, v33
    v_and_b32 v46, s73, v33
    v_lshlrev_b32 v41, 16, v34
    v_and_b32 v43, s73, v34
    v_lshlrev_b32 v45, 16, v35
    v_and_b32 v47, s73, v35
    s_waitcnt vmcnt(13)
    v_lshlrev_b32 v48, 16, v36
    v_and_b32 v50, s73, v36
    v_lshlrev_b32 v52, 16, v37
    v_and_b32 v54, s73, v37
    v_lshlrev_b32 v49, 16, v38
    v_and_b32 v51, s73, v38
    v_lshlrev_b32 v53, 16, v39
    v_and_b32 v55, s73, v39
    s_waitcnt vmcnt(5)
    s_barrier
    ds_read_b64 v[56:57], v210 offset:640
    ds_read_b64 v[58:59], v210 offset:768
    ds_read_b64 v[60:61], v210 offset:896
    ds_read_b64 v[62:63], v210 offset:1040
    ds_read_b64 v[78:79], v210 offset:17680
    ds_read_b64 v[64:65], v210 offset:1168
    ds_read_b64 v[80:81], v210 offset:17808
    ds_read_b64 v[66:67], v210 offset:1296
    ds_read_b64 v[82:83], v210 offset:17936
    ds_read_b64 v[68:69], v210 offset:1424
    ds_read_b64 v[84:85], v210 offset:18064
    ds_read_b64 v[70:71], v210 offset:1552
    ds_read_b64 v[86:87], v210 offset:18192
    ds_read_b64 v[72:73], v210 offset:1680
    ds_read_b64 v[88:89], v210 offset:18320
    ds_read_b64 v[74:75], v210 offset:1808
    ds_read_b64 v[90:91], v210 offset:18448
    ds_read_b64 v[76:77], v210 offset:1936
    ds_read_b64 v[92:93], v210 offset:18576
    s_add_u32 s72, s101, 0
    buffer_load_dword v18, off, s[52:55], s72 sc1
    s_waitcnt lgkmcnt(12)
    v_lshlrev_b32 v94, 16, v56
    v_and_b32 v95, s73, v56
    v_lshlrev_b32 v96, 16, v57
    v_and_b32 v97, s73, v57
    v_lshlrev_b32 v98, 16, v58
    v_and_b32 v99, s73, v58
    v_lshlrev_b32 v100, 16, v59
    v_and_b32 v101, s73, v59
    v_lshlrev_b32 v102, 16, v60
    v_and_b32 v103, s73, v60
    v_lshlrev_b32 v104, 16, v61
    v_and_b32 v105, s73, v61
    v_lshlrev_b32 v106, 16, v62
    v_and_b32 v107, s73, v62
    v_lshlrev_b32 v170, 16, v78
    v_and_b32 v171, s73, v78
    v_pk_mul_f32 v[138:139], v[94:95], v[46:47]
    v_pk_fma_f32 v[138:139], v[98:99], v[44:45], v[138:139]
    v_pk_fma_f32 v[138:139], v[102:103], v[42:43], v[138:139]
    v_pk_fma_f32 v[138:139], v[106:107], v[40:41], v[138:139]
    v_pk_mul_f32 v[138:139], v[138:139], v[170:171]
    v_lshlrev_b32 v110, 16, v64
    v_and_b32 v111, s73, v64
    v_lshlrev_b32 v172, 16, v80
    v_and_b32 v173, s73, v80
    v_pk_mul_f32 v[142:143], v[98:99], v[46:47]
    v_pk_fma_f32 v[142:143], v[102:103], v[44:45], v[142:143]
    v_pk_fma_f32 v[142:143], v[106:107], v[42:43], v[142:143]
    v_pk_fma_f32 v[142:143], v[110:111], v[40:41], v[142:143]
    v_pk_mul_f32 v[142:143], v[142:143], v[172:173]
    s_waitcnt lgkmcnt(0)
    v_lshlrev_b32 v114, 16, v66
    v_and_b32 v115, s73, v66
    v_lshlrev_b32 v170, 16, v82
    v_and_b32 v171, s73, v82
    v_pk_mul_f32 v[146:147], v[102:103], v[46:47]
    v_pk_fma_f32 v[146:147], v[106:107], v[44:45], v[146:147]
    v_pk_fma_f32 v[146:147], v[110:111], v[42:43], v[146:147]
    v_pk_fma_f32 v[146:147], v[114:115], v[40:41], v[146:147]
    v_pk_mul_f32 v[146:147], v[146:147], v[170:171]
    v_lshlrev_b32 v118, 16, v68
    v_and_b32 v119, s73, v68
    v_lshlrev_b32 v172, 16, v84
    v_and_b32 v173, s73, v84
    v_pk_mul_f32 v[150:151], v[106:107], v[46:47]
    v_pk_fma_f32 v[150:151], v[110:111], v[44:45], v[150:151]
    v_pk_fma_f32 v[150:151], v[114:115], v[42:43], v[150:151]
    v_pk_fma_f32 v[150:151], v[118:119], v[40:41], v[150:151]
    v_pk_mul_f32 v[150:151], v[150:151], v[172:173]
    v_lshlrev_b32 v122, 16, v70
    v_and_b32 v123, s73, v70
    v_lshlrev_b32 v170, 16, v86
    v_and_b32 v171, s73, v86
    v_pk_mul_f32 v[154:155], v[110:111], v[46:47]
    v_pk_fma_f32 v[154:155], v[114:115], v[44:45], v[154:155]
    v_pk_fma_f32 v[154:155], v[118:119], v[42:43], v[154:155]
    v_pk_fma_f32 v[154:155], v[122:123], v[40:41], v[154:155]
    v_pk_mul_f32 v[154:155], v[154:155], v[170:171]
    v_lshlrev_b32 v126, 16, v72
    v_and_b32 v127, s73, v72
    v_lshlrev_b32 v172, 16, v88
    v_and_b32 v173, s73, v88
    v_pk_mul_f32 v[158:159], v[114:115], v[46:47]
    v_pk_fma_f32 v[158:159], v[118:119], v[44:45], v[158:159]
    v_pk_fma_f32 v[158:159], v[122:123], v[42:43], v[158:159]
    v_pk_fma_f32 v[158:159], v[126:127], v[40:41], v[158:159]
    v_pk_mul_f32 v[158:159], v[158:159], v[172:173]
    v_lshlrev_b32 v130, 16, v74
    v_and_b32 v131, s73, v74
    v_lshlrev_b32 v170, 16, v90
    v_and_b32 v171, s73, v90
    v_pk_mul_f32 v[162:163], v[118:119], v[46:47]
    v_pk_fma_f32 v[162:163], v[122:123], v[44:45], v[162:163]
    v_pk_fma_f32 v[162:163], v[126:127], v[42:43], v[162:163]
    v_pk_fma_f32 v[162:163], v[130:131], v[40:41], v[162:163]
    v_pk_mul_f32 v[162:163], v[162:163], v[170:171]
    v_lshlrev_b32 v134, 16, v76
    v_and_b32 v135, s73, v76
    v_lshlrev_b32 v172, 16, v92
    v_and_b32 v173, s73, v92
    v_pk_mul_f32 v[166:167], v[122:123], v[46:47]
    v_pk_fma_f32 v[166:167], v[126:127], v[44:45], v[166:167]
    v_pk_fma_f32 v[166:167], v[130:131], v[42:43], v[166:167]
    v_pk_fma_f32 v[166:167], v[134:135], v[40:41], v[166:167]
    v_pk_mul_f32 v[166:167], v[166:167], v[172:173]
    v_cvt_pk_bf16_f32 v176, v166, v162
    v_cvt_pk_bf16_f32 v177, v158, v154
    v_cvt_pk_bf16_f32 v178, v150, v146
    v_cvt_pk_bf16_f32 v179, v142, v138
    v_cvt_pk_bf16_f32 v180, v167, v163
    v_cvt_pk_bf16_f32 v181, v159, v155
    v_cvt_pk_bf16_f32 v182, v151, v147
    v_cvt_pk_bf16_f32 v183, v143, v139
    s_add_u32 s66, s65, 3840
    buffer_store_dwordx4 v[176:179], v211, s[32:35], s66 offen sc1
    s_add_u32 s66, s65, 7936
    buffer_store_dwordx4 v[180:183], v211, s[32:35], s66 offen sc1
    v_lshlrev_b32 v108, 16, v63
    v_and_b32 v109, s73, v63
    v_lshlrev_b32 v170, 16, v79
    v_and_b32 v171, s73, v79
    v_pk_mul_f32 v[140:141], v[96:97], v[54:55]
    v_pk_fma_f32 v[140:141], v[100:101], v[52:53], v[140:141]
    v_pk_fma_f32 v[140:141], v[104:105], v[50:51], v[140:141]
    v_pk_fma_f32 v[140:141], v[108:109], v[48:49], v[140:141]
    v_pk_mul_f32 v[140:141], v[140:141], v[170:171]
    v_lshlrev_b32 v112, 16, v65
    v_and_b32 v113, s73, v65
    v_lshlrev_b32 v172, 16, v81
    v_and_b32 v173, s73, v81
    v_pk_mul_f32 v[144:145], v[100:101], v[54:55]
    v_pk_fma_f32 v[144:145], v[104:105], v[52:53], v[144:145]
    v_pk_fma_f32 v[144:145], v[108:109], v[50:51], v[144:145]
    v_pk_fma_f32 v[144:145], v[112:113], v[48:49], v[144:145]
    v_pk_mul_f32 v[144:145], v[144:145], v[172:173]
    v_lshlrev_b32 v116, 16, v67
    v_and_b32 v117, s73, v67
    v_lshlrev_b32 v170, 16, v83
    v_and_b32 v171, s73, v83
    v_pk_mul_f32 v[148:149], v[104:105], v[54:55]
    v_pk_fma_f32 v[148:149], v[108:109], v[52:53], v[148:149]
    v_pk_fma_f32 v[148:149], v[112:113], v[50:51], v[148:149]
    v_pk_fma_f32 v[148:149], v[116:117], v[48:49], v[148:149]
    v_pk_mul_f32 v[148:149], v[148:149], v[170:171]
    v_lshlrev_b32 v120, 16, v69
    v_and_b32 v121, s73, v69
    v_lshlrev_b32 v172, 16, v85
    v_and_b32 v173, s73, v85
    v_pk_mul_f32 v[152:153], v[108:109], v[54:55]
    v_pk_fma_f32 v[152:153], v[112:113], v[52:53], v[152:153]
    v_pk_fma_f32 v[152:153], v[116:117], v[50:51], v[152:153]
    v_pk_fma_f32 v[152:153], v[120:121], v[48:49], v[152:153]
    v_pk_mul_f32 v[152:153], v[152:153], v[172:173]
    v_lshlrev_b32 v124, 16, v71
    v_and_b32 v125, s73, v71
    v_lshlrev_b32 v170, 16, v87
    v_and_b32 v171, s73, v87
    v_pk_mul_f32 v[156:157], v[112:113], v[54:55]
    v_pk_fma_f32 v[156:157], v[116:117], v[52:53], v[156:157]
    v_pk_fma_f32 v[156:157], v[120:121], v[50:51], v[156:157]
    v_pk_fma_f32 v[156:157], v[124:125], v[48:49], v[156:157]
    v_pk_mul_f32 v[156:157], v[156:157], v[170:171]
    v_lshlrev_b32 v128, 16, v73
    v_and_b32 v129, s73, v73
    v_lshlrev_b32 v172, 16, v89
    v_and_b32 v173, s73, v89
    v_pk_mul_f32 v[160:161], v[116:117], v[54:55]
    v_pk_fma_f32 v[160:161], v[120:121], v[52:53], v[160:161]
    v_pk_fma_f32 v[160:161], v[124:125], v[50:51], v[160:161]
    v_pk_fma_f32 v[160:161], v[128:129], v[48:49], v[160:161]
    v_pk_mul_f32 v[160:161], v[160:161], v[172:173]
    v_lshlrev_b32 v132, 16, v75
    v_and_b32 v133, s73, v75
    v_lshlrev_b32 v170, 16, v91
    v_and_b32 v171, s73, v91
    v_pk_mul_f32 v[164:165], v[120:121], v[54:55]
    v_pk_fma_f32 v[164:165], v[124:125], v[52:53], v[164:165]
    v_pk_fma_f32 v[164:165], v[128:129], v[50:51], v[164:165]
    v_pk_fma_f32 v[164:165], v[132:133], v[48:49], v[164:165]
    v_pk_mul_f32 v[164:165], v[164:165], v[170:171]
    v_lshlrev_b32 v136, 16, v77
    v_and_b32 v137, s73, v77
    v_lshlrev_b32 v172, 16, v93
    v_and_b32 v173, s73, v93
    v_pk_mul_f32 v[168:169], v[124:125], v[54:55]
    v_pk_fma_f32 v[168:169], v[128:129], v[52:53], v[168:169]
    v_pk_fma_f32 v[168:169], v[132:133], v[50:51], v[168:169]
    v_pk_fma_f32 v[168:169], v[136:137], v[48:49], v[168:169]
    v_pk_mul_f32 v[168:169], v[168:169], v[172:173]
    v_cvt_pk_bf16_f32 v184, v168, v164
    v_cvt_pk_bf16_f32 v185, v160, v156
    v_cvt_pk_bf16_f32 v186, v152, v148
    v_cvt_pk_bf16_f32 v187, v144, v140
    v_cvt_pk_bf16_f32 v188, v169, v165
    v_cvt_pk_bf16_f32 v189, v161, v157
    v_cvt_pk_bf16_f32 v190, v153, v149
    v_cvt_pk_bf16_f32 v191, v145, v141
    s_add_u32 s66, s65, 12032
    buffer_store_dwordx4 v[184:187], v211, s[32:35], s66 offen sc1
    s_add_u32 s66, s65, 16128
    buffer_store_dwordx4 v[188:191], v211, s[32:35], s66 offen sc1
    s_mul_i32 s65, s56, 16640
    v_add_u32 v32, s65, v4
    v_mov_b32 v34, 0
    v_mov_b32 v35, 0
    v_mov_b32 v36, 0
    v_mov_b32 v37, 0
    v_bfe_u32 v33, v1, 1, 2
    v_mul_u32_u24 v33, 4160, v33
    v_and_b32 v38, 1, v1
    v_lshl_add_u32 v33, v38, 4, v33
    v_add_u32 v33, s65, v33
    ds_write_b128 v33, v[34:37] offset:0
    s_waitcnt vmcnt(9)
    ds_write_b128 v32, v[232:235] offset:32
    v_mov_b32 v44, 0
    v_mov_b32 v52, 0
    v_mov_b32 v45, v232
    v_mov_b32 v46, v233
    v_mov_b32 v47, v234
    v_mov_b32_dpp v44, v235 wave_shr:1 row_mask:0xf bank_mask:0xf
    v_mov_b32_dpp v52, v234 wave_shr:1 row_mask:0xf bank_mask:0xf
    v_alignbit_b32 v41, v233, v232, 16
    v_alignbit_b32 v42, v234, v233, 16
    v_alignbit_b32 v43, v235, v234, 16
    v_alignbit_b32 v40, v232, v44, 16
    v_alignbit_b32 v48, v44, v52, 16
    v_mov_b32 v49, v40
    v_mov_b32 v50, v41
    v_mov_b32 v51, v42
    ds_write_b128 v32, v[44:47] offset:8352
    ds_write_b128 v32, v[40:43] offset:4192
    ds_write_b128 v32, v[48:51] offset:12512
    s_waitcnt vmcnt(8)
    ds_write_b128 v32, v[236:239] offset:1056
    v_mov_b32_dpp v58, v235 wave_ror:1 row_mask:0xf bank_mask:0xf
    v_mov_b32_dpp v66, v234 wave_ror:1 row_mask:0xf bank_mask:0xf
    v_mov_b32 v59, v236
    v_mov_b32 v60, v237
    v_mov_b32 v61, v238
    v_mov_b32_dpp v58, v239 wave_shr:1 row_mask:0xf bank_mask:0xf
    v_mov_b32_dpp v66, v238 wave_shr:1 row_mask:0xf bank_mask:0xf
    v_alignbit_b32 v55, v237, v236, 16
    v_alignbit_b32 v56, v238, v237, 16
    v_alignbit_b32 v57, v239, v238, 16
    v_alignbit_b32 v54, v236, v58, 16
    v_alignbit_b32 v62, v58, v66, 16
    v_mov_b32 v63, v54
    v_mov_b32 v64, v55
    v_mov_b32 v65, v56
    ds_write_b128 v32, v[58:61] offset:9376
    ds_write_b128 v32, v[54:57] offset:5216
    ds_write_b128 v32, v[62:65] offset:13536
    s_waitcnt vmcnt(7)
    ds_write_b128 v32, v[240:243] offset:2080
    v_mov_b32_dpp v44, v239 wave_ror:1 row_mask:0xf bank_mask:0xf
    v_mov_b32_dpp v52, v238 wave_ror:1 row_mask:0xf bank_mask:0xf
    v_mov_b32 v45, v240
    v_mov_b32 v46, v241
    v_mov_b32 v47, v242
    v_mov_b32_dpp v44, v243 wave_shr:1 row_mask:0xf bank_mask:0xf
    v_mov_b32_dpp v52, v242 wave_shr:1 row_mask:0xf bank_mask:0xf
    v_alignbit_b32 v41, v241, v240, 16
    v_alignbit_b32 v42, v242, v241, 16
    v_alignbit_b32 v43, v243, v242, 16
    v_alignbit_b32 v40, v240, v44, 16
    v_alignbit_b32 v48, v44, v52, 16
    v_mov_b32 v49, v40
    v_mov_b32 v50, v41
    v_mov_b32 v51, v42
    ds_write_b128 v32, v[44:47] offset:10400
    ds_write_b128 v32, v[40:43] offset:6240
    ds_write_b128 v32, v[48:51] offset:14560
    s_waitcnt vmcnt(0)
    v_cmp_gt_u32 vcc, s100, v18
    s_nop 0
    s_cbranch_vccnz L_slow1
L_ret1:
    s_barrier
    s_cmp_lg_u32 s56, 0
    s_cbranch_scc1 L_nosig2
    s_mov_b32 s19, 1
    s_atomic_add s19, s[32:33], s15 glc
L_nosig2:
    ds_write_b128 v32, v[244:247] offset:3104
    v_mov_b32_dpp v58, v243 wave_ror:1 row_mask:0xf bank_mask:0xf
    v_mov_b32_dpp v66, v242 wave_ror:1 row_mask:0xf bank_mask:0xf
    v_mov_b32 v59, v244
    v_mov_b32 v60, v245
    v_mov_b32 v61, v246
    v_mov_b32_dpp v58, v247 wave_shr:1 row_mask:0xf bank_mask:0xf
    v_mov_b32_dpp v66, v246 wave_shr:1 row_mask:0xf bank_mask:0xf
    v_alignbit_b32 v55, v245, v244, 16
    v_alignbit_b32 v56, v246, v245, 16
    v_alignbit_b32 v57, v247, v246, 16
    v_alignbit_b32 v54, v244, v58, 16
    v_alignbit_b32 v62, v58, v66, 16
    v_mov_b32 v63, v54
    v_mov_b32 v64, v55
    v_mov_b32 v65, v56
    ds_write_b128 v32, v[58:61] offset:11424
    ds_write_b128 v32, v[54:57] offset:7264
    ds_write_b128 v32, v[62:65] offset:15584
    v_and_b32 v160, 15, v1
    v_lshrrev_b32 v161, 4, v1
    v_lshl_add_u32 v160, v161, 3, v160
    v_sub_u32 v160, 15, v160
    v_and_b32 v161, 1, v160
    v_lshlrev_b32 v161, 4, v161
    v_lshlrev_b32 v162, v161, v248
    v_ashrrev_i32 v160, 1, v160
    v_cmp_eq_u32 vcc, 0, v160
    s_nop 1
    v_cndmask_b32 v28, 0, v162, vcc
    v_cmp_eq_u32 vcc, 1, v160
    s_nop 1
    v_cndmask_b32 v29, 0, v162, vcc
    v_cmp_eq_u32 vcc, 2, v160
    s_nop 1
    v_cndmask_b32 v30, 0, v162, vcc
    v_cmp_eq_u32 vcc, 3, v160
    s_nop 1
    v_cndmask_b32 v31, 0, v162, vcc
    s_mul_i32 s67, s56, 4608
    s_lshl_b32 s68, s56, 12
    s_lshl_b32 s70, s59, 14
    s_add_u32 s70, s70, s68
    v_mov_b32 v164, 0
    v_mov_b32 v165, 0
    s_add_u32 s65, s67, 70656
    v_add_u32 v160, s65, v9
    ds_write_b64 v160, v[164:165]
    s_cmp_lg_u32 s56, 0
    s_cbranch_scc1 L_nopoll
        s_waitcnt lgkmcnt(0)
    s_cmp_lg_u32 s19, 15
    s_cbranch_scc1 L_notlast
    s_atomic_add s12, s[32:33], s24 offset:44032
    s_branch L_nopoll
L_notlast:
    s_add_u32 s72, s24, 44032
    buffer_load_dword v18, off, s[32:35], s72 sc1
    s_waitcnt vmcnt(0)
    v_cmp_gt_u32 vcc, 1, v18
    s_nop 0
    s_cbranch_vccnz L_slow3
L_ret3:
    s_nop 2
L_nopoll:
    s_barrier
    s_add_u32 m0, s67, 66560
    s_nop 0
    buffer_load_dwordx4 v4, s[32:35], s70 offen offset:3072 sc1 lds
    buffer_load_dwordx4 v4, s[32:35], s70 offen offset:2048 sc1 lds
    s_add_u32 m0, s67, 66560
    s_nop 0
    buffer_load_dwordx4 v4, s[32:35], s70 offen offset:1024 sc1 lds
    buffer_load_dwordx4 v4, s[32:35], s70 offen offset:0 sc1 lds
    ds_read_b64 a[164:165], v21 offset:0
    ds_read_b64 a[166:167], v21 offset:8
    ds_read_b64 a[168:169], v21 offset:512
    ds_read_b64 a[170:171], v21 offset:520
    ds_read_b64 a[0:1], v21 offset:1024
    ds_read_b64 a[2:3], v21 offset:1032
    ds_read_b64 a[4:5], v21 offset:1536
    ds_read_b64 a[6:7], v21 offset:1544
    ds_read_b64 a[172:173], v21 offset:64
    ds_read_b64 a[174:175], v21 offset:72
    ds_read_b64 a[176:177], v21 offset:576
    ds_read_b64 a[178:179], v21 offset:584
    ds_read_b64 a[8:9], v21 offset:1088
    ds_read_b64 a[10:11], v21 offset:1096
    ds_read_b64 a[12:13], v21 offset:1600
    ds_read_b64 a[14:15], v21 offset:1608
    ds_read_b64 a[180:181], v21 offset:128
    ds_read_b64 a[182:183], v21 offset:136
    ds_read_b64 a[184:185], v21 offset:640
    ds_read_b64 a[186:187], v21 offset:648
    ds_read_b64 a[16:17], v21 offset:1152
    ds_read_b64 a[18:19], v21 offset:1160
    ds_read_b64 a[20:21], v21 offset:1664
    ds_read_b64 a[22:23], v21 offset:1672
    ds_read_b64 a[188:189], v21 offset:192
    ds_read_b64 a[190:191], v21 offset:200
    ds_read_b64 a[192:193], v21 offset:704
    ds_read_b64 a[194:195], v21 offset:712
    ds_read_b64 a[24:25], v21 offset:1216
    ds_read_b64 a[26:27], v21 offset:1224
    ds_read_b64 a[28:29], v21 offset:1728
    ds_read_b64 a[30:31], v21 offset:1736
    ds_read_b64 a[196:197], v21 offset:256
    ds_read_b64 a[198:199], v21 offset:264
    ds_read_b64 a[200:201], v21 offset:768
    ds_read_b64 a[202:203], v21 offset:776
    ds_read_b64 a[32:33], v21 offset:1280
    ds_read_b64 a[34:35], v21 offset:1288
    ds_read_b64 a[36:37], v21 offset:1792
    ds_read_b64 a[38:39], v21 offset:1800
    ds_read_b64 a[204:205], v21 offset:320
    ds_read_b64 a[206:207], v21 offset:328
    ds_read_b64 a[208:209], v21 offset:832
    ds_read_b64 a[210:211], v21 offset:840
    ds_read_b64 a[40:41], v21 offset:1344
    ds_read_b64 a[42:43], v21 offset:1352
    ds_read_b64 a[44:45], v21 offset:1856
    ds_read_b64 a[46:47], v21 offset:1864
    ds_read_b64 a[212:213], v21 offset:384
    ds_read_b64 a[214:215], v21 offset:392
    ds_read_b64 a[216:217], v21 offset:896
    ds_read_b64 a[218:219], v21 offset:904
    ds_read_b64 a[48:49], v21 offset:1408
    ds_read_b64 a[50:51], v21 offset:1416
    ds_read_b64 a[52:53], v21 offset:1920
    ds_read_b64 a[54:55], v21 offset:1928
    ds_read_b64 a[220:221], v21 offset:448
    ds_read_b64 a[222:223], v21 offset:456
    ds_read_b64 a[224:225], v21 offset:960
    ds_read_b64 a[226:227], v21 offset:968
    ds_read_b64 a[56:57], v21 offset:1472
    ds_read_b64 a[58:59], v21 offset:1480
    ds_read_b64 a[60:61], v21 offset:1984
    ds_read_b64 a[62:63], v21 offset:1992
    s_waitcnt vmcnt(2)
    s_mov_b64 s[16:17], 0
    s_load_dword s16, s[32:33], s18 offset:103424
    ds_read_b128 v[64:67], v22 offset:2048
    ds_read_b128 v[188:191], v22 offset:3584
    ds_read_b128 v[68:71], v22 offset:2560
    ds_read_b128 v[192:195], v22 offset:3072
    ds_read_b32 v16, v9
    s_waitcnt lgkmcnt(1)
    v_mfma_f32_16x16x32_bf16 v[44:47], v[28:31], v[64:67], 0
    ds_read_b128 v[96:99], v22 offset:2112
    v_mfma_f32_16x16x32_bf16 v[44:47], a[164:167], v[64:67], v[44:47]
    ds_read_b128 v[196:199], v22 offset:3648
    v_mfma_f32_16x16x32_bf16 v[44:47], a[4:7], v[188:191], v[44:47]
    ds_read_b128 v[100:103], v22 offset:2624
    v_mfma_f32_16x16x32_bf16 v[40:43], a[0:3], v[188:191], 0
    ds_read_b128 v[200:203], v22 offset:3136
    ds_read_b32 v16, v9
    v_mfma_f32_16x16x32_bf16 v[36:39], a[168:171], v[188:191], 0
    v_mfma_f32_16x16x32_bf16 v[32:35], v[28:31], v[188:191], 0
    v_mfma_f32_16x16x32_bf16 v[32:35], a[164:167], v[188:191], v[32:35]
    v_mfma_f32_16x16x32_bf16 v[40:43], v[28:31], v[68:71], v[40:43]
    v_mfma_f32_16x16x32_bf16 v[40:43], a[164:167], v[68:71], v[40:43]
    v_mfma_f32_16x16x32_bf16 v[44:47], a[168:171], v[68:71], v[44:47]
    v_mfma_f32_16x16x32_bf16 v[44:47], a[0:3], v[192:195], v[44:47]
    v_mfma_f32_16x16x32_bf16 v[36:39], v[28:31], v[192:195], v[36:39]
    v_mfma_f32_16x16x32_bf16 v[36:39], a[164:167], v[192:195], v[36:39]
    v_mfma_f32_16x16x32_bf16 v[40:43], a[168:171], v[192:195], v[40:43]
    s_waitcnt lgkmcnt(1)
    v_mfma_f32_16x16x32_bf16 v[44:47], a[172:175], v[96:99], v[44:47]
    ds_read_b128 v[64:67], v22 offset:2176
    v_mfma_f32_16x16x32_bf16 v[44:47], a[12:15], v[196:199], v[44:47]
    ds_read_b128 v[204:207], v22 offset:3712
    s_cmp_lt_u32 s16, 8
    s_cbranch_scc1 L_slow4
L_ret4:
    s_barrier
    v_mfma_f32_16x16x32_bf16 v[40:43], a[8:11], v[196:199], v[40:43]
    ds_read_b128 v[68:71], v22 offset:2688
    s_lshr_b32 s19, s68, 1
    s_add_u32 m0, s19, 101376
    s_add_u32 s66, s19, 17498112
    buffer_load_dwordx4 v4, s[32:35], s66 offen offset:0 sc1 lds
    v_mfma_f32_16x16x32_bf16 v[36:39], a[176:179], v[196:199], v[36:39]
    ds_read_b128 v[208:211], v22 offset:3200
    v_mfma_f32_16x16x32_bf16 v[32:35], a[172:175], v[196:199], v[32:35]
    buffer_load_dwordx4 v4, s[32:35], s66 offen offset:1024 sc1 lds
    v_mfma_f32_16x16x32_bf16 v[40:43], a[172:175], v[100:103], v[40:43]
    v_mfma_f32_16x16x32_bf16 v[44:47], a[176:179], v[100:103], v[44:47]
    s_add_u32 m0, s19, 84992
    s_sub_u32 s66, s70, s19
    s_add_u32 s66, s66, 2621440
    buffer_load_dwordx4 v4, s[32:35], s66 offen offset:0 sc1 lds
    v_mfma_f32_16x16x32_bf16 v[44:47], a[8:11], v[200:203], v[44:47]
    v_mfma_f32_16x16x32_bf16 v[36:39], a[172:175], v[200:203], v[36:39]
    buffer_load_dwordx4 v4, s[32:35], s66 offen offset:1024 sc1 lds
    v_mfma_f32_16x16x32_bf16 v[40:43], a[176:179], v[200:203], v[40:43]
    s_waitcnt lgkmcnt(0)
    v_mfma_f32_16x16x32_bf16 v[44:47], a[180:183], v[64:67], v[44:47]
    ds_read_b128 v[96:99], v22 offset:2240
    v_mfma_f32_16x16x32_bf16 v[44:47], a[20:23], v[204:207], v[44:47]
    ds_read_b128 v[212:215], v22 offset:3776
    v_mfma_f32_16x16x32_bf16 v[40:43], a[16:19], v[204:207], v[40:43]
    ds_read_b128 v[100:103], v22 offset:2752
    v_mfma_f32_16x16x32_bf16 v[36:39], a[184:187], v[204:207], v[36:39]
    ds_read_b128 v[216:219], v22 offset:3264
    v_mfma_f32_16x16x32_bf16 v[32:35], a[180:183], v[204:207], v[32:35]
    v_mfma_f32_16x16x32_bf16 v[40:43], a[180:183], v[68:71], v[40:43]
    v_mfma_f32_16x16x32_bf16 v[44:47], a[184:187], v[68:71], v[44:47]
    v_mfma_f32_16x16x32_bf16 v[44:47], a[16:19], v[208:211], v[44:47]
    v_mfma_f32_16x16x32_bf16 v[36:39], a[180:183], v[208:211], v[36:39]
    v_mfma_f32_16x16x32_bf16 v[40:43], a[184:187], v[208:211], v[40:43]
    s_waitcnt lgkmcnt(0)
    v_mfma_f32_16x16x32_bf16 v[44:47], a[188:191], v[96:99], v[44:47]
    ds_read_b128 v[64:67], v22 offset:2304
    v_mfma_f32_16x16x32_bf16 v[44:47], a[28:31], v[212:215], v[44:47]
    ds_read_b128 v[220:223], v22 offset:3840
    v_mfma_f32_16x16x32_bf16 v[40:43], a[24:27], v[212:215], v[40:43]
    ds_read_b128 v[68:71], v22 offset:2816
    v_mfma_f32_16x16x32_bf16 v[36:39], a[192:195], v[212:215], v[36:39]
    ds_read_b128 v[224:227], v22 offset:3328
    v_mfma_f32_16x16x32_bf16 v[32:35], a[188:191], v[212:215], v[32:35]
    v_mfma_f32_16x16x32_bf16 v[40:43], a[188:191], v[100:103], v[40:43]
    v_mfma_f32_16x16x32_bf16 v[44:47], a[192:195], v[100:103], v[44:47]
    v_mfma_f32_16x16x32_bf16 v[44:47], a[24:27], v[216:219], v[44:47]
    v_mfma_f32_16x16x32_bf16 v[36:39], a[188:191], v[216:219], v[36:39]
    v_mfma_f32_16x16x32_bf16 v[40:43], a[192:195], v[216:219], v[40:43]
    s_waitcnt lgkmcnt(0)
    v_mfma_f32_16x16x32_bf16 v[44:47], a[196:199], v[64:67], v[44:47]
    ds_read_b128 v[96:99], v22 offset:2368
    v_mfma_f32_16x16x32_bf16 v[44:47], a[36:39], v[220:223], v[44:47]
    ds_read_b128 v[228:231], v22 offset:3904
    v_mfma_f32_16x16x32_bf16 v[40:43], a[32:35], v[220:223], v[40:43]
    ds_read_b128 v[100:103], v22 offset:2880
    v_mfma_f32_16x16x32_bf16 v[36:39], a[200:203], v[220:223], v[36:39]
    ds_read_b128 v[232:235], v22 offset:3392
    v_mfma_f32_16x16x32_bf16 v[32:35], a[196:199], v[220:223], v[32:35]
    v_mfma_f32_16x16x32_bf16 v[40:43], a[196:199], v[68:71], v[40:43]
    v_mfma_f32_16x16x32_bf16 v[44:47], a[200:203], v[68:71], v[44:47]
    v_mfma_f32_16x16x32_bf16 v[44:47], a[32:35], v[224:227], v[44:47]
    v_mfma_f32_16x16x32_bf16 v[36:39], a[196:199], v[224:227], v[36:39]
    v_mfma_f32_16x16x32_bf16 v[40:43], a[200:203], v[224:227], v[40:43]
    s_waitcnt lgkmcnt(0)
    v_mfma_f32_16x16x32_bf16 v[44:47], a[204:207], v[96:99], v[44:47]
    ds_read_b128 v[64:67], v22 offset:2432
    v_mfma_f32_16x16x32_bf16 v[44:47], a[44:47], v[228:231], v[44:47]
    ds_read_b128 v[236:239], v22 offset:3968
    v_mfma_f32_16x16x32_bf16 v[40:43], a[40:43], v[228:231], v[40:43]
    ds_read_b128 v[68:71], v22 offset:2944
    v_mfma_f32_16x16x32_bf16 v[36:39], a[208:211], v[228:231], v[36:39]
    ds_read_b128 v[240:243], v22 offset:3456
    v_mfma_f32_16x16x32_bf16 v[32:35], a[204:207], v[228:231], v[32:35]
    v_mfma_f32_16x16x32_bf16 v[40:43], a[204:207], v[100:103], v[40:43]
    v_mfma_f32_16x16x32_bf16 v[44:47], a[208:211], v[100:103], v[44:47]
    s_waitcnt vmcnt(0)
    s_barrier
    v_mfma_f32_16x16x32_bf16 v[44:47], a[40:43], v[232:235], v[44:47]
    ds_read_b64 v[160:161], v23 offset:0
    ds_read_b128 v[164:167], v24 offset:0
    v_mfma_f32_16x16x32_bf16 v[36:39], a[204:207], v[232:235], v[36:39]
    ds_read_b128 v[168:171], v24 offset:1024
    v_mfma_f32_16x16x32_bf16 v[40:43], a[208:211], v[232:235], v[40:43]
    s_waitcnt lgkmcnt(3)
    v_mfma_f32_16x16x32_bf16 v[44:47], a[212:215], v[64:67], v[44:47]
    ds_read_b128 v[96:99], v22 offset:2496
    v_mfma_f32_16x16x32_bf16 v[44:47], a[52:55], v[236:239], v[44:47]
    ds_read_b128 v[244:247], v22 offset:4032
    v_mfma_f32_16x16x32_bf16 v[40:43], a[48:51], v[236:239], v[40:43]
    ds_read_b128 v[100:103], v22 offset:3008
    v_mfma_f32_16x16x32_bf16 v[36:39], a[216:219], v[236:239], v[36:39]
    ds_read_b128 v[248:251], v22 offset:3520
    v_mfma_f32_16x16x32_bf16 v[32:35], a[212:215], v[236:239], v[32:35]
    v_mfma_f32_16x16x32_bf16 v[40:43], a[212:215], v[68:71], v[40:43]
    s_waitcnt lgkmcnt(5)
    v_lshlrev_b32 v176, 16, v160
    v_and_b32 v177, s73, v160
    v_lshlrev_b32 v178, 16, v161
    v_and_b32 v179, s73, v161
    v_mfma_f32_16x16x32_bf16 v[44:47], a[216:219], v[68:71], v[44:47]
    s_waitcnt lgkmcnt(3)
    v_fmac_f32 v168, v176, v164
    v_fmac_f32 v169, v177, v165
    v_mfma_f32_16x16x32_bf16 v[44:47], a[48:51], v[240:243], v[44:47]
    v_fmac_f32 v170, v178, v166
    v_fmac_f32 v171, v179, v167
    v_mfma_f32_16x16x32_bf16 v[36:39], a[212:215], v[240:243], v[36:39]
    ds_read_b64 v[160:161], v23 offset:2048
    ds_read_b128 v[164:167], v24 offset:2048
    ds_read_b128 v[172:175], v24 offset:3072
    v_mfma_f32_16x16x32_bf16 v[40:43], a[216:219], v[240:243], v[40:43]
    s_waitcnt lgkmcnt(3)
    v_mfma_f32_16x16x32_bf16 v[44:47], a[220:223], v[96:99], v[44:47]
    ds_read_b128 v[64:67], v22 offset:1024
    ds_read_b64 v[68:69], v21 offset:1024
    v_mfma_f32_16x16x32_bf16 v[44:47], a[60:63], v[244:247], v[44:47]
    ds_read_b64 v[70:71], v21 offset:1032
    v_mfma_f32_16x16x32_bf16 v[40:43], a[56:59], v[244:247], v[40:43]
    ds_read_b64 v[72:73], v21 offset:2560
    v_mfma_f32_16x16x32_bf16 v[36:39], a[224:227], v[244:247], v[36:39]
    ds_read_b64 v[74:75], v21 offset:2568
    v_mfma_f32_16x16x32_bf16 v[32:35], a[220:223], v[244:247], v[32:35]
    ds_read_b128 v[76:79], v22 offset:2560
    v_mfma_f32_16x16x32_bf16 v[40:43], a[220:223], v[100:103], v[40:43]
    ds_read_b128 v[80:83], v22 offset:1536
    ds_read_b64 v[84:85], v21 offset:1536
    s_waitcnt lgkmcnt(8)
    v_lshlrev_b32 v180, 16, v160
    v_and_b32 v181, s73, v160
    v_mfma_f32_16x16x32_bf16 v[44:47], a[224:227], v[100:103], v[44:47]
    ds_read_b64 v[86:87], v21 offset:1544
    v_lshlrev_b32 v182, 16, v161
    v_and_b32 v183, s73, v161
    v_mfma_f32_16x16x32_bf16 v[44:47], a[56:59], v[248:251], v[44:47]
    ds_read_b64 v[88:89], v21 offset:2048
    v_fmac_f32 v172, v180, v164
    v_fmac_f32 v173, v181, v165
    v_mfma_f32_16x16x32_bf16 v[36:39], a[220:223], v[248:251], v[36:39]
    ds_read_b64 v[90:91], v21 offset:2056
    v_fmac_f32 v174, v182, v166
    v_fmac_f32 v175, v183, v167
    v_mfma_f32_16x16x32_bf16 v[40:43], a[224:227], v[248:251], v[40:43]
    ds_read_b128 v[92:95], v22 offset:2048
    ds_read_b64 v[128:129], v23 offset:4096
    s_waitcnt lgkmcnt(8)
    v_mfma_f32_16x16x32_bf16 v[52:55], v[28:31], v[64:67], 0
    ds_read_b128 v[96:99], v22 offset:1088
    ds_read_b128 v[132:135], v24 offset:4096
    ds_read_b128 v[136:139], v24 offset:5120
    v_mfma_f32_16x16x32_bf16 v[52:55], a[164:167], v[64:67], v[52:55]
    ds_read_b64 v[100:101], v21 offset:1088
    v_mfma_f32_16x16x32_bf16 v[56:59], a[168:171], v[64:67], 0
    ds_read_b64 v[102:103], v21 offset:1096
    v_mfma_f32_16x16x32_bf16 v[60:63], v[68:71], v[64:67], 0
    ds_read_b64 v[104:105], v21 offset:2624
    v_mfma_f32_16x16x32_bf16 v[52:55], v[72:75], v[188:191], v[52:55]
    ds_read_b64 v[106:107], v21 offset:2632
    v_mfma_f32_16x16x32_bf16 v[56:59], v[72:75], v[192:195], v[56:59]
    ds_read_b128 v[108:111], v22 offset:2624
    s_waitcnt lgkmcnt(9)
    s_mov_b64 s[16:17], 0
    s_load_dword s16, s[32:33], s18 offset:119808
    v_mfma_f32_16x16x32_bf16 v[60:63], v[72:75], v[76:79], v[60:63]
    ds_read_b128 v[112:115], v22 offset:1600
    v_mfma_f32_16x16x32_bf16 v[48:51], v[68:71], v[76:79], 0
    ds_read_b64 v[116:117], v21 offset:1600
    s_waitcnt lgkmcnt(6)
    v_lshlrev_b32 v144, 16, v128
    v_and_b32 v145, s73, v128
    v_lshlrev_b32 v146, 16, v129
    v_and_b32 v147, s73, v129
    v_fmac_f32 v136, v144, v132
    v_fmac_f32 v137, v145, v133
    v_mfma_f32_16x16x32_bf16 v[48:51], v[28:31], v[80:83], v[48:51]
    ds_read_b64 v[118:119], v21 offset:1608
    v_fmac_f32 v138, v146, v134
    v_fmac_f32 v139, v147, v135
    v_mfma_f32_16x16x32_bf16 v[48:51], a[164:167], v[80:83], v[48:51]
    ds_read_b64 v[120:121], v21 offset:2112
    ds_read_b64 v[128:129], v23 offset:6144
    ds_read_b128 v[132:135], v24 offset:6144
    ds_read_b128 v[140:143], v24 offset:7168
    v_mfma_f32_16x16x32_bf16 v[52:55], a[168:171], v[80:83], v[52:55]
    ds_read_b64 v[122:123], v21 offset:2120
    s_waitcnt lgkmcnt(3)
    v_lshlrev_b32 v148, 16, v128
    v_and_b32 v149, s73, v128
    v_lshlrev_b32 v150, 16, v129
    v_and_b32 v151, s73, v129
    s_waitcnt lgkmcnt(1)
    v_fmac_f32 v140, v148, v132
    v_fmac_f32 v141, v149, v133
    v_fmac_f32 v142, v150, v134
    v_fmac_f32 v143, v151, v135
    v_mfma_f32_16x16x32_bf16 v[56:59], v[68:71], v[80:83], v[56:59]
    ds_read_b128 v[124:127], v22 offset:2112
    ds_read_b32 v16, v9
    v_mfma_f32_16x16x32_bf16 v[60:63], v[84:87], v[80:83], v[60:63]
    v_fmac_f32 v176, v168, v32
    v_fmac_f32 v177, v169, v33
    v_fmac_f32 v178, v170, v34
    v_mfma_f32_16x16x32_bf16 v[48:51], v[84:87], v[192:195], v[48:51]
    v_fmac_f32 v179, v171, v35
    v_cvt_pk_bf16_f32 v184, v176, v177
    v_mfma_f32_16x16x32_bf16 v[52:55], v[84:87], v[76:79], v[52:55]
    v_cvt_pk_bf16_f32 v185, v178, v179
    v_fmac_f32 v180, v172, v36
    v_mfma_f32_16x16x32_bf16 v[48:51], v[88:91], v[188:191], v[48:51]
    v_fmac_f32 v181, v173, v37
    v_fmac_f32 v182, v174, v38
    v_mfma_f32_16x16x32_bf16 v[52:55], v[88:91], v[192:195], v[52:55]
    v_fmac_f32 v183, v175, v39
    v_cvt_pk_bf16_f32 v186, v180, v181
    v_mfma_f32_16x16x32_bf16 v[56:59], v[88:91], v[76:79], v[56:59]
    v_cvt_pk_bf16_f32 v187, v182, v183
    v_mfma_f32_16x16x32_bf16 v[60:63], v[88:91], v[92:95], v[60:63]
    s_add_u32 s65, s84, 0
    buffer_store_dwordx4 v[184:187], v25, s[32:35], s65 offen sc1
    v_mfma_f32_16x16x32_bf16 v[48:51], a[168:171], v[92:95], v[48:51]
    v_fmac_f32 v144, v136, v40
    v_fmac_f32 v145, v137, v41
    v_mfma_f32_16x16x32_bf16 v[52:55], v[68:71], v[92:95], v[52:55]
    v_fmac_f32 v146, v138, v42
    v_fmac_f32 v147, v139, v43
    v_mfma_f32_16x16x32_bf16 v[56:59], v[84:87], v[92:95], v[56:59]
    v_cvt_pk_bf16_f32 v152, v144, v145
    s_waitcnt lgkmcnt(1)
    v_mfma_f32_16x16x32_bf16 v[52:55], a[172:175], v[96:99], v[52:55]
    ds_read_b128 v[64:67], v22 offset:1152
    v_cvt_pk_bf16_f32 v153, v146, v147
    v_mfma_f32_16x16x32_bf16 v[56:59], a[176:179], v[96:99], v[56:59]
    ds_read_b64 v[68:69], v21 offset:1152
    v_fmac_f32 v148, v140, v44
    v_mfma_f32_16x16x32_bf16 v[60:63], v[100:103], v[96:99], v[60:63]
    ds_read_b64 v[70:71], v21 offset:1160
    v_fmac_f32 v149, v141, v45
    v_mfma_f32_16x16x32_bf16 v[52:55], v[104:107], v[196:199], v[52:55]
    ds_read_b64 v[72:73], v21 offset:2688
    v_fmac_f32 v150, v142, v46
    v_mfma_f32_16x16x32_bf16 v[56:59], v[104:107], v[200:203], v[56:59]
    ds_read_b64 v[74:75], v21 offset:2696
    v_fmac_f32 v151, v143, v47
    v_mfma_f32_16x16x32_bf16 v[60:63], v[104:107], v[108:111], v[60:63]
    ds_read_b128 v[76:79], v22 offset:2688
    v_cvt_pk_bf16_f32 v154, v148, v149
    v_mfma_f32_16x16x32_bf16 v[48:51], v[100:103], v[108:111], v[48:51]
    ds_read_b128 v[80:83], v22 offset:1664
    v_cvt_pk_bf16_f32 v155, v150, v151
    v_mfma_f32_16x16x32_bf16 v[48:51], a[172:175], v[112:115], v[48:51]
    ds_read_b64 v[84:85], v21 offset:1664
    v_mfma_f32_16x16x32_bf16 v[52:55], a[176:179], v[112:115], v[52:55]
    ds_read_b64 v[86:87], v21 offset:1672
    s_add_u32 s65, s84, 40960
    buffer_store_dwordx4 v[152:155], v25, s[32:35], s65 offen sc1
    v_mfma_f32_16x16x32_bf16 v[56:59], v[100:103], v[112:115], v[56:59]
    ds_read_b64 v[88:89], v21 offset:2176
    v_mfma_f32_16x16x32_bf16 v[60:63], v[116:119], v[112:115], v[60:63]
    ds_read_b64 v[90:91], v21 offset:2184
    v_mfma_f32_16x16x32_bf16 v[48:51], v[116:119], v[200:203], v[48:51]
    ds_read_b128 v[92:95], v22 offset:2176
    v_mfma_f32_16x16x32_bf16 v[52:55], v[116:119], v[108:111], v[52:55]
    v_mfma_f32_16x16x32_bf16 v[48:51], v[120:123], v[196:199], v[48:51]
    s_cmp_lt_u32 s16, 16
    s_cbranch_scc1 L_slow5
L_ret5:
    s_barrier
    v_mfma_f32_16x16x32_bf16 v[52:55], v[120:123], v[200:203], v[52:55]
    s_add_u32 s69, s94, 0
    buffer_load_dwordx4 a[0:3], v20, s[32:35], s69 offen offset:0 sc1
    v_mfma_f32_16x16x32_bf16 v[56:59], v[120:123], v[108:111], v[56:59]
    v_mfma_f32_16x16x32_bf16 v[60:63], v[120:123], v[124:127], v[60:63]
    v_mfma_f32_16x16x32_bf16 v[48:51], a[176:179], v[124:127], v[48:51]
    buffer_load_dwordx4 a[4:7], v20, s[32:35], s69 offen offset:1024 sc1
    v_mfma_f32_16x16x32_bf16 v[52:55], v[100:103], v[124:127], v[52:55]
    v_mfma_f32_16x16x32_bf16 v[56:59], v[116:119], v[124:127], v[56:59]
    s_waitcnt lgkmcnt(0)
    v_mfma_f32_16x16x32_bf16 v[52:55], a[180:183], v[64:67], v[52:55]
    ds_read_b128 v[96:99], v22 offset:1216
    v_mfma_f32_16x16x32_bf16 v[56:59], a[184:187], v[64:67], v[56:59]
    ds_read_b64 v[100:101], v21 offset:1216
    buffer_load_dwordx4 a[8:11], v20, s[32:35], s69 offen offset:2048 sc1
    v_mfma_f32_16x16x32_bf16 v[60:63], v[68:71], v[64:67], v[60:63]
    ds_read_b64 v[102:103], v21 offset:1224
    v_mfma_f32_16x16x32_bf16 v[52:55], v[72:75], v[204:207], v[52:55]
    ds_read_b64 v[104:105], v21 offset:2752
    v_mfma_f32_16x16x32_bf16 v[56:59], v[72:75], v[208:211], v[56:59]
    ds_read_b64 v[106:107], v21 offset:2760
    buffer_load_dwordx4 a[12:15], v20, s[32:35], s69 offen offset:3072 sc1
    v_mfma_f32_16x16x32_bf16 v[60:63], v[72:75], v[76:79], v[60:63]
    ds_read_b128 v[108:111], v22 offset:2752
    v_mfma_f32_16x16x32_bf16 v[48:51], v[68:71], v[76:79], v[48:51]
    ds_read_b128 v[112:115], v22 offset:1728
    v_mfma_f32_16x16x32_bf16 v[48:51], a[180:183], v[80:83], v[48:51]
    ds_read_b64 v[116:117], v21 offset:1728
    v_mfma_f32_16x16x32_bf16 v[52:55], a[184:187], v[80:83], v[52:55]
    ds_read_b64 v[118:119], v21 offset:1736
    s_add_u32 s69, s94, 4096
    buffer_load_dwordx4 a[16:19], v20, s[32:35], s69 offen offset:0 sc1
    v_mfma_f32_16x16x32_bf16 v[56:59], v[68:71], v[80:83], v[56:59]
    ds_read_b64 v[120:121], v21 offset:2240
    v_mfma_f32_16x16x32_bf16 v[60:63], v[84:87], v[80:83], v[60:63]
    ds_read_b64 v[122:123], v21 offset:2248
    v_mfma_f32_16x16x32_bf16 v[48:51], v[84:87], v[208:211], v[48:51]
    ds_read_b128 v[124:127], v22 offset:2240
    ds_read_b32 v16, v9
    buffer_load_dwordx4 a[20:23], v20, s[32:35], s69 offen offset:1024 sc1
    v_mfma_f32_16x16x32_bf16 v[52:55], v[84:87], v[76:79], v[52:55]
    v_mfma_f32_16x16x32_bf16 v[48:51], v[88:91], v[204:207], v[48:51]
    s_mov_b64 s[16:17], 0
    s_load_dword s16, s[32:33], s18 offset:131072
    v_mfma_f32_16x16x32_bf16 v[52:55], v[88:91], v[208:211], v[52:55]
    v_mfma_f32_16x16x32_bf16 v[56:59], v[88:91], v[76:79], v[56:59]
    buffer_load_dwordx4 a[24:27], v20, s[32:35], s69 offen offset:2048 sc1
    v_mfma_f32_16x16x32_bf16 v[60:63], v[88:91], v[92:95], v[60:63]
    v_mfma_f32_16x16x32_bf16 v[48:51], a[184:187], v[92:95], v[48:51]
    v_mfma_f32_16x16x32_bf16 v[52:55], v[68:71], v[92:95], v[52:55]
    v_mfma_f32_16x16x32_bf16 v[56:59], v[84:87], v[92:95], v[56:59]
    buffer_load_dwordx4 a[28:31], v20, s[32:35], s69 offen offset:3072 sc1
    s_waitcnt lgkmcnt(1)
    v_mfma_f32_16x16x32_bf16 v[52:55], a[188:191], v[96:99], v[52:55]
    ds_read_b128 v[64:67], v22 offset:1280
    v_mfma_f32_16x16x32_bf16 v[56:59], a[192:195], v[96:99], v[56:59]
    ds_read_b64 v[68:69], v21 offset:1280
    v_mfma_f32_16x16x32_bf16 v[60:63], v[100:103], v[96:99], v[60:63]
    ds_read_b64 v[70:71], v21 offset:1288
    s_add_u32 s69, s94, 8192
    buffer_load_dwordx4 a[32:35], v20, s[32:35], s69 offen offset:0 sc1
    v_mfma_f32_16x16x32_bf16 v[52:55], v[104:107], v[212:215], v[52:55]
    ds_read_b64 v[72:73], v21 offset:2816
    v_mfma_f32_16x16x32_bf16 v[56:59], v[104:107], v[216:219], v[56:59]
    ds_read_b64 v[74:75], v21 offset:2824
    v_mfma_f32_16x16x32_bf16 v[60:63], v[104:107], v[108:111], v[60:63]
    ds_read_b128 v[76:79], v22 offset:2816
    v_mfma_f32_16x16x32_bf16 v[48:51], v[100:103], v[108:111], v[48:51]
    ds_read_b128 v[80:83], v22 offset:1792
    buffer_load_dwordx4 a[36:39], v20, s[32:35], s69 offen offset:1024 sc1
    v_mfma_f32_16x16x32_bf16 v[48:51], a[188:191], v[112:115], v[48:51]
    ds_read_b64 v[84:85], v21 offset:1792
    v_mfma_f32_16x16x32_bf16 v[52:55], a[192:195], v[112:115], v[52:55]
    ds_read_b64 v[86:87], v21 offset:1800
    v_mfma_f32_16x16x32_bf16 v[56:59], v[100:103], v[112:115], v[56:59]
    ds_read_b64 v[88:89], v21 offset:2304
    buffer_load_dwordx4 a[40:43], v20, s[32:35], s69 offen offset:2048 sc1
    v_mfma_f32_16x16x32_bf16 v[60:63], v[116:119], v[112:115], v[60:63]
    ds_read_b64 v[90:91], v21 offset:2312
    v_mfma_f32_16x16x32_bf16 v[48:51], v[116:119], v[216:219], v[48:51]
    ds_read_b128 v[92:95], v22 offset:2304
    ds_read_b32 v16, v9
    v_mfma_f32_16x16x32_bf16 v[52:55], v[116:119], v[108:111], v[52:55]
    v_mfma_f32_16x16x32_bf16 v[48:51], v[120:123], v[212:215], v[48:51]
    buffer_load_dwordx4 a[44:47], v20, s[32:35], s69 offen offset:3072 sc1
    v_mfma_f32_16x16x32_bf16 v[52:55], v[120:123], v[216:219], v[52:55]
    v_mfma_f32_16x16x32_bf16 v[56:59], v[120:123], v[108:111], v[56:59]
    v_mfma_f32_16x16x32_bf16 v[60:63], v[120:123], v[124:127], v[60:63]
    v_mfma_f32_16x16x32_bf16 v[48:51], a[192:195], v[124:127], v[48:51]
    s_add_u32 s69, s94, 12288
    buffer_load_dwordx4 a[48:51], v20, s[32:35], s69 offen offset:0 sc1
    v_mfma_f32_16x16x32_bf16 v[52:55], v[100:103], v[124:127], v[52:55]
    v_mfma_f32_16x16x32_bf16 v[56:59], v[116:119], v[124:127], v[56:59]
    s_waitcnt lgkmcnt(1)
    v_mfma_f32_16x16x32_bf16 v[52:55], a[196:199], v[64:67], v[52:55]
    ds_read_b128 v[96:99], v22 offset:1344
    buffer_load_dwordx4 a[52:55], v20, s[32:35], s69 offen offset:1024 sc1
    v_mfma_f32_16x16x32_bf16 v[56:59], a[200:203], v[64:67], v[56:59]
    ds_read_b64 v[100:101], v21 offset:1344
    v_mfma_f32_16x16x32_bf16 v[60:63], v[68:71], v[64:67], v[60:63]
    ds_read_b64 v[102:103], v21 offset:1352
    v_mfma_f32_16x16x32_bf16 v[52:55], v[72:75], v[220:223], v[52:55]
    ds_read_b64 v[104:105], v21 offset:2880
    s_waitcnt vmcnt(14)
    s_cmp_lt_u32 s16, 8
    s_cbranch_scc1 L_slow6
L_ret6:
    s_barrier
    s_cmp_ge_u32 s56, 2
    s_cbranch_scc1 L_nosig7
    s_atomic_add s12, s[32:33], s13 offset:0
L_nosig7:
    v_mfma_f32_16x16x32_bf16 v[56:59], v[72:75], v[224:227], v[56:59]
    ds_read_b64 v[106:107], v21 offset:2888
    s_lshr_b32 s19, s68, 1
    s_add_u32 m0, s19, 109568
    s_add_u32 s66, s19, 17506304
    buffer_load_dwordx4 v4, s[32:35], s66 offen offset:0 sc1 lds
    buffer_load_dwordx4 a[56:59], v20, s[32:35], s69 offen offset:2048 sc1
    v_mfma_f32_16x16x32_bf16 v[60:63], v[72:75], v[76:79], v[60:63]
    ds_read_b128 v[108:111], v22 offset:2880
    v_mfma_f32_16x16x32_bf16 v[48:51], v[68:71], v[76:79], v[48:51]
    ds_read_b128 v[112:115], v22 offset:1856
    buffer_load_dwordx4 v4, s[32:35], s66 offen offset:1024 sc1 lds
    v_mfma_f32_16x16x32_bf16 v[48:51], a[196:199], v[80:83], v[48:51]
    ds_read_b64 v[116:117], v21 offset:1856
    buffer_load_dwordx4 a[60:63], v20, s[32:35], s69 offen offset:3072 sc1
    v_mfma_f32_16x16x32_bf16 v[52:55], a[200:203], v[80:83], v[52:55]
    ds_read_b64 v[118:119], v21 offset:1864
    s_add_u32 m0, s19, 93184
    s_sub_u32 s66, s70, s19
    s_add_u32 s66, s66, 2629632
    buffer_load_dwordx4 v4, s[32:35], s66 offen offset:0 sc1 lds
    v_mfma_f32_16x16x32_bf16 v[56:59], v[68:71], v[80:83], v[56:59]
    ds_read_b64 v[120:121], v21 offset:2368
    v_mfma_f32_16x16x32_bf16 v[60:63], v[84:87], v[80:83], v[60:63]
    ds_read_b64 v[122:123], v21 offset:2376
    buffer_load_dwordx4 v4, s[32:35], s66 offen offset:1024 sc1 lds
    v_mfma_f32_16x16x32_bf16 v[48:51], v[84:87], v[224:227], v[48:51]
    ds_read_b128 v[124:127], v22 offset:2368
    ds_read_b32 v16, v9
    s_add_u32 s69, s94, 16384
    buffer_load_dwordx4 a[64:67], v20, s[32:35], s69 offen offset:0 sc1
    v_mfma_f32_16x16x32_bf16 v[52:55], v[84:87], v[76:79], v[52:55]
    v_mfma_f32_16x16x32_bf16 v[48:51], v[88:91], v[220:223], v[48:51]
    v_mfma_f32_16x16x32_bf16 v[52:55], v[88:91], v[224:227], v[52:55]
    v_mfma_f32_16x16x32_bf16 v[56:59], v[88:91], v[76:79], v[56:59]
    buffer_load_dwordx4 a[68:71], v20, s[32:35], s69 offen offset:1024 sc1
    v_mfma_f32_16x16x32_bf16 v[60:63], v[88:91], v[92:95], v[60:63]
    v_mfma_f32_16x16x32_bf16 v[48:51], a[200:203], v[92:95], v[48:51]
    v_mfma_f32_16x16x32_bf16 v[52:55], v[68:71], v[92:95], v[52:55]
    buffer_load_dwordx4 a[72:75], v20, s[32:35], s69 offen offset:2048 sc1
    v_mfma_f32_16x16x32_bf16 v[56:59], v[84:87], v[92:95], v[56:59]
    s_waitcnt lgkmcnt(1)
    v_mfma_f32_16x16x32_bf16 v[52:55], a[204:207], v[96:99], v[52:55]
    ds_read_b128 v[64:67], v22 offset:1408
    v_mfma_f32_16x16x32_bf16 v[56:59], a[208:211], v[96:99], v[56:59]
    ds_read_b64 v[68:69], v21 offset:1408
    v_mfma_f32_16x16x32_bf16 v[60:63], v[100:103], v[96:99], v[60:63]
    ds_read_b64 v[70:71], v21 offset:1416
    buffer_load_dwordx4 a[76:79], v20, s[32:35], s69 offen offset:3072 sc1
    v_mfma_f32_16x16x32_bf16 v[52:55], v[104:107], v[228:231], v[52:55]
    ds_read_b64 v[72:73], v21 offset:2944
    v_mfma_f32_16x16x32_bf16 v[56:59], v[104:107], v[232:235], v[56:59]
    ds_read_b64 v[74:75], v21 offset:2952
    v_mfma_f32_16x16x32_bf16 v[60:63], v[104:107], v[108:111], v[60:63]
    ds_read_b128 v[76:79], v22 offset:2944
    s_add_u32 s69, s94, 20480
    buffer_load_dwordx4 a[80:83], v4, s[32:35], s69 offen offset:0 sc1
    v_mfma_f32_16x16x32_bf16 v[48:51], v[100:103], v[108:111], v[48:51]
    ds_read_b128 v[80:83], v22 offset:1920
    v_mfma_f32_16x16x32_bf16 v[48:51], a[204:207], v[112:115], v[48:51]
    ds_read_b64 v[84:85], v21 offset:1920
    v_mfma_f32_16x16x32_bf16 v[52:55], a[208:211], v[112:115], v[52:55]
    ds_read_b64 v[86:87], v21 offset:1928
    v_mfma_f32_16x16x32_bf16 v[56:59], v[100:103], v[112:115], v[56:59]
    ds_read_b64 v[88:89], v21 offset:2432
    buffer_load_dwordx4 a[84:87], v4, s[32:35], s69 offen offset:1024 sc1
    v_mfma_f32_16x16x32_bf16 v[60:63], v[116:119], v[112:115], v[60:63]
    ds_read_b64 v[90:91], v21 offset:2440
    v_mfma_f32_16x16x32_bf16 v[48:51], v[116:119], v[232:235], v[48:51]
    ds_read_b128 v[92:95], v22 offset:2432
    ds_read_b32 v16, v9
    v_mfma_f32_16x16x32_bf16 v[52:55], v[116:119], v[108:111], v[52:55]
    v_mfma_f32_16x16x32_bf16 v[48:51], v[120:123], v[228:231], v[48:51]
    buffer_load_dwordx4 a[88:91], v4, s[32:35], s69 offen offset:2048 sc1
    v_mfma_f32_16x16x32_bf16 v[52:55], v[120:123], v[232:235], v[52:55]
    v_mfma_f32_16x16x32_bf16 v[56:59], v[120:123], v[108:111], v[56:59]
    v_mfma_f32_16x16x32_bf16 v[60:63], v[120:123], v[124:127], v[60:63]
    buffer_load_dwordx4 a[92:95], v4, s[32:35], s69 offen offset:3072 sc1
    v_mfma_f32_16x16x32_bf16 v[48:51], a[208:211], v[124:127], v[48:51]
    v_mfma_f32_16x16x32_bf16 v[52:55], v[100:103], v[124:127], v[52:55]
    v_mfma_f32_16x16x32_bf16 v[56:59], v[116:119], v[124:127], v[56:59]
    s_waitcnt lgkmcnt(1)
    v_mfma_f32_16x16x32_bf16 v[52:55], a[212:215], v[64:67], v[52:55]
    ds_read_b128 v[96:99], v22 offset:1472
    s_add_u32 s69, s94, 24576
    buffer_load_dwordx4 a[96:99], v4, s[32:35], s69 offen offset:0 sc1
    v_mfma_f32_16x16x32_bf16 v[56:59], a[216:219], v[64:67], v[56:59]
    ds_read_b64 v[100:101], v21 offset:1472
    v_mfma_f32_16x16x32_bf16 v[60:63], v[68:71], v[64:67], v[60:63]
    ds_read_b64 v[102:103], v21 offset:1480
    v_mfma_f32_16x16x32_bf16 v[52:55], v[72:75], v[236:239], v[52:55]
    ds_read_b64 v[104:105], v21 offset:3008
    buffer_load_dwordx4 a[100:103], v4, s[32:35], s69 offen offset:1024 sc1
    v_mfma_f32_16x16x32_bf16 v[56:59], v[72:75], v[240:243], v[56:59]
    ds_read_b64 v[106:107], v21 offset:3016
    v_mfma_f32_16x16x32_bf16 v[60:63], v[72:75], v[76:79], v[60:63]
    ds_read_b128 v[108:111], v22 offset:3008
    v_mfma_f32_16x16x32_bf16 v[48:51], v[68:71], v[76:79], v[48:51]
    ds_read_b128 v[112:115], v22 offset:1984
    v_mfma_f32_16x16x32_bf16 v[48:51], a[212:215], v[80:83], v[48:51]
    ds_read_b64 v[116:117], v21 offset:1984
    buffer_load_dwordx4 a[104:107], v4, s[32:35], s69 offen offset:2048 sc1
    v_mfma_f32_16x16x32_bf16 v[52:55], a[216:219], v[80:83], v[52:55]
    ds_read_b64 v[118:119], v21 offset:1992
    v_mfma_f32_16x16x32_bf16 v[56:59], v[68:71], v[80:83], v[56:59]
    ds_read_b64 v[120:121], v21 offset:2496
    v_mfma_f32_16x16x32_bf16 v[60:63], v[84:87], v[80:83], v[60:63]
    ds_read_b64 v[122:123], v21 offset:2504
    v_mfma_f32_16x16x32_bf16 v[48:51], v[84:87], v[240:243], v[48:51]
    ds_read_b128 v[124:127], v22 offset:2496
    buffer_load_dwordx4 a[108:111], v4, s[32:35], s69 offen offset:3072 sc1
    v_mfma_f32_16x16x32_bf16 v[52:55], v[84:87], v[76:79], v[52:55]
    v_mfma_f32_16x16x32_bf16 v[48:51], v[88:91], v[236:239], v[48:51]
    s_waitcnt vmcnt(12)
    s_barrier
    v_mfma_f32_16x16x32_bf16 v[52:55], v[88:91], v[240:243], v[52:55]
    s_add_u32 s69, s94, 28672
    buffer_load_dwordx4 a[112:115], v4, s[32:35], s69 offen offset:0 sc1
    v_mfma_f32_16x16x32_bf16 v[56:59], v[88:91], v[76:79], v[56:59]
    ds_read_b64 v[160:161], v23 offset:8192
    ds_read_b128 v[164:167], v24 offset:8192
    v_mfma_f32_16x16x32_bf16 v[60:63], v[88:91], v[92:95], v[60:63]
    ds_read_b128 v[168:171], v24 offset:9216
    v_mfma_f32_16x16x32_bf16 v[48:51], a[216:219], v[92:95], v[48:51]
    v_mfma_f32_16x16x32_bf16 v[52:55], v[68:71], v[92:95], v[52:55]
    buffer_load_dwordx4 a[116:119], v4, s[32:35], s69 offen offset:1024 sc1
    v_mfma_f32_16x16x32_bf16 v[56:59], v[84:87], v[92:95], v[56:59]
    s_waitcnt lgkmcnt(3)
    v_mfma_f32_16x16x32_bf16 v[52:55], a[220:223], v[96:99], v[52:55]
    ds_read_b128 v[64:67], v22 offset:0
    v_mfma_f32_16x16x32_bf16 v[56:59], a[224:227], v[96:99], v[56:59]
    ds_read_b64 v[68:69], v21 offset:3584
    buffer_load_dwordx4 a[120:123], v4, s[32:35], s69 offen offset:2048 sc1
    v_mfma_f32_16x16x32_bf16 v[60:63], v[100:103], v[96:99], v[60:63]
    ds_read_b64 v[70:71], v21 offset:3592
    ds_read_b64 v[128:129], v23 offset:12288
    v_mfma_f32_16x16x32_bf16 v[52:55], v[104:107], v[244:247], v[52:55]
    ds_read_b128 v[72:75], v22 offset:512
    ds_read_b128 v[132:135], v24 offset:12288
    v_mfma_f32_16x16x32_bf16 v[56:59], v[104:107], v[248:251], v[56:59]
    ds_read_b64 v[76:77], v21 offset:3072
    ds_read_b128 v[136:139], v24 offset:13312
    v_mfma_f32_16x16x32_bf16 v[60:63], v[104:107], v[108:111], v[60:63]
    ds_read_b64 v[78:79], v21 offset:3080
    buffer_load_dwordx4 a[124:127], v4, s[32:35], s69 offen offset:3072 sc1
    v_mfma_f32_16x16x32_bf16 v[48:51], v[100:103], v[108:111], v[48:51]
    ds_read_b128 v[80:83], v22 offset:64
    s_waitcnt lgkmcnt(8)
    v_lshlrev_b32 v176, 16, v160
    v_mfma_f32_16x16x32_bf16 v[48:51], a[220:223], v[112:115], v[48:51]
    ds_read_b64 v[84:85], v21 offset:3648
    v_and_b32 v177, s73, v160
    v_mfma_f32_16x16x32_bf16 v[52:55], a[224:227], v[112:115], v[52:55]
    ds_read_b64 v[86:87], v21 offset:3656
    v_lshlrev_b32 v178, 16, v161
    v_mfma_f32_16x16x32_bf16 v[56:59], v[100:103], v[112:115], v[56:59]
    ds_read_b128 v[88:91], v22 offset:576
    s_add_u32 s69, s94, 32768
    buffer_load_dwordx4 a[128:131], v4, s[32:35], s69 offen offset:0 sc1
    v_mfma_f32_16x16x32_bf16 v[60:63], v[116:119], v[112:115], v[60:63]
    ds_read_b64 v[92:93], v21 offset:3136
    v_and_b32 v179, s73, v161
    v_mfma_f32_16x16x32_bf16 v[48:51], v[116:119], v[248:251], v[48:51]
    ds_read_b64 v[94:95], v21 offset:3144
    v_fmac_f32 v168, v176, v164
    v_mfma_f32_16x16x32_bf16 v[52:55], v[116:119], v[108:111], v[52:55]
    buffer_load_dwordx4 a[132:135], v4, s[32:35], s69 offen offset:1024 sc1
    v_fmac_f32 v169, v177, v165
    v_mfma_f32_16x16x32_bf16 v[48:51], v[120:123], v[244:247], v[48:51]
    v_fmac_f32 v170, v178, v166
    v_fmac_f32 v171, v179, v167
    v_mfma_f32_16x16x32_bf16 v[52:55], v[120:123], v[248:251], v[52:55]
    ds_read_b64 v[160:161], v23 offset:10240
    ds_read_b128 v[164:167], v24 offset:10240
    v_mfma_f32_16x16x32_bf16 v[56:59], v[120:123], v[108:111], v[56:59]
    ds_read_b128 v[172:175], v24 offset:11264
    s_waitcnt lgkmcnt(4)
    v_lshlrev_b32 v144, 16, v128
    v_mfma_f32_16x16x32_bf16 v[60:63], v[120:123], v[124:127], v[60:63]
    buffer_load_dwordx4 a[136:139], v4, s[32:35], s69 offen offset:2048 sc1
    v_and_b32 v145, s73, v128
    v_mfma_f32_16x16x32_bf16 v[48:51], a[224:227], v[124:127], v[48:51]
    v_lshlrev_b32 v146, 16, v129
    v_and_b32 v147, s73, v129
    v_fmac_f32 v136, v144, v132
    v_mfma_f32_16x16x32_bf16 v[52:55], v[100:103], v[124:127], v[52:55]
    v_fmac_f32 v137, v145, v133
    v_fmac_f32 v138, v146, v134
    v_fmac_f32 v139, v147, v135
    v_mfma_f32_16x16x32_bf16 v[56:59], v[116:119], v[124:127], v[56:59]
    buffer_load_dwordx4 a[140:143], v4, s[32:35], s69 offen offset:3072 sc1
    ds_read_b64 v[128:129], v23 offset:14336
    ds_read_b128 v[132:135], v24 offset:14336
    s_waitcnt lgkmcnt(5)
    v_mfma_f32_16x16x32_bf16 v[60:63], v[28:31], v[64:67], v[60:63]
    ds_read_b128 v[96:99], v22 offset:128
    ds_read_b128 v[140:143], v24 offset:15360
    v_mfma_f32_16x16x32_bf16 v[60:63], a[164:167], v[64:67], v[60:63]
    ds_read_b64 v[100:101], v21 offset:3712
    s_waitcnt lgkmcnt(5)
    v_lshlrev_b32 v180, 16, v160
    v_and_b32 v181, s73, v160
    v_lshlrev_b32 v182, 16, v161
    v_and_b32 v183, s73, v161
    v_fmac_f32 v172, v180, v164
    v_fmac_f32 v173, v181, v165
    v_fmac_f32 v174, v182, v166
    v_fmac_f32 v175, v183, v167
    v_mfma_f32_16x16x32_bf16 v[60:63], v[68:71], v[188:191], v[60:63]
    ds_read_b64 v[102:103], v21 offset:3720
    v_mfma_f32_16x16x32_bf16 v[56:59], v[28:31], v[72:75], v[56:59]
    ds_read_b128 v[104:107], v22 offset:640
    s_add_u32 s69, s94, 36864
    buffer_load_dwordx4 a[144:147], v4, s[32:35], s69 offen offset:0 sc1
    v_mfma_f32_16x16x32_bf16 v[56:59], a[164:167], v[72:75], v[56:59]
    ds_read_b64 v[108:109], v21 offset:3200
    v_fmac_f32 v176, v168, v48
    v_fmac_f32 v177, v169, v49
    v_mfma_f32_16x16x32_bf16 v[60:63], a[168:171], v[72:75], v[60:63]
    ds_read_b64 v[110:111], v21 offset:3208
    v_fmac_f32 v178, v170, v50
    v_mfma_f32_16x16x32_bf16 v[56:59], v[76:79], v[188:191], v[56:59]
    v_fmac_f32 v179, v171, v51
    v_cvt_pk_bf16_f32 v184, v176, v177
    v_cvt_pk_bf16_f32 v185, v178, v179
    v_mfma_f32_16x16x32_bf16 v[60:63], v[76:79], v[192:195], v[60:63]
    ds_read_b128 v[112:115], v22 offset:192
    buffer_load_dwordx4 a[148:151], v4, s[32:35], s69 offen offset:1024 sc1
    v_mfma_f32_16x16x32_bf16 v[60:63], a[172:175], v[80:83], v[60:63]
    ds_read_b64 v[116:117], v21 offset:3776
    v_fmac_f32 v180, v172, v52
    v_fmac_f32 v181, v173, v53
    v_mfma_f32_16x16x32_bf16 v[60:63], v[84:87], v[196:199], v[60:63]
    ds_read_b64 v[118:119], v21 offset:3784
    v_fmac_f32 v182, v174, v54
    v_mfma_f32_16x16x32_bf16 v[56:59], a[172:175], v[88:91], v[56:59]
    ds_read_b128 v[120:123], v22 offset:704
    buffer_load_dwordx4 a[152:155], v4, s[32:35], s69 offen offset:2048 sc1
    v_fmac_f32 v183, v175, v55
    v_mfma_f32_16x16x32_bf16 v[60:63], a[176:179], v[88:91], v[60:63]
    ds_read_b64 v[124:125], v21 offset:3264
    v_cvt_pk_bf16_f32 v186, v180, v181
    v_mfma_f32_16x16x32_bf16 v[56:59], v[92:95], v[196:199], v[56:59]
    ds_read_b64 v[126:127], v21 offset:3272
    v_cvt_pk_bf16_f32 v187, v182, v183
    s_waitcnt lgkmcnt(4)
    v_lshlrev_b32 v148, 16, v128
    v_mfma_f32_16x16x32_bf16 v[60:63], v[92:95], v[200:203], v[60:63]
    s_add_u32 s65, s84, 81920
    buffer_store_dwordx4 v[184:187], v25, s[32:35], s65 offen sc1
    v_mfma_f32_16x16x32_bf16 v[60:63], a[180:183], v[96:99], v[60:63]
    ds_read_b128 v[64:67], v22 offset:256
    buffer_load_dwordx4 a[156:159], v4, s[32:35], s69 offen offset:3072 sc1
    v_mfma_f32_16x16x32_bf16 v[60:63], v[100:103], v[204:207], v[60:63]
    ds_read_b64 v[68:69], v21 offset:3840
    v_and_b32 v149, s73, v128
    v_mfma_f32_16x16x32_bf16 v[56:59], a[180:183], v[104:107], v[56:59]
    ds_read_b64 v[70:71], v21 offset:3848
    v_lshlrev_b32 v150, 16, v129
    v_mfma_f32_16x16x32_bf16 v[60:63], a[184:187], v[104:107], v[60:63]
    ds_read_b128 v[72:75], v22 offset:768
    v_and_b32 v151, s73, v129
    v_mfma_f32_16x16x32_bf16 v[56:59], v[108:111], v[204:207], v[56:59]
    ds_read_b64 v[76:77], v21 offset:3328
    v_fmac_f32 v140, v148, v132
    v_mfma_f32_16x16x32_bf16 v[60:63], v[108:111], v[208:211], v[60:63]
    ds_read_b64 v[78:79], v21 offset:3336
    v_fmac_f32 v141, v149, v133
    v_mfma_f32_16x16x32_bf16 v[60:63], a[188:191], v[112:115], v[60:63]
    ds_read_b128 v[80:83], v22 offset:320
    s_waitcnt lgkmcnt(7)
    v_mfma_f32_16x16x32_bf16 v[60:63], v[116:119], v[212:215], v[60:63]
    ds_read_b64 v[84:85], v21 offset:3904
    v_fmac_f32 v142, v150, v134
    v_mfma_f32_16x16x32_bf16 v[56:59], a[188:191], v[120:123], v[56:59]
    ds_read_b64 v[86:87], v21 offset:3912
    v_fmac_f32 v143, v151, v135
    v_mfma_f32_16x16x32_bf16 v[60:63], a[192:195], v[120:123], v[60:63]
    ds_read_b128 v[88:91], v22 offset:832
    v_mfma_f32_16x16x32_bf16 v[56:59], v[124:127], v[212:215], v[56:59]
    ds_read_b64 v[92:93], v21 offset:3392
    v_mfma_f32_16x16x32_bf16 v[60:63], v[124:127], v[216:219], v[60:63]
    ds_read_b64 v[94:95], v21 offset:3400
    s_waitcnt lgkmcnt(6)
    v_mfma_f32_16x16x32_bf16 v[60:63], a[196:199], v[64:67], v[60:63]
    ds_read_b128 v[96:99], v22 offset:384
    v_mfma_f32_16x16x32_bf16 v[60:63], v[68:71], v[220:223], v[60:63]
    ds_read_b64 v[100:101], v21 offset:3968
    v_mfma_f32_16x16x32_bf16 v[56:59], a[196:199], v[72:75], v[56:59]
    ds_read_b64 v[102:103], v21 offset:3976
    v_mfma_f32_16x16x32_bf16 v[60:63], a[200:203], v[72:75], v[60:63]
    ds_read_b128 v[104:107], v22 offset:896
    v_mfma_f32_16x16x32_bf16 v[56:59], v[76:79], v[220:223], v[56:59]
    ds_read_b64 v[108:109], v21 offset:3456
    s_mov_b64 s[16:17], 0
    s_load_dword s16, s[32:33], s14 offset:0
    s_load_dword s17, s[32:33], s14 offset:256
    v_mfma_f32_16x16x32_bf16 v[60:63], v[76:79], v[224:227], v[60:63]
    ds_read_b64 v[110:111], v21 offset:3464
    s_waitcnt lgkmcnt(6)
    v_mfma_f32_16x16x32_bf16 v[60:63], a[204:207], v[80:83], v[60:63]
    ds_read_b128 v[112:115], v22 offset:448
    v_mfma_f32_16x16x32_bf16 v[60:63], v[84:87], v[228:231], v[60:63]
    ds_read_b64 v[116:117], v21 offset:4032
    v_mfma_f32_16x16x32_bf16 v[56:59], a[204:207], v[88:91], v[56:59]
    ds_read_b64 v[118:119], v21 offset:4040
    v_mfma_f32_16x16x32_bf16 v[60:63], a[208:211], v[88:91], v[60:63]
    ds_read_b128 v[120:123], v22 offset:960
    v_mfma_f32_16x16x32_bf16 v[56:59], v[92:95], v[228:231], v[56:59]
    ds_read_b64 v[124:125], v21 offset:3520
    v_mfma_f32_16x16x32_bf16 v[60:63], v[92:95], v[232:235], v[60:63]
    ds_read_b64 v[126:127], v21 offset:3528
    ds_read_b32 v16, v9
    ds_read_b32 v16, v9
    s_waitcnt lgkmcnt(6)
    v_mfma_f32_16x16x32_bf16 v[60:63], a[212:215], v[96:99], v[60:63]
    v_mfma_f32_16x16x32_bf16 v[60:63], v[100:103], v[236:239], v[60:63]
    v_mfma_f32_16x16x32_bf16 v[56:59], a[212:215], v[104:107], v[56:59]
    v_mfma_f32_16x16x32_bf16 v[60:63], a[216:219], v[104:107], v[60:63]
    v_mfma_f32_16x16x32_bf16 v[56:59], v[108:111], v[236:239], v[56:59]
    v_mfma_f32_16x16x32_bf16 v[60:63], v[108:111], v[240:243], v[60:63]
    s_waitcnt lgkmcnt(2)
    v_mfma_f32_16x16x32_bf16 v[60:63], a[220:223], v[112:115], v[60:63]
    v_mfma_f32_16x16x32_bf16 v[60:63], v[116:119], v[244:247], v[60:63]
    v_mfma_f32_16x16x32_bf16 v[56:59], a[220:223], v[120:123], v[56:59]
    v_mfma_f32_16x16x32_bf16 v[60:63], a[224:227], v[120:123], v[60:63]
    v_mfma_f32_16x16x32_bf16 v[56:59], v[124:127], v[244:247], v[56:59]
    v_mfma_f32_16x16x32_bf16 v[60:63], v[124:127], v[248:251], v[60:63]
    s_nop 6
    v_fmac_f32 v144, v136, v56
    v_fmac_f32 v145, v137, v57
    v_fmac_f32 v146, v138, v58
    v_fmac_f32 v147, v139, v59
    v_cvt_pk_bf16_f32 v152, v144, v145
    v_cvt_pk_bf16_f32 v153, v146, v147
    v_fmac_f32 v148, v140, v60
    v_fmac_f32 v149, v141, v61
    v_fmac_f32 v150, v142, v62
    v_fmac_f32 v151, v143, v63
    v_cvt_pk_bf16_f32 v154, v148, v149
    v_cvt_pk_bf16_f32 v155, v150, v151
    s_add_u32 s65, s84, 122880
    buffer_store_dwordx4 v[152:155], v25, s[32:35], s65 offen sc1
    s_min_u32 s72, s16, s17
    s_cmp_lt_u32 s72, 20
    s_cbranch_scc1 L_slow8
L_ret8:
    s_barrier
    s_add_u32 m0, s86, 117760
    s_add_u32 s66, s85, 0
    buffer_load_dwordx4 v4, s[32:35], s66 offen offset:0 sc1 lds
    buffer_load_dwordx4 v4, s[32:35], s66 offen offset:1024 sc1 lds
    buffer_load_dwordx4 v4, s[32:35], s66 offen offset:2048 sc1 lds
    buffer_load_dwordx4 v4, s[32:35], s66 offen offset:3072 sc1 lds
    s_add_u32 m0, s86, 121856
    s_add_u32 s66, s85, 4096
    buffer_load_dwordx4 v4, s[32:35], s66 offen offset:0 sc1 lds
    buffer_load_dwordx4 v4, s[32:35], s66 offen offset:1024 sc1 lds
    buffer_load_dwordx4 v4, s[32:35], s66 offen offset:2048 sc1 lds
    buffer_load_dwordx4 v4, s[32:35], s66 offen offset:3072 sc1 lds
    s_add_u32 m0, s86, 125952
    s_add_u32 s66, s85, 8192
    buffer_load_dwordx4 v4, s[32:35], s66 offen offset:0 sc1 lds
    buffer_load_dwordx4 v4, s[32:35], s66 offen offset:1024 sc1 lds
L_g1:
    s_cmp_eq_u32 s56, 3
    s_cbranch_scc1 L_g1w3
    s_mov_b32 s74, 0x2edbe6ff
    s_mov_b32 s19, 4
    v_mov_b32 v106, 0
    v_mov_b32 v107, 0
    s_mov_b64 s[16:17], 0
    s_load_dword s16, s[32:33], s18 offset:111616
    v_and_b32 v56, 31, v1
    s_mul_i32 s67, s62, 3
    s_add_u32 s67, s67, s56
    v_lshl_add_u32 v56, s67, 5, v56
    v_lshlrev_b32 v57, 1, v56
    v_lshlrev_b32 v56, 2, v56
    buffer_load_ushort v63, v57, s[44:47], 0 offen
    s_mov_b32 s67, 17514496
    buffer_load_dword v58, v56, s[32:35], s67 offen sc1
    s_mov_b32 s67, 17522688
    buffer_load_dword v59, v56, s[32:35], s67 offen sc1
    s_mov_b32 s67, 17530880
    buffer_load_dword v60, v56, s[32:35], s67 offen sc1
    s_mov_b32 s67, 17539072
    buffer_load_dword v61, v56, s[32:35], s67 offen sc1
    s_mov_b32 s67, 17547264
    buffer_load_dword v62, v56, s[32:35], s67 offen sc1
    s_waitcnt vmcnt(6)
    s_barrier
    s_cmp_lg_u32 s3, 0
    s_cbranch_scc1 L_nosig10
    s_cmp_ge_u32 s56, 2
    s_cbranch_scc1 L_nosig9
    s_atomic_add s12, s[32:33], s13 offset:16384
L_nosig9:
L_nosig10:
    ds_read_b64_tr_b16 v[72:73], v2 offset:0
    ds_read_b64_tr_b16 v[74:75], v3 offset:0
    ds_read_b64_tr_b16 v[76:77], v2 offset:1024
    ds_read_b64_tr_b16 v[78:79], v3 offset:1024
    ds_read_b64_tr_b16 v[80:81], v2 offset:2048
    ds_read_b64_tr_b16 v[82:83], v3 offset:2048
    ds_read_b64_tr_b16 v[84:85], v2 offset:3072
    ds_read_b64_tr_b16 v[86:87], v3 offset:3072
    ds_read_b64_tr_b16 v[88:89], v2 offset:4096
    ds_read_b64_tr_b16 v[90:91], v3 offset:4096
    ds_read_b64_tr_b16 v[92:93], v2 offset:5120
    ds_read_b64_tr_b16 v[94:95], v3 offset:5120
    ds_read_b64_tr_b16 v[96:97], v2 offset:6144
    ds_read_b64_tr_b16 v[98:99], v3 offset:6144
    s_waitcnt lgkmcnt(12)
    v_mfma_f32_32x32x16_bf16 v[24:39], a[0:3], v[72:75], 0
    ds_read_b64_tr_b16 v[100:101], v2 offset:7168
    ds_read_b64_tr_b16 v[102:103], v3 offset:7168
    s_add_u32 m0, s86, 0
    s_add_u32 s66, s85, 40960
    buffer_load_dwordx4 v4, s[32:35], s66 offen offset:0 sc1 lds
    ds_read_b64_tr_b16 v[124:125], v7 offset:0
    s_waitcnt lgkmcnt(9)
    v_mfma_f32_32x32x16_bf16 v[24:39], a[4:7], v[76:79], v[24:39]
    ds_read_b64_tr_b16 v[72:73], v2 offset:8192
    ds_read_b64_tr_b16 v[74:75], v3 offset:8192
    buffer_load_dwordx4 v4, s[32:35], s66 offen offset:1024 sc1 lds
    ds_read_b64_tr_b16 v[126:127], v7 offset:2048
    v_mfma_f32_32x32x16_bf16 v[24:39], a[8:11], v[80:83], v[24:39]
    ds_read_b64_tr_b16 v[76:77], v2 offset:9216
    ds_read_b64_tr_b16 v[78:79], v3 offset:9216
    v_mfma_f32_32x32x16_bf16 v[24:39], a[12:15], v[84:87], v[24:39]
    ds_read_b64_tr_b16 v[80:81], v2 offset:10240
    ds_read_b64_tr_b16 v[82:83], v3 offset:10240
    buffer_load_dwordx4 v4, s[32:35], s66 offen offset:2048 sc1 lds
    s_waitcnt lgkmcnt(8)
    v_mfma_f32_32x32x16_bf16 v[24:39], a[16:19], v[88:91], v[24:39]
    ds_read_b64_tr_b16 v[84:85], v2 offset:11264
    ds_read_b64_tr_b16 v[86:87], v3 offset:11264
    buffer_load_dwordx4 v4, s[32:35], s66 offen offset:3072 sc1 lds
    v_mfma_f32_32x32x16_bf16 v[24:39], a[20:23], v[92:95], v[24:39]
    ds_read_b64_tr_b16 v[88:89], v2 offset:12288
    ds_read_b64_tr_b16 v[90:91], v3 offset:12288
    s_waitcnt lgkmcnt(8)
    ds_write_b64 v8, v[124:125] offset:0
    ds_write_b64 v8, v[126:127] offset:64
    v_add_u32 v7, 4294849536, v7
    v_mfma_f32_32x32x16_bf16 v[24:39], a[24:27], v[96:99], v[24:39]
    ds_read_b64_tr_b16 v[92:93], v2 offset:13312
    ds_read_b64_tr_b16 v[94:95], v3 offset:13312
    s_add_u32 m0, s86, 4096
    s_add_u32 s66, s85, 45056
    buffer_load_dwordx4 v4, s[32:35], s66 offen offset:0 sc1 lds
    v_mfma_f32_32x32x16_bf16 v[24:39], a[28:31], v[100:103], v[24:39]
    ds_read_b64_tr_b16 v[96:97], v2 offset:14336
    ds_read_b64_tr_b16 v[98:99], v3 offset:14336
    buffer_load_dwordx4 v4, s[32:35], s66 offen offset:1024 sc1 lds
    s_waitcnt lgkmcnt(8)
    v_mfma_f32_32x32x16_bf16 v[24:39], a[32:35], v[72:75], v[24:39]
    ds_read_b64_tr_b16 v[100:101], v2 offset:15360
    ds_read_b64_tr_b16 v[102:103], v3 offset:15360
    v_mfma_f32_32x32x16_bf16 v[24:39], a[36:39], v[76:79], v[24:39]
    ds_read_b64_tr_b16 v[72:73], v2 offset:16384
    ds_read_b64_tr_b16 v[74:75], v3 offset:16384
    buffer_load_dwordx4 v4, s[32:35], s66 offen offset:2048 sc1 lds
    v_mfma_f32_32x32x16_bf16 v[24:39], a[40:43], v[80:83], v[24:39]
    ds_read_b64_tr_b16 v[76:77], v2 offset:17408
    ds_read_b64_tr_b16 v[78:79], v3 offset:17408
    buffer_load_dwordx4 v4, s[32:35], s66 offen offset:3072 sc1 lds
    v_mfma_f32_32x32x16_bf16 v[24:39], a[44:47], v[84:87], v[24:39]
    ds_read_b64_tr_b16 v[80:81], v2 offset:18432
    ds_read_b64_tr_b16 v[82:83], v3 offset:18432
    s_waitcnt lgkmcnt(6)
    v_mfma_f32_32x32x16_bf16 v[24:39], a[48:51], v[88:91], v[24:39]
    ds_read_b64_tr_b16 v[84:85], v2 offset:19456
    ds_read_b64_tr_b16 v[86:87], v3 offset:19456
    s_add_u32 m0, s86, 8192
    s_add_u32 s66, s85, 49152
    buffer_load_dwordx4 v4, s[32:35], s66 offen offset:0 sc1 lds
    v_mfma_f32_32x32x16_bf16 v[24:39], a[52:55], v[92:95], v[24:39]
    ds_read_b64_tr_b16 v[88:89], v2 offset:20480
    ds_read_b64_tr_b16 v[90:91], v3 offset:20480
    buffer_load_dwordx4 v4, s[32:35], s66 offen offset:1024 sc1 lds
    v_mfma_f32_32x32x16_bf16 v[24:39], a[56:59], v[96:99], v[24:39]
    ds_read_b64_tr_b16 v[92:93], v2 offset:21504
    ds_read_b64_tr_b16 v[94:95], v3 offset:21504
    s_cmp_lt_u32 s16, 14
    s_cbranch_scc1 L_slow12
L_ret12:
    v_mfma_f32_32x32x16_bf16 v[24:39], a[60:63], v[100:103], v[24:39]
    ds_read_b64_tr_b16 v[96:97], v2 offset:22528
    ds_read_b64_tr_b16 v[98:99], v3 offset:22528
    s_add_u32 s69, s87, 0
    buffer_load_dwordx4 a[228:231], v4, s[32:35], s69 offen offset:0 sc1
    s_waitcnt lgkmcnt(6)
    v_mfma_f32_32x32x16_bf16 v[24:39], a[64:67], v[72:75], v[24:39]
    ds_read_b64_tr_b16 v[100:101], v2 offset:23552
    ds_read_b64_tr_b16 v[102:103], v3 offset:23552
    buffer_load_dwordx4 a[232:235], v4, s[32:35], s69 offen offset:1024 sc1
    v_mfma_f32_32x32x16_bf16 v[24:39], a[68:71], v[76:79], v[24:39]
    ds_read_b64_tr_b16 v[72:73], v2 offset:24576
    ds_read_b64_tr_b16 v[74:75], v3 offset:24576
    v_mfma_f32_32x32x16_bf16 v[24:39], a[72:75], v[80:83], v[24:39]
    ds_read_b64_tr_b16 v[76:77], v2 offset:25600
    ds_read_b64_tr_b16 v[78:79], v3 offset:25600
    buffer_load_dwordx4 a[236:239], v4, s[32:35], s69 offen offset:2048 sc1
    v_mfma_f32_32x32x16_bf16 v[24:39], a[76:79], v[84:87], v[24:39]
    ds_read_b64_tr_b16 v[80:81], v2 offset:26624
    ds_read_b64_tr_b16 v[82:83], v3 offset:26624
    buffer_load_dwordx4 a[240:243], v4, s[32:35], s69 offen offset:3072 sc1
    s_waitcnt lgkmcnt(6)
    v_mfma_f32_32x32x16_bf16 v[24:39], a[80:83], v[88:91], v[24:39]
    ds_read_b64_tr_b16 v[84:85], v2 offset:27648
    ds_read_b64_tr_b16 v[86:87], v3 offset:27648
    s_waitcnt vmcnt(17)
    v_add_f32 v58, v58, v59
    s_waitcnt vmcnt(16)
    v_add_f32 v58, v58, v60
    s_waitcnt vmcnt(15)
    v_add_f32 v58, v58, v61
    s_waitcnt vmcnt(14)
    v_add_f32 v58, v58, v62
    v_mfma_f32_32x32x16_bf16 v[24:39], a[84:87], v[92:95], v[24:39]
    ds_read_b64_tr_b16 v[88:89], v2 offset:28672
    ds_read_b64_tr_b16 v[90:91], v3 offset:28672
    s_add_u32 s69, s87, 4096
    buffer_load_dwordx4 a[244:247], v4, s[32:35], s69 offen offset:0 sc1
    v_mul_f32 v58, 0xbacccccd, v58
    v_lshl_or_b32 v63, v63, 16, v63
    v_mfma_f32_32x32x16_bf16 v[24:39], a[88:91], v[96:99], v[24:39]
    ds_read_b64_tr_b16 v[92:93], v2 offset:29696
    ds_read_b64_tr_b16 v[94:95], v3 offset:29696
    buffer_load_dwordx4 a[248:251], v4, s[32:35], s69 offen offset:1024 sc1
    v_cmp_gt_u32 s[98:99], 32, v1
    v_and_b32 v64, s73, v58
    v_sub_f32 v58, v58, v64
    v_mfma_f32_32x32x16_bf16 v[24:39], a[92:95], v[100:103], v[24:39]
    ds_read_b64_tr_b16 v[96:97], v2 offset:30720
    ds_read_b64_tr_b16 v[98:99], v3 offset:30720
    v_cndmask_b32 v63, 0, v63, s[98:99]
    v_cndmask_b32 v64, v58, v64, s[98:99]
    v_accvgpr_write_b32 a162, 0
    s_waitcnt lgkmcnt(6)
    v_mfma_f32_32x32x16_bf16 v[24:39], a[96:99], v[72:75], v[24:39]
    ds_read_b64_tr_b16 v[100:101], v2 offset:31744
    ds_read_b64_tr_b16 v[102:103], v3 offset:31744
    buffer_load_dwordx4 a[252:255], v4, s[32:35], s69 offen offset:2048 sc1
    v_accvgpr_write_b32 a163, 0
    v_cvt_pk_bf16_f32 v64, v64, v64
    v_accvgpr_write_b32 a161, v63
    v_mfma_f32_32x32x16_bf16 v[24:39], a[100:103], v[76:79], v[24:39]
    ds_read_b64_tr_b16 v[72:73], v2 offset:32768
    ds_read_b64_tr_b16 v[74:75], v3 offset:32768
    buffer_load_dwordx4 v[128:131], v4, s[32:35], s69 offen offset:3072 sc1
    v_accvgpr_write_b32 a160, v64
    v_mfma_f32_32x32x16_bf16 v[24:39], a[104:107], v[80:83], v[24:39]
    ds_read_b64_tr_b16 v[76:77], v2 offset:33792
    ds_read_b64_tr_b16 v[78:79], v3 offset:33792
    v_mfma_f32_32x32x16_bf16 v[24:39], a[108:111], v[84:87], v[24:39]
    ds_read_b64_tr_b16 v[80:81], v2 offset:34816
    ds_read_b64_tr_b16 v[82:83], v3 offset:34816
    s_add_u32 s69, s87, 8192
    buffer_load_dwordx4 v[132:135], v4, s[32:35], s69 offen offset:0 sc1
    s_waitcnt lgkmcnt(6)
    v_mfma_f32_32x32x16_bf16 v[24:39], a[112:115], v[88:91], v[24:39]
    ds_read_b64_tr_b16 v[84:85], v2 offset:35840
    ds_read_b64_tr_b16 v[86:87], v3 offset:35840
    buffer_load_dwordx4 v[136:139], v4, s[32:35], s69 offen offset:1024 sc1
    v_mfma_f32_32x32x16_bf16 v[24:39], a[116:119], v[92:95], v[24:39]
    ds_read_b64_tr_b16 v[88:89], v2 offset:36864
    ds_read_b64_tr_b16 v[90:91], v3 offset:36864
    v_mfma_f32_32x32x16_bf16 v[24:39], a[120:123], v[96:99], v[24:39]
    ds_read_b64_tr_b16 v[92:93], v2 offset:37888
    ds_read_b64_tr_b16 v[94:95], v3 offset:37888
    buffer_load_dwordx4 v[140:143], v4, s[32:35], s69 offen offset:2048 sc1
    v_mfma_f32_32x32x16_bf16 v[24:39], a[124:127], v[100:103], v[24:39]
    ds_read_b64_tr_b16 v[96:97], v2 offset:38912
    ds_read_b64_tr_b16 v[98:99], v3 offset:38912
    s_waitcnt lgkmcnt(6)
    v_mfma_f32_32x32x16_bf16 v[24:39], a[128:131], v[72:75], v[24:39]
    ds_read_b64_tr_b16 v[100:101], v2 offset:39936
    ds_read_b64_tr_b16 v[102:103], v3 offset:39936
    buffer_load_dwordx4 v[144:147], v4, s[32:35], s69 offen offset:3072 sc1
    v_add_u32 v2, 4294849536, v2
    v_add_u32 v3, 4294849536, v3
    s_waitcnt vmcnt(12)
    s_barrier
    s_mov_b64 s[16:17], 0
    s_load_dword s16, s[32:33], s14 offset:16384
    s_load_dword s17, s[32:33], s14 offset:16640
    v_mfma_f32_32x32x16_bf16 v[24:39], a[132:135], v[76:79], v[24:39]
    ds_read_b64_tr_b16 v[72:73], v2 offset:0
    ds_read_b64_tr_b16 v[74:75], v3 offset:0
    s_add_u32 s69, s87, 12288
    buffer_load_dwordx4 v[148:151], v4, s[32:35], s69 offen offset:0 sc1
    v_mfma_f32_32x32x16_bf16 v[24:39], a[136:139], v[80:83], v[24:39]
    ds_read_b64_tr_b16 v[76:77], v2 offset:1024
    ds_read_b64_tr_b16 v[78:79], v3 offset:1024
    v_mfma_f32_32x32x16_bf16 v[24:39], a[140:143], v[84:87], v[24:39]
    ds_read_b64_tr_b16 v[80:81], v2 offset:2048
    ds_read_b64_tr_b16 v[82:83], v3 offset:2048
    buffer_load_dwordx4 v[152:155], v4, s[32:35], s69 offen offset:1024 sc1
    s_waitcnt lgkmcnt(6)
    v_mfma_f32_32x32x16_bf16 v[24:39], a[144:147], v[88:91], v[24:39]
    ds_read_b64_tr_b16 v[84:85], v2 offset:3072
    ds_read_b64_tr_b16 v[86:87], v3 offset:3072
    buffer_load_dwordx4 v[156:159], v4, s[32:35], s69 offen offset:2048 sc1
    v_mfma_f32_32x32x16_bf16 v[24:39], a[148:151], v[92:95], v[24:39]
    ds_read_b64_tr_b16 v[88:89], v2 offset:4096
    ds_read_b64_tr_b16 v[90:91], v3 offset:4096
    v_mfma_f32_32x32x16_bf16 v[24:39], a[152:155], v[96:99], v[24:39]
    ds_read_b64_tr_b16 v[92:93], v2 offset:5120
    ds_read_b64_tr_b16 v[94:95], v3 offset:5120
    buffer_load_dwordx4 a[164:167], v4, s[32:35], s69 offen offset:3072 sc1
    v_mfma_f32_32x32x16_bf16 v[24:39], a[156:159], v[100:103], v[24:39]
    ds_read_b64_tr_b16 v[96:97], v2 offset:6144
    ds_read_b64_tr_b16 v[98:99], v3 offset:6144
    s_add_u32 s69, s87, 16384
    buffer_load_dwordx4 a[168:171], v4, s[32:35], s69 offen offset:0 sc1
    s_waitcnt lgkmcnt(6)
    v_mfma_f32_32x32x16_bf16 v[40:55], a[0:3], v[72:75], 0
    ds_read_b64_tr_b16 v[100:101], v2 offset:7168
    ds_read_b64_tr_b16 v[102:103], v3 offset:7168
    ds_read_b64_tr_b16 v[124:125], v7 offset:0
    ds_read_b64_tr_b16 v[126:127], v7 offset:2048
    v_mfma_f32_32x32x16_bf16 v[40:55], a[4:7], v[76:79], v[40:55]
    ds_read_b64_tr_b16 v[72:73], v2 offset:8192
    ds_read_b64_tr_b16 v[74:75], v3 offset:8192
    buffer_load_dwordx4 a[172:175], v4, s[32:35], s69 offen offset:1024 sc1
    v_mfma_f32_32x32x16_bf16 v[40:55], a[8:11], v[80:83], v[40:55]
    ds_read_b64_tr_b16 v[76:77], v2 offset:9216
    ds_read_b64_tr_b16 v[78:79], v3 offset:9216
    buffer_load_dwordx4 a[176:179], v4, s[32:35], s69 offen offset:2048 sc1
    v_mfma_f32_32x32x16_bf16 v[40:55], a[12:15], v[84:87], v[40:55]
    ds_read_b64_tr_b16 v[80:81], v2 offset:10240
    ds_read_b64_tr_b16 v[82:83], v3 offset:10240
    s_waitcnt lgkmcnt(8)
    v_mfma_f32_32x32x16_bf16 v[40:55], a[16:19], v[88:91], v[40:55]
    ds_read_b64_tr_b16 v[84:85], v2 offset:11264
    ds_read_b64_tr_b16 v[86:87], v3 offset:11264
    buffer_load_dwordx4 a[180:183], v4, s[32:35], s69 offen offset:3072 sc1
    s_waitcnt lgkmcnt(7)
    ds_write_b64 v8, v[124:125] offset:2560
    ds_write_b64 v8, v[126:127] offset:2624
    v_add_u32 v7, 40960, v7
    v_mfma_f32_32x32x16_bf16 v[40:55], a[20:23], v[92:95], v[40:55]
    ds_read_b64_tr_b16 v[88:89], v2 offset:12288
    ds_read_b64_tr_b16 v[90:91], v3 offset:12288
    v_mfma_f32_32x32x16_bf16 v[40:55], a[24:27], v[96:99], v[40:55]
    ds_read_b64_tr_b16 v[92:93], v2 offset:13312
    ds_read_b64_tr_b16 v[94:95], v3 offset:13312
    s_min_u32 s72, s16, s17
    s_cmp_lt_u32 s72, 20
    s_cbranch_scc1 L_slow13
L_ret13:
    s_barrier
    v_mfma_f32_32x32x16_bf16 v[40:55], a[28:31], v[100:103], v[40:55]
    ds_read_b64_tr_b16 v[96:97], v2 offset:14336
    ds_read_b64_tr_b16 v[98:99], v3 offset:14336
    s_add_u32 m0, s10, 40960
    s_add_u32 s66, s11, 81920
    buffer_load_dwordx4 v4, s[32:35], s66 offen offset:0 sc1 lds
    s_waitcnt lgkmcnt(8)
    v_mfma_f32_32x32x16_bf16 v[40:55], a[32:35], v[72:75], v[40:55]
    ds_read_b64_tr_b16 v[100:101], v2 offset:15360
    ds_read_b64_tr_b16 v[102:103], v3 offset:15360
    buffer_load_dwordx4 v4, s[32:35], s66 offen offset:1024 sc1 lds
    v_mfma_f32_32x32x16_bf16 v[40:55], a[36:39], v[76:79], v[40:55]
    ds_read_b64_tr_b16 v[72:73], v2 offset:16384
    ds_read_b64_tr_b16 v[74:75], v3 offset:16384
    buffer_load_dwordx4 v4, s[32:35], s66 offen offset:2048 sc1 lds
    v_mfma_f32_32x32x16_bf16 v[40:55], a[40:43], v[80:83], v[40:55]
    ds_read_b64_tr_b16 v[76:77], v2 offset:17408
    ds_read_b64_tr_b16 v[78:79], v3 offset:17408
    buffer_load_dwordx4 v4, s[32:35], s66 offen offset:3072 sc1 lds
    v_mfma_f32_32x32x16_bf16 v[40:55], a[44:47], v[84:87], v[40:55]
    ds_read_b64_tr_b16 v[80:81], v2 offset:18432
    ds_read_b64_tr_b16 v[82:83], v3 offset:18432
    s_add_u32 m0, s10, 45056
    s_add_u32 s66, s11, 86016
    buffer_load_dwordx4 v4, s[32:35], s66 offen offset:0 sc1 lds
    s_waitcnt lgkmcnt(6)
    v_mfma_f32_32x32x16_bf16 v[40:55], a[48:51], v[88:91], v[40:55]
    ds_read_b64_tr_b16 v[84:85], v2 offset:19456
    ds_read_b64_tr_b16 v[86:87], v3 offset:19456
    buffer_load_dwordx4 v4, s[32:35], s66 offen offset:1024 sc1 lds
    v_mfma_f32_32x32x16_bf16 v[40:55], a[52:55], v[92:95], v[40:55]
    ds_read_b64_tr_b16 v[88:89], v2 offset:20480
    ds_read_b64_tr_b16 v[90:91], v3 offset:20480
    buffer_load_dwordx4 v4, s[32:35], s66 offen offset:2048 sc1 lds
    s_barrier
    v_mfma_f32_32x32x16_bf16 v[40:55], a[56:59], v[96:99], v[40:55]
    ds_read_b64_tr_b16 v[92:93], v2 offset:21504
    ds_read_b64_tr_b16 v[94:95], v3 offset:21504
    buffer_load_dwordx4 v4, s[32:35], s66 offen offset:3072 sc1 lds
    ds_read_b64 v[104:105], v6 offset:16
    ds_read_b128 v[108:111], v6 offset:0
    v_mfma_f32_32x32x16_bf16 v[40:55], a[60:63], v[100:103], v[40:55]
    ds_read_b64_tr_b16 v[96:97], v2 offset:22528
    ds_read_b64_tr_b16 v[98:99], v3 offset:22528
    s_add_u32 m0, s10, 49152
    s_add_u32 s66, s11, 90112
    buffer_load_dwordx4 v4, s[32:35], s66 offen offset:0 sc1 lds
    s_waitcnt lgkmcnt(8)
    v_mfma_f32_32x32x16_bf16 v[40:55], a[64:67], v[72:75], v[40:55]
    ds_read_b64_tr_b16 v[100:101], v2 offset:23552
    ds_read_b64_tr_b16 v[102:103], v3 offset:23552
    buffer_load_dwordx4 v4, s[32:35], s66 offen offset:1024 sc1 lds
    v_mfma_f32_32x32x16_bf16 v[40:55], a[68:71], v[76:79], v[40:55]
    ds_read_b64_tr_b16 v[72:73], v2 offset:24576
    ds_read_b64_tr_b16 v[74:75], v3 offset:24576
    buffer_load_dwordx4 v4, s[32:35], s66 offen offset:2048 sc1 lds
    s_waitcnt lgkmcnt(6)
    v_mfma_f32_32x32x16_bf16 v[24:39], a[160:163], v[104:107], v[24:39]
    v_mfma_f32_32x32x16_bf16 v[40:55], a[72:75], v[80:83], v[40:55]
    ds_read_b64_tr_b16 v[76:77], v2 offset:25600
    ds_read_b64_tr_b16 v[78:79], v3 offset:25600
    buffer_load_dwordx4 v4, s[32:35], s66 offen offset:3072 sc1 lds
    v_mfma_f32_32x32x16_bf16 v[40:55], a[76:79], v[84:87], v[40:55]
    ds_read_b64_tr_b16 v[80:81], v2 offset:26624
    ds_read_b64_tr_b16 v[82:83], v3 offset:26624
    s_add_u32 m0, s10, 53248
    s_add_u32 s66, s11, 94208
    buffer_load_dwordx4 v4, s[32:35], s66 offen offset:0 sc1 lds
    s_waitcnt lgkmcnt(6)
    v_mfma_f32_32x32x16_bf16 v[40:55], a[80:83], v[88:91], v[40:55]
    ds_read_b64_tr_b16 v[84:85], v2 offset:27648
    ds_read_b64_tr_b16 v[86:87], v3 offset:27648
    buffer_load_dwordx4 v4, s[32:35], s66 offen offset:1024 sc1 lds
    v_mul_f32 v116, v24, v24
    v_mul_f32 v117, v25, v25
    v_fma_f32 v116, v116, v110, v109
    v_fma_f32 v117, v117, v110, v109
    v_mul_f32 v116, v116, v24
    v_mfma_f32_32x32x16_bf16 v[40:55], a[84:87], v[92:95], v[40:55]
    ds_read_b64_tr_b16 v[88:89], v2 offset:28672
    ds_read_b64_tr_b16 v[90:91], v3 offset:28672
    s_add_u32 s69, s87, 20480
    buffer_load_dwordx4 a[184:187], v4, s[32:35], s69 offen offset:0 sc1
    v_mul_f32 v117, v117, v25
    v_exp_f32 v116, v116
    v_mfma_f32_32x32x16_bf16 v[40:55], a[88:91], v[96:99], v[40:55]
    ds_read_b64_tr_b16 v[92:93], v2 offset:29696
    ds_read_b64_tr_b16 v[94:95], v3 offset:29696
    v_exp_f32 v117, v117
    v_mul_f32 v118, v26, v26
    v_fma_f32 v116, v116, v108, v108
    v_mul_f32 v119, v27, v27
    v_fma_f32 v117, v117, v108, v108
    v_mfma_f32_32x32x16_bf16 v[40:55], a[92:95], v[100:103], v[40:55]
    ds_read_b64_tr_b16 v[96:97], v2 offset:30720
    ds_read_b64_tr_b16 v[98:99], v3 offset:30720
    buffer_load_dwordx4 a[188:191], v4, s[32:35], s69 offen offset:1024 sc1
    v_rcp_f32 v116, v116
    v_fma_f32 v118, v118, v110, v109
    v_fma_f32 v119, v119, v110, v109
    s_waitcnt lgkmcnt(6)
    v_mfma_f32_32x32x16_bf16 v[40:55], a[96:99], v[72:75], v[40:55]
    ds_read_b64_tr_b16 v[100:101], v2 offset:31744
    ds_read_b64_tr_b16 v[102:103], v3 offset:31744
    v_rcp_f32 v117, v117
    v_mul_f32 v118, v118, v26
    v_mul_f32 v119, v119, v27
    v_exp_f32 v118, v118
    v_mfma_f32_32x32x16_bf16 v[40:55], a[100:103], v[76:79], v[40:55]
    ds_read_b64_tr_b16 v[72:73], v2 offset:32768
    ds_read_b64_tr_b16 v[74:75], v3 offset:32768
    buffer_load_dwordx4 a[192:195], v4, s[32:35], s69 offen offset:2048 sc1
    v_mul_f32 v116, v116, v24
    v_mul_f32 v117, v117, v25
    v_exp_f32 v119, v119
    v_cvt_pk_bf16_f32 v24, v116, v117
    v_mfma_f32_32x32x16_bf16 v[40:55], a[104:107], v[80:83], v[40:55]
    ds_read_b64_tr_b16 v[76:77], v2 offset:33792
    ds_read_b64_tr_b16 v[78:79], v3 offset:33792
    buffer_load_dwordx4 a[196:199], v4, s[32:35], s69 offen offset:3072 sc1
    v_mul_f32 v120, v28, v28
    v_fma_f32 v118, v118, v108, v108
    v_mul_f32 v121, v29, v29
    v_fma_f32 v119, v119, v108, v108
    v_mfma_f32_32x32x16_bf16 v[40:55], a[108:111], v[84:87], v[40:55]
    ds_read_b64_tr_b16 v[80:81], v2 offset:34816
    ds_read_b64_tr_b16 v[82:83], v3 offset:34816
    v_rcp_f32 v118, v118
    v_fma_f32 v120, v120, v110, v109
    v_fma_f32 v121, v121, v110, v109
    s_waitcnt lgkmcnt(6)
    v_mfma_f32_32x32x16_bf16 v[40:55], a[112:115], v[88:91], v[40:55]
    ds_read_b64_tr_b16 v[84:85], v2 offset:35840
    ds_read_b64_tr_b16 v[86:87], v3 offset:35840
    s_add_u32 s69, s87, 24576
    buffer_load_dwordx4 a[200:203], v4, s[32:35], s69 offen offset:0 sc1
    v_rcp_f32 v119, v119
    v_mul_f32 v120, v120, v28
    v_mul_f32 v121, v121, v29
    v_mfma_f32_32x32x16_bf16 v[40:55], a[116:119], v[92:95], v[40:55]
    ds_read_b64_tr_b16 v[88:89], v2 offset:36864
    ds_read_b64_tr_b16 v[90:91], v3 offset:36864
    buffer_load_dwordx4 a[204:207], v4, s[32:35], s69 offen offset:1024 sc1
    v_exp_f32 v120, v120
    v_mul_f32 v118, v118, v26
    v_mul_f32 v119, v119, v27
    v_exp_f32 v121, v121
    v_mfma_f32_32x32x16_bf16 v[40:55], a[120:123], v[96:99], v[40:55]
    ds_read_b64_tr_b16 v[92:93], v2 offset:37888
    ds_read_b64_tr_b16 v[94:95], v3 offset:37888
    v_cvt_pk_bf16_f32 v25, v118, v119
    v_mul_f32 v116, v30, v30
    v_fma_f32 v120, v120, v108, v108
    v_mul_f32 v117, v31, v31
    v_fma_f32 v121, v121, v108, v108
    v_mfma_f32_32x32x16_bf16 v[40:55], a[124:127], v[100:103], v[40:55]
    ds_read_b64_tr_b16 v[96:97], v2 offset:38912
    ds_read_b64_tr_b16 v[98:99], v3 offset:38912
    buffer_load_dwordx4 a[208:211], v4, s[32:35], s69 offen offset:2048 sc1
    v_rcp_f32 v120, v120
    v_fma_f32 v116, v116, v110, v109
    v_fma_f32 v117, v117, v110, v109
    s_waitcnt lgkmcnt(6)
    v_mfma_f32_32x32x16_bf16 v[40:55], a[128:131], v[72:75], v[40:55]
    ds_read_b64_tr_b16 v[100:101], v2 offset:39936
    ds_read_b64_tr_b16 v[102:103], v3 offset:39936
    buffer_load_dwordx4 a[212:215], v4, s[32:35], s69 offen offset:3072 sc1
    v_add_u32 v2, 40960, v2
    v_add_u32 v3, 40960, v3
    s_waitcnt vmcnt(8)
    s_barrier
    v_mfma_f32_32x32x16_bf16 v[40:55], a[132:135], v[76:79], v[40:55]
    ds_read_b64_tr_b16 v[72:73], v2 offset:0
    ds_read_b64_tr_b16 v[74:75], v3 offset:0
    v_rcp_f32 v121, v121
    v_mul_f32 v116, v116, v30
    v_mul_f32 v117, v117, v31
    v_exp_f32 v116, v116
    v_mul_f32 v120, v120, v28
    v_mfma_f32_32x32x16_bf16 v[40:55], a[136:139], v[80:83], v[40:55]
    ds_read_b64_tr_b16 v[76:77], v2 offset:1024
    ds_read_b64_tr_b16 v[78:79], v3 offset:1024
    s_add_u32 s69, s87, 28672
    buffer_load_dwordx4 a[216:219], v4, s[32:35], s69 offen offset:0 sc1
    v_mul_f32 v121, v121, v29
    v_exp_f32 v117, v117
    v_cvt_pk_bf16_f32 v26, v120, v121
    v_mfma_f32_32x32x16_bf16 v[40:55], a[140:143], v[84:87], v[40:55]
    ds_read_b64_tr_b16 v[80:81], v2 offset:2048
    ds_read_b64_tr_b16 v[82:83], v3 offset:2048
    buffer_load_dwordx4 a[220:223], v4, s[32:35], s69 offen offset:1024 sc1
    v_mul_f32 v118, v32, v32
    v_fma_f32 v116, v116, v108, v108
    v_mul_f32 v119, v33, v33
    s_waitcnt lgkmcnt(6)
    v_mfma_f32_32x32x16_bf16 v[40:55], a[144:147], v[88:91], v[40:55]
    ds_read_b64_tr_b16 v[84:85], v2 offset:3072
    ds_read_b64_tr_b16 v[86:87], v3 offset:3072
    v_fma_f32 v117, v117, v108, v108
    v_rcp_f32 v116, v116
    v_fma_f32 v118, v118, v110, v109
    v_fma_f32 v119, v119, v110, v109
    v_mfma_f32_32x32x16_bf16 v[40:55], a[148:151], v[92:95], v[40:55]
    ds_read_b64_tr_b16 v[88:89], v2 offset:4096
    ds_read_b64_tr_b16 v[90:91], v3 offset:4096
    buffer_load_dwordx4 a[224:227], v4, s[32:35], s69 offen offset:2048 sc1
    v_rcp_f32 v117, v117
    v_mul_f32 v118, v118, v32
    v_mul_f32 v119, v119, v33
    v_exp_f32 v118, v118
    v_mfma_f32_32x32x16_bf16 v[40:55], a[152:155], v[96:99], v[40:55]
    ds_read_b64_tr_b16 v[92:93], v2 offset:5120
    ds_read_b64_tr_b16 v[94:95], v3 offset:5120
    v_mul_f32 v116, v116, v30
    v_mul_f32 v117, v117, v31
    v_exp_f32 v119, v119
    v_cvt_pk_bf16_f32 v27, v116, v117
    v_mfma_f32_32x32x16_bf16 v[40:55], a[156:159], v[100:103], v[40:55]
    ds_read_b64_tr_b16 v[96:97], v2 offset:6144
    ds_read_b64_tr_b16 v[98:99], v3 offset:6144
    buffer_load_dwordx4 v[160:163], v4, s[32:35], s69 offen offset:3072 sc1
    s_add_u32 s65, s90, 0
    buffer_store_dwordx4 v[24:27], v5, s[32:35], s65 offen offset:0 sc1
    v_mul_f32 v120, v34, v34
    v_fma_f32 v118, v118, v108, v108
    s_waitcnt lgkmcnt(6)
    v_mfma_f32_32x32x16_bf16 v[56:71], a[0:3], v[72:75], 0
    ds_read_b64_tr_b16 v[100:101], v2 offset:7168
    ds_read_b64_tr_b16 v[102:103], v3 offset:7168
    s_add_u32 m0, s10, 117760
    s_add_u32 s66, s11, 122880
    buffer_load_dwordx4 v4, s[32:35], s66 offen offset:0 sc1 lds
    ds_read_b64_tr_b16 v[124:125], v7 offset:0
    ds_read_b64_tr_b16 v[126:127], v7 offset:2048
    v_mul_f32 v121, v35, v35
    v_mfma_f32_32x32x16_bf16 v[56:71], a[4:7], v[76:79], v[56:71]
    ds_read_b64_tr_b16 v[72:73], v2 offset:8192
    ds_read_b64_tr_b16 v[74:75], v3 offset:8192
    buffer_load_dwordx4 v4, s[32:35], s66 offen offset:1024 sc1 lds
    v_fma_f32 v119, v119, v108, v108
    v_rcp_f32 v118, v118
    v_fma_f32 v120, v120, v110, v109
    v_fma_f32 v121, v121, v110, v109
    v_mfma_f32_32x32x16_bf16 v[56:71], a[8:11], v[80:83], v[56:71]
    ds_read_b64_tr_b16 v[76:77], v2 offset:9216
    ds_read_b64_tr_b16 v[78:79], v3 offset:9216
    buffer_load_dwordx4 v4, s[32:35], s66 offen offset:2048 sc1 lds
    v_rcp_f32 v119, v119
    v_mul_f32 v120, v120, v34
    v_mul_f32 v121, v121, v35
    v_mfma_f32_32x32x16_bf16 v[56:71], a[12:15], v[84:87], v[56:71]
    ds_read_b64_tr_b16 v[80:81], v2 offset:10240
    ds_read_b64_tr_b16 v[82:83], v3 offset:10240
    buffer_load_dwordx4 v4, s[32:35], s66 offen offset:3072 sc1 lds
    v_exp_f32 v120, v120
    v_mul_f32 v118, v118, v32
    v_mul_f32 v119, v119, v33
    s_waitcnt lgkmcnt(8)
    v_mfma_f32_32x32x16_bf16 v[56:71], a[16:19], v[88:91], v[56:71]
    ds_read_b64_tr_b16 v[84:85], v2 offset:11264
    ds_read_b64_tr_b16 v[86:87], v3 offset:11264
    s_add_u32 m0, s10, 121856
    s_add_u32 s66, s11, 126976
    buffer_load_dwordx4 v4, s[32:35], s66 offen offset:0 sc1 lds
    s_waitcnt lgkmcnt(4)
    ds_write_b64 v8, v[124:125] offset:5120
    ds_write_b64 v8, v[126:127] offset:5184
    v_add_u32 v7, 76800, v7
    v_mfma_f32_32x32x16_bf16 v[56:71], a[20:23], v[92:95], v[56:71]
    ds_read_b64_tr_b16 v[88:89], v2 offset:12288
    ds_read_b64_tr_b16 v[90:91], v3 offset:12288
    buffer_load_dwordx4 v4, s[32:35], s66 offen offset:1024 sc1 lds
    v_exp_f32 v121, v121
    v_cvt_pk_bf16_f32 v32, v118, v119
    v_mul_f32 v116, v36, v36
    v_fma_f32 v120, v120, v108, v108
    v_mul_f32 v117, v37, v37
    v_mfma_f32_32x32x16_bf16 v[56:71], a[24:27], v[96:99], v[56:71]
    ds_read_b64_tr_b16 v[92:93], v2 offset:13312
    ds_read_b64_tr_b16 v[94:95], v3 offset:13312
    v_fma_f32 v121, v121, v108, v108
    v_rcp_f32 v120, v120
    v_fma_f32 v116, v116, v110, v109
    v_fma_f32 v117, v117, v110, v109
    v_mfma_f32_32x32x16_bf16 v[56:71], a[28:31], v[100:103], v[56:71]
    ds_read_b64_tr_b16 v[96:97], v2 offset:14336
    ds_read_b64_tr_b16 v[98:99], v3 offset:14336
    buffer_load_dwordx4 v4, s[32:35], s66 offen offset:2048 sc1 lds
    v_rcp_f32 v121, v121
    v_mul_f32 v116, v116, v36
    v_mul_f32 v117, v117, v37
    s_waitcnt lgkmcnt(8)
    v_mfma_f32_32x32x16_bf16 v[56:71], a[32:35], v[72:75], v[56:71]
    ds_read_b64_tr_b16 v[100:101], v2 offset:15360
    ds_read_b64_tr_b16 v[102:103], v3 offset:15360
    buffer_load_dwordx4 v4, s[32:35], s66 offen offset:3072 sc1 lds
    v_exp_f32 v116, v116
    v_mul_f32 v120, v120, v34
    v_mul_f32 v121, v121, v35
    v_mfma_f32_32x32x16_bf16 v[56:71], a[36:39], v[76:79], v[56:71]
    ds_read_b64_tr_b16 v[72:73], v2 offset:16384
    ds_read_b64_tr_b16 v[74:75], v3 offset:16384
    s_add_u32 m0, s10, 125952
    s_add_u32 s66, s11, 131072
    buffer_load_dwordx4 v4, s[32:35], s66 offen offset:0 sc1 lds
    v_exp_f32 v117, v117
    v_cvt_pk_bf16_f32 v33, v120, v121
    v_mul_f32 v118, v38, v38
    v_mfma_f32_32x32x16_bf16 v[56:71], a[40:43], v[80:83], v[56:71]
    ds_read_b64_tr_b16 v[76:77], v2 offset:17408
    ds_read_b64_tr_b16 v[78:79], v3 offset:17408
    buffer_load_dwordx4 v4, s[32:35], s66 offen offset:1024 sc1 lds
    v_fma_f32 v116, v116, v108, v108
    v_mul_f32 v119, v39, v39
    v_fma_f32 v117, v117, v108, v108
    v_rcp_f32 v116, v116
    v_mfma_f32_32x32x16_bf16 v[56:71], a[44:47], v[84:87], v[56:71]
    ds_read_b64_tr_b16 v[80:81], v2 offset:18432
    ds_read_b64_tr_b16 v[82:83], v3 offset:18432
    buffer_load_dwordx4 v4, s[32:35], s66 offen offset:2048 sc1 lds
    v_fma_f32 v118, v118, v110, v109
    v_fma_f32 v119, v119, v110, v109
    s_waitcnt lgkmcnt(6)
    v_mfma_f32_32x32x16_bf16 v[56:71], a[48:51], v[88:91], v[56:71]
    ds_read_b64_tr_b16 v[84:85], v2 offset:19456
    ds_read_b64_tr_b16 v[86:87], v3 offset:19456
    buffer_load_dwordx4 v4, s[32:35], s66 offen offset:3072 sc1 lds
    v_rcp_f32 v117, v117
    v_mul_f32 v118, v118, v38
    v_mul_f32 v119, v119, v39
    v_exp_f32 v118, v118
    v_mfma_f32_32x32x16_bf16 v[56:71], a[52:55], v[92:95], v[56:71]
    ds_read_b64_tr_b16 v[88:89], v2 offset:20480
    ds_read_b64_tr_b16 v[90:91], v3 offset:20480
    s_add_u32 m0, s10, 130048
    s_add_u32 s66, s11, 135168
    buffer_load_dwordx4 v4, s[32:35], s66 offen offset:0 sc1 lds
    v_mul_f32 v116, v116, v36
    v_mul_f32 v117, v117, v37
    s_barrier
    v_mfma_f32_32x32x16_bf16 v[56:71], a[56:59], v[96:99], v[56:71]
    ds_read_b64_tr_b16 v[92:93], v2 offset:21504
    ds_read_b64_tr_b16 v[94:95], v3 offset:21504
    buffer_load_dwordx4 v4, s[32:35], s66 offen offset:1024 sc1 lds
    ds_read_b64 v[104:105], v6 offset:1040
    ds_read_b128 v[112:115], v6 offset:1024
    v_exp_f32 v119, v119
    v_cvt_pk_bf16_f32 v34, v116, v117
    v_mfma_f32_32x32x16_bf16 v[56:71], a[60:63], v[100:103], v[56:71]
    ds_read_b64_tr_b16 v[96:97], v2 offset:22528
    ds_read_b64_tr_b16 v[98:99], v3 offset:22528
    s_add_u32 s69, s87, 32768
    buffer_load_dwordx4 v[164:167], v4, s[32:35], s69 offen offset:0 sc1
    v_fma_f32 v118, v118, v108, v108
    v_fma_f32 v119, v119, v108, v108
    s_waitcnt lgkmcnt(8)
    v_mfma_f32_32x32x16_bf16 v[56:71], a[64:67], v[72:75], v[56:71]
    ds_read_b64_tr_b16 v[100:101], v2 offset:23552
    ds_read_b64_tr_b16 v[102:103], v3 offset:23552
    v_rcp_f32 v118, v118
    v_rcp_f32 v119, v119
    v_mul_f32 v118, v118, v38
    v_mul_f32 v119, v119, v39
    v_mfma_f32_32x32x16_bf16 v[56:71], a[68:71], v[76:79], v[56:71]
    ds_read_b64_tr_b16 v[72:73], v2 offset:24576
    ds_read_b64_tr_b16 v[74:75], v3 offset:24576
    buffer_load_dwordx4 v[168:171], v4, s[32:35], s69 offen offset:1024 sc1
    s_waitcnt lgkmcnt(4)
    v_mfma_f32_32x32x16_bf16 v[40:55], a[160:163], v[104:107], v[40:55]
    v_cvt_pk_bf16_f32 v35, v118, v119
    s_add_u32 s65, s90, 0
    buffer_store_dwordx4 v[32:35], v5, s[32:35], s65 offen offset:512 sc1
    v_mfma_f32_32x32x16_bf16 v[56:71], a[72:75], v[80:83], v[56:71]
    ds_read_b64_tr_b16 v[76:77], v2 offset:25600
    ds_read_b64_tr_b16 v[78:79], v3 offset:25600
    buffer_load_dwordx4 v[172:175], v4, s[32:35], s69 offen offset:2048 sc1
    v_mfma_f32_32x32x16_bf16 v[56:71], a[76:79], v[84:87], v[56:71]
    ds_read_b64_tr_b16 v[80:81], v2 offset:26624
    ds_read_b64_tr_b16 v[82:83], v3 offset:26624
    s_waitcnt lgkmcnt(6)
    v_mfma_f32_32x32x16_bf16 v[56:71], a[80:83], v[88:91], v[56:71]
    ds_read_b64_tr_b16 v[84:85], v2 offset:27648
    ds_read_b64_tr_b16 v[86:87], v3 offset:27648
    buffer_load_dwordx4 v[176:179], v4, s[32:35], s69 offen offset:3072 sc1
    v_mul_f32 v116, v40, v40
    v_mul_f32 v117, v41, v41
    v_fma_f32 v116, v116, v114, v113
    v_fma_f32 v117, v117, v114, v113
    v_mul_f32 v116, v116, v40
    v_mul_f32 v117, v117, v41
    v_mfma_f32_32x32x16_bf16 v[56:71], a[84:87], v[92:95], v[56:71]
    ds_read_b64_tr_b16 v[88:89], v2 offset:28672
    ds_read_b64_tr_b16 v[90:91], v3 offset:28672
    s_add_u32 s69, s87, 36864
    buffer_load_dwordx4 v[180:183], v4, s[32:35], s69 offen offset:0 sc1
    v_exp_f32 v116, v116
    v_mfma_f32_32x32x16_bf16 v[56:71], a[88:91], v[96:99], v[56:71]
    ds_read_b64_tr_b16 v[92:93], v2 offset:29696
    ds_read_b64_tr_b16 v[94:95], v3 offset:29696
    v_exp_f32 v117, v117
    v_mul_f32 v118, v42, v42
    v_fma_f32 v116, v116, v112, v112
    v_mul_f32 v119, v43, v43
    v_fma_f32 v117, v117, v112, v112
    v_mfma_f32_32x32x16_bf16 v[56:71], a[92:95], v[100:103], v[56:71]
    ds_read_b64_tr_b16 v[96:97], v2 offset:30720
    ds_read_b64_tr_b16 v[98:99], v3 offset:30720
    buffer_load_dwordx4 v[184:187], v4, s[32:35], s69 offen offset:1024 sc1
    v_rcp_f32 v116, v116
    v_fma_f32 v118, v118, v114, v113
    v_fma_f32 v119, v119, v114, v113
    s_waitcnt lgkmcnt(6)
    v_mfma_f32_32x32x16_bf16 v[56:71], a[96:99], v[72:75], v[56:71]
    ds_read_b64_tr_b16 v[100:101], v2 offset:31744
    ds_read_b64_tr_b16 v[102:103], v3 offset:31744
    buffer_load_dwordx4 v[188:191], v4, s[32:35], s69 offen offset:2048 sc1
    v_rcp_f32 v117, v117
    v_mul_f32 v118, v118, v42
    v_mul_f32 v119, v119, v43
    v_mfma_f32_32x32x16_bf16 v[56:71], a[100:103], v[76:79], v[56:71]
    ds_read_b64_tr_b16 v[72:73], v2 offset:32768
    ds_read_b64_tr_b16 v[74:75], v3 offset:32768
    v_exp_f32 v118, v118
    v_mul_f32 v116, v116, v40
    v_mul_f32 v117, v117, v41
    v_exp_f32 v119, v119
    v_mfma_f32_32x32x16_bf16 v[56:71], a[104:107], v[80:83], v[56:71]
    ds_read_b64_tr_b16 v[76:77], v2 offset:33792
    ds_read_b64_tr_b16 v[78:79], v3 offset:33792
    buffer_load_dwordx4 v[192:195], v4, s[32:35], s69 offen offset:3072 sc1
    v_cvt_pk_bf16_f32 v40, v116, v117
    v_mul_f32 v120, v44, v44
    v_fma_f32 v118, v118, v112, v112
    v_mul_f32 v121, v45, v45
    v_fma_f32 v119, v119, v112, v112
    v_mfma_f32_32x32x16_bf16 v[56:71], a[108:111], v[84:87], v[56:71]
    ds_read_b64_tr_b16 v[80:81], v2 offset:34816
    ds_read_b64_tr_b16 v[82:83], v3 offset:34816
    s_add_u32 s69, s87, 40960
    buffer_load_dwordx4 v[196:199], v4, s[32:35], s69 offen offset:0 sc1
    v_rcp_f32 v118, v118
    s_waitcnt lgkmcnt(6)
    v_mfma_f32_32x32x16_bf16 v[56:71], a[112:115], v[88:91], v[56:71]
    ds_read_b64_tr_b16 v[84:85], v2 offset:35840
    ds_read_b64_tr_b16 v[86:87], v3 offset:35840
    v_fma_f32 v120, v120, v114, v113
    v_fma_f32 v121, v121, v114, v113
    v_rcp_f32 v119, v119
    v_mul_f32 v120, v120, v44
    v_mul_f32 v121, v121, v45
    v_mfma_f32_32x32x16_bf16 v[56:71], a[116:119], v[92:95], v[56:71]
    ds_read_b64_tr_b16 v[88:89], v2 offset:36864
    ds_read_b64_tr_b16 v[90:91], v3 offset:36864
    buffer_load_dwordx4 v[200:203], v4, s[32:35], s69 offen offset:1024 sc1
    v_exp_f32 v120, v120
    v_mul_f32 v118, v118, v42
    v_mul_f32 v119, v119, v43
    v_mfma_f32_32x32x16_bf16 v[56:71], a[120:123], v[96:99], v[56:71]
    ds_read_b64_tr_b16 v[92:93], v2 offset:37888
    ds_read_b64_tr_b16 v[94:95], v3 offset:37888
    v_exp_f32 v121, v121
    v_cvt_pk_bf16_f32 v41, v118, v119
    v_mul_f32 v116, v46, v46
    v_fma_f32 v120, v120, v112, v112
    v_mul_f32 v117, v47, v47
    v_mfma_f32_32x32x16_bf16 v[56:71], a[124:127], v[100:103], v[56:71]
    ds_read_b64_tr_b16 v[96:97], v2 offset:38912
    ds_read_b64_tr_b16 v[98:99], v3 offset:38912
    buffer_load_dwordx4 v[204:207], v4, s[32:35], s69 offen offset:2048 sc1
    v_fma_f32 v121, v121, v112, v112
    v_rcp_f32 v120, v120
    s_waitcnt lgkmcnt(6)
    v_mfma_f32_32x32x16_bf16 v[56:71], a[128:131], v[72:75], v[56:71]
    ds_read_b64_tr_b16 v[100:101], v2 offset:39936
    ds_read_b64_tr_b16 v[102:103], v3 offset:39936
    buffer_load_dwordx4 v[208:211], v4, s[32:35], s69 offen offset:3072 sc1
    v_fma_f32 v116, v116, v114, v113
    v_add_u32 v2, 76800, v2
    v_add_u32 v3, 76800, v3
    s_waitcnt vmcnt(13)
    s_barrier
    v_mfma_f32_32x32x16_bf16 v[56:71], a[132:135], v[76:79], v[56:71]
    ds_read_b64_tr_b16 v[72:73], v2 offset:0
    ds_read_b64_tr_b16 v[74:75], v3 offset:0
    v_fma_f32 v117, v117, v114, v113
    v_rcp_f32 v121, v121
    v_mul_f32 v116, v116, v46
    v_mul_f32 v117, v117, v47
    v_mfma_f32_32x32x16_bf16 v[56:71], a[136:139], v[80:83], v[56:71]
    ds_read_b64_tr_b16 v[76:77], v2 offset:1024
    ds_read_b64_tr_b16 v[78:79], v3 offset:1024
    s_add_u32 s69, s87, 45056
    buffer_load_dwordx4 v[212:215], v4, s[32:35], s69 offen offset:0 sc1
    v_exp_f32 v116, v116
    v_mul_f32 v120, v120, v44
    v_mul_f32 v121, v121, v45
    v_mfma_f32_32x32x16_bf16 v[56:71], a[140:143], v[84:87], v[56:71]
    ds_read_b64_tr_b16 v[80:81], v2 offset:2048
    ds_read_b64_tr_b16 v[82:83], v3 offset:2048
    buffer_load_dwordx4 v[216:219], v4, s[32:35], s69 offen offset:1024 sc1
    v_exp_f32 v117, v117
    v_cvt_pk_bf16_f32 v42, v120, v121
    v_mul_f32 v118, v48, v48
    s_waitcnt lgkmcnt(6)
    v_mfma_f32_32x32x16_bf16 v[56:71], a[144:147], v[88:91], v[56:71]
    ds_read_b64_tr_b16 v[84:85], v2 offset:3072
    ds_read_b64_tr_b16 v[86:87], v3 offset:3072
    v_fma_f32 v116, v116, v112, v112
    v_mul_f32 v119, v49, v49
    v_fma_f32 v117, v117, v112, v112
    v_rcp_f32 v116, v116
    v_mfma_f32_32x32x16_bf16 v[56:71], a[148:151], v[92:95], v[56:71]
    ds_read_b64_tr_b16 v[88:89], v2 offset:4096
    ds_read_b64_tr_b16 v[90:91], v3 offset:4096
    buffer_load_dwordx4 v[220:223], v4, s[32:35], s69 offen offset:2048 sc1
    v_fma_f32 v118, v118, v114, v113
    v_fma_f32 v119, v119, v114, v113
    v_rcp_f32 v117, v117
    v_mul_f32 v118, v118, v48
    v_mfma_f32_32x32x16_bf16 v[56:71], a[152:155], v[96:99], v[56:71]
    ds_read_b64_tr_b16 v[92:93], v2 offset:5120
    ds_read_b64_tr_b16 v[94:95], v3 offset:5120
    buffer_load_dwordx4 v[224:227], v4, s[32:35], s69 offen offset:3072 sc1
    v_mul_f32 v119, v119, v49
    v_exp_f32 v118, v118
    v_mul_f32 v116, v116, v46
    v_mfma_f32_32x32x16_bf16 v[56:71], a[156:159], v[100:103], v[56:71]
    ds_read_b64_tr_b16 v[96:97], v2 offset:6144
    ds_read_b64_tr_b16 v[98:99], v3 offset:6144
    v_mul_f32 v117, v117, v47
    v_exp_f32 v119, v119
    v_cvt_pk_bf16_f32 v43, v116, v117
    s_waitcnt lgkmcnt(6)
    v_mfma_f32_32x32x16_bf16 v[24:39], a[0:3], v[72:75], 0
    ds_read_b64_tr_b16 v[100:101], v2 offset:7168
    ds_read_b64_tr_b16 v[102:103], v3 offset:7168
    s_add_u32 s69, s87, 49152
    buffer_load_dwordx4 v[228:231], v4, s[32:35], s69 offen offset:0 sc1
    ds_read_b64_tr_b16 v[124:125], v7 offset:0
    ds_read_b64_tr_b16 v[126:127], v7 offset:2048
    s_add_u32 s65, s90, 114688
    buffer_store_dwordx4 v[40:43], v5, s[32:35], s65 offen offset:0 sc1
    v_mfma_f32_32x32x16_bf16 v[24:39], a[4:7], v[76:79], v[24:39]
    ds_read_b64_tr_b16 v[72:73], v2 offset:8192
    ds_read_b64_tr_b16 v[74:75], v3 offset:8192
    buffer_load_dwordx4 v[232:235], v4, s[32:35], s69 offen offset:1024 sc1
    v_mul_f32 v120, v50, v50
    v_fma_f32 v118, v118, v112, v112
    v_mul_f32 v121, v51, v51
    v_fma_f32 v119, v119, v112, v112
    v_mfma_f32_32x32x16_bf16 v[24:39], a[8:11], v[80:83], v[24:39]
    ds_read_b64_tr_b16 v[76:77], v2 offset:9216
    ds_read_b64_tr_b16 v[78:79], v3 offset:9216
    v_rcp_f32 v118, v118
    v_fma_f32 v120, v120, v114, v113
    v_fma_f32 v121, v121, v114, v113
    v_rcp_f32 v119, v119
    v_mul_f32 v120, v120, v50
    v_mfma_f32_32x32x16_bf16 v[24:39], a[12:15], v[84:87], v[24:39]
    ds_read_b64_tr_b16 v[80:81], v2 offset:10240
    ds_read_b64_tr_b16 v[82:83], v3 offset:10240
    buffer_load_dwordx4 v[236:239], v4, s[32:35], s69 offen offset:2048 sc1
    v_mul_f32 v121, v121, v51
    v_exp_f32 v120, v120
    s_waitcnt lgkmcnt(8)
    v_mfma_f32_32x32x16_bf16 v[24:39], a[16:19], v[88:91], v[24:39]
    ds_read_b64_tr_b16 v[84:85], v2 offset:11264
    ds_read_b64_tr_b16 v[86:87], v3 offset:11264
    s_waitcnt lgkmcnt(4)
    ds_write_b64 v8, v[124:125] offset:7680
    ds_write_b64 v8, v[126:127] offset:7744
    v_mul_f32 v118, v118, v48
    v_mul_f32 v119, v119, v49
    v_exp_f32 v121, v121
    v_mfma_f32_32x32x16_bf16 v[24:39], a[20:23], v[92:95], v[24:39]
    ds_read_b64_tr_b16 v[88:89], v2 offset:12288
    ds_read_b64_tr_b16 v[90:91], v3 offset:12288
    buffer_load_dwordx4 v[240:243], v4, s[32:35], s69 offen offset:3072 sc1
    v_cvt_pk_bf16_f32 v48, v118, v119
    v_mul_f32 v116, v52, v52
    v_fma_f32 v120, v120, v112, v112
    v_mul_f32 v117, v53, v53
    v_mfma_f32_32x32x16_bf16 v[24:39], a[24:27], v[96:99], v[24:39]
    ds_read_b64_tr_b16 v[92:93], v2 offset:13312
    ds_read_b64_tr_b16 v[94:95], v3 offset:13312
    s_add_u32 s69, s87, 53248
    buffer_load_dwordx4 v[244:247], v4, s[32:35], s69 offen offset:0 sc1
    v_fma_f32 v121, v121, v112, v112
    v_rcp_f32 v120, v120
    v_fma_f32 v116, v116, v114, v113
    v_mfma_f32_32x32x16_bf16 v[24:39], a[28:31], v[100:103], v[24:39]
    ds_read_b64_tr_b16 v[96:97], v2 offset:14336
    ds_read_b64_tr_b16 v[98:99], v3 offset:14336
    v_fma_f32 v117, v117, v114, v113
    v_rcp_f32 v121, v121
    v_mul_f32 v116, v116, v52
    s_waitcnt lgkmcnt(8)
    v_mfma_f32_32x32x16_bf16 v[24:39], a[32:35], v[72:75], v[24:39]
    ds_read_b64_tr_b16 v[100:101], v2 offset:15360
    ds_read_b64_tr_b16 v[102:103], v3 offset:15360
    buffer_load_dwordx4 v[248:251], v4, s[32:35], s69 offen offset:1024 sc1
    v_mul_f32 v117, v117, v53
    v_exp_f32 v116, v116
    v_mul_f32 v120, v120, v50
    v_mul_f32 v121, v121, v51
    v_mfma_f32_32x32x16_bf16 v[24:39], a[36:39], v[76:79], v[24:39]
    ds_read_b64_tr_b16 v[72:73], v2 offset:16384
    ds_read_b64_tr_b16 v[74:75], v3 offset:16384
    buffer_load_dwordx4 v[252:255], v4, s[32:35], s69 offen offset:2048 sc1
    v_exp_f32 v117, v117
    v_cvt_pk_bf16_f32 v49, v120, v121
    v_mul_f32 v118, v54, v54
    v_fma_f32 v116, v116, v112, v112
    v_mfma_f32_32x32x16_bf16 v[24:39], a[40:43], v[80:83], v[24:39]
    ds_read_b64_tr_b16 v[76:77], v2 offset:17408
    ds_read_b64_tr_b16 v[78:79], v3 offset:17408
    v_mul_f32 v119, v55, v55
    v_fma_f32 v117, v117, v112, v112
    v_rcp_f32 v116, v116
    v_fma_f32 v118, v118, v114, v113
    v_mfma_f32_32x32x16_bf16 v[24:39], a[44:47], v[84:87], v[24:39]
    ds_read_b64_tr_b16 v[80:81], v2 offset:18432
    ds_read_b64_tr_b16 v[82:83], v3 offset:18432
    buffer_load_dwordx4 a[0:3], v4, s[32:35], s69 offen offset:3072 sc1
    v_fma_f32 v119, v119, v114, v113
    v_rcp_f32 v117, v117
    v_mul_f32 v118, v118, v54
    s_waitcnt lgkmcnt(6)
    v_mfma_f32_32x32x16_bf16 v[24:39], a[48:51], v[88:91], v[24:39]
    ds_read_b64_tr_b16 v[84:85], v2 offset:19456
    ds_read_b64_tr_b16 v[86:87], v3 offset:19456
    s_add_u32 s69, s87, 57344
    buffer_load_dwordx4 a[4:7], v4, s[32:35], s69 offen offset:0 sc1
    v_mul_f32 v119, v119, v55
    v_exp_f32 v118, v118
    v_mfma_f32_32x32x16_bf16 v[24:39], a[52:55], v[92:95], v[24:39]
    ds_read_b64_tr_b16 v[88:89], v2 offset:20480
    ds_read_b64_tr_b16 v[90:91], v3 offset:20480
    v_mul_f32 v116, v116, v52
    s_waitcnt vmcnt(24)
    s_barrier
    s_cmp_lg_u32 s56, 0
    s_cbranch_scc1 L_nosig11
    s_atomic_add s19, s[32:33], s88 offset:0
L_nosig11:
    v_mfma_f32_32x32x16_bf16 v[24:39], a[56:59], v[96:99], v[24:39]
    ds_read_b64_tr_b16 v[92:93], v2 offset:21504
    ds_read_b64_tr_b16 v[94:95], v3 offset:21504
    buffer_load_dwordx4 a[8:11], v4, s[32:35], s69 offen offset:1024 sc1
    ds_read_b64 v[104:105], v6 offset:16
    ds_read_b128 v[108:111], v6 offset:0
    v_mul_f32 v117, v117, v53
    v_mfma_f32_32x32x16_bf16 v[24:39], a[60:63], v[100:103], v[24:39]
    ds_read_b64_tr_b16 v[96:97], v2 offset:22528
    ds_read_b64_tr_b16 v[98:99], v3 offset:22528
    buffer_load_dwordx4 a[12:15], v4, s[32:35], s69 offen offset:2048 sc1
    v_exp_f32 v119, v119
    v_cvt_pk_bf16_f32 v50, v116, v117
    v_fma_f32 v118, v118, v112, v112
    v_fma_f32 v119, v119, v112, v112
    s_waitcnt lgkmcnt(8)
    v_mfma_f32_32x32x16_bf16 v[24:39], a[64:67], v[72:75], v[24:39]
    ds_read_b64_tr_b16 v[100:101], v2 offset:23552
    ds_read_b64_tr_b16 v[102:103], v3 offset:23552
    v_rcp_f32 v118, v118
    v_rcp_f32 v119, v119
    v_mul_f32 v118, v118, v54
    v_mul_f32 v119, v119, v55
    v_mfma_f32_32x32x16_bf16 v[24:39], a[68:71], v[76:79], v[24:39]
    ds_read_b64_tr_b16 v[72:73], v2 offset:24576
    ds_read_b64_tr_b16 v[74:75], v3 offset:24576
    buffer_load_dwordx4 a[16:19], v4, s[32:35], s69 offen offset:3072 sc1
    s_waitcnt lgkmcnt(4)
    v_mfma_f32_32x32x16_bf16 v[56:71], a[160:163], v[104:107], v[56:71]
    v_cvt_pk_bf16_f32 v51, v118, v119
    s_add_u32 s65, s90, 114688
    buffer_store_dwordx4 v[48:51], v5, s[32:35], s65 offen offset:512 sc1
    v_mfma_f32_32x32x16_bf16 v[24:39], a[72:75], v[80:83], v[24:39]
    ds_read_b64_tr_b16 v[76:77], v2 offset:25600
    ds_read_b64_tr_b16 v[78:79], v3 offset:25600
    s_add_u32 s69, s87, 61440
    buffer_load_dwordx4 a[20:23], v4, s[32:35], s69 offen offset:0 sc1
    v_mfma_f32_32x32x16_bf16 v[24:39], a[76:79], v[84:87], v[24:39]
    ds_read_b64_tr_b16 v[80:81], v2 offset:26624
    ds_read_b64_tr_b16 v[82:83], v3 offset:26624
    s_waitcnt lgkmcnt(6)
    v_mfma_f32_32x32x16_bf16 v[24:39], a[80:83], v[88:91], v[24:39]
    ds_read_b64_tr_b16 v[84:85], v2 offset:27648
    ds_read_b64_tr_b16 v[86:87], v3 offset:27648
    buffer_load_dwordx4 a[24:27], v4, s[32:35], s69 offen offset:1024 sc1
    v_mul_f32 v116, v56, v56
    v_mul_f32 v117, v57, v57
    v_fma_f32 v116, v116, v110, v109
    v_fma_f32 v117, v117, v110, v109
    v_mul_f32 v116, v116, v56
    v_mul_f32 v117, v117, v57
    v_mfma_f32_32x32x16_bf16 v[24:39], a[84:87], v[92:95], v[24:39]
    ds_read_b64_tr_b16 v[88:89], v2 offset:28672
    ds_read_b64_tr_b16 v[90:91], v3 offset:28672
    v_exp_f32 v116, v116
    v_exp_f32 v117, v117
    v_mul_f32 v118, v58, v58
    v_fma_f32 v116, v116, v108, v108
    v_mfma_f32_32x32x16_bf16 v[24:39], a[88:91], v[96:99], v[24:39]
    ds_read_b64_tr_b16 v[92:93], v2 offset:29696
    ds_read_b64_tr_b16 v[94:95], v3 offset:29696
    buffer_load_dwordx4 a[28:31], v4, s[32:35], s69 offen offset:2048 sc1
    v_mul_f32 v119, v59, v59
    v_fma_f32 v117, v117, v108, v108
    v_rcp_f32 v116, v116
    v_fma_f32 v118, v118, v110, v109
    v_fma_f32 v119, v119, v110, v109
    v_mfma_f32_32x32x16_bf16 v[24:39], a[92:95], v[100:103], v[24:39]
    ds_read_b64_tr_b16 v[96:97], v2 offset:30720
    ds_read_b64_tr_b16 v[98:99], v3 offset:30720
    buffer_load_dwordx4 a[32:35], v4, s[32:35], s69 offen offset:3072 sc1
    v_rcp_f32 v117, v117
    v_mul_f32 v118, v118, v58
    v_mul_f32 v119, v119, v59
    s_waitcnt lgkmcnt(6)
    v_mfma_f32_32x32x16_bf16 v[24:39], a[96:99], v[72:75], v[24:39]
    ds_read_b64_tr_b16 v[100:101], v2 offset:31744
    ds_read_b64_tr_b16 v[102:103], v3 offset:31744
    v_exp_f32 v118, v118
    v_mul_f32 v116, v116, v56
    v_mul_f32 v117, v117, v57
    v_exp_f32 v119, v119
    v_mfma_f32_32x32x16_bf16 v[24:39], a[100:103], v[76:79], v[24:39]
    ds_read_b64_tr_b16 v[72:73], v2 offset:32768
    ds_read_b64_tr_b16 v[74:75], v3 offset:32768
    s_add_u32 s69, s87, 65536
    buffer_load_dwordx4 a[36:39], v4, s[32:35], s69 offen offset:0 sc1
    v_cvt_pk_bf16_f32 v56, v116, v117
    v_mul_f32 v120, v60, v60
    v_fma_f32 v118, v118, v108, v108
    v_mul_f32 v121, v61, v61
    v_mfma_f32_32x32x16_bf16 v[24:39], a[104:107], v[80:83], v[24:39]
    ds_read_b64_tr_b16 v[76:77], v2 offset:33792
    ds_read_b64_tr_b16 v[78:79], v3 offset:33792
    buffer_load_dwordx4 a[40:43], v4, s[32:35], s69 offen offset:1024 sc1
    v_fma_f32 v119, v119, v108, v108
    v_rcp_f32 v118, v118
    v_fma_f32 v120, v120, v110, v109
    v_fma_f32 v121, v121, v110, v109
    v_mfma_f32_32x32x16_bf16 v[24:39], a[108:111], v[84:87], v[24:39]
    ds_read_b64_tr_b16 v[80:81], v2 offset:34816
    ds_read_b64_tr_b16 v[82:83], v3 offset:34816
    v_rcp_f32 v119, v119
    v_mul_f32 v120, v120, v60
    v_mul_f32 v121, v121, v61
    s_waitcnt lgkmcnt(6)
    v_mfma_f32_32x32x16_bf16 v[24:39], a[112:115], v[88:91], v[24:39]
    ds_read_b64_tr_b16 v[84:85], v2 offset:35840
    ds_read_b64_tr_b16 v[86:87], v3 offset:35840
    buffer_load_dwordx4 a[44:47], v4, s[32:35], s69 offen offset:2048 sc1
    v_exp_f32 v120, v120
    v_mul_f32 v118, v118, v58
    v_mul_f32 v119, v119, v59
    v_exp_f32 v121, v121
    v_mfma_f32_32x32x16_bf16 v[24:39], a[116:119], v[92:95], v[24:39]
    ds_read_b64_tr_b16 v[88:89], v2 offset:36864
    ds_read_b64_tr_b16 v[90:91], v3 offset:36864
    buffer_load_dwordx4 a[48:51], v4, s[32:35], s69 offen offset:3072 sc1
    v_cvt_pk_bf16_f32 v57, v118, v119
    v_mul_f32 v116, v62, v62
    v_fma_f32 v120, v120, v108, v108
    v_mul_f32 v117, v63, v63
    v_fma_f32 v121, v121, v108, v108
    v_mfma_f32_32x32x16_bf16 v[24:39], a[120:123], v[96:99], v[24:39]
    ds_read_b64_tr_b16 v[92:93], v2 offset:37888
    ds_read_b64_tr_b16 v[94:95], v3 offset:37888
    v_rcp_f32 v120, v120
    v_fma_f32 v116, v116, v110, v109
    v_fma_f32 v117, v117, v110, v109
    v_rcp_f32 v121, v121
    v_mul_f32 v116, v116, v62
    v_mfma_f32_32x32x16_bf16 v[24:39], a[124:127], v[100:103], v[24:39]
    ds_read_b64_tr_b16 v[96:97], v2 offset:38912
    ds_read_b64_tr_b16 v[98:99], v3 offset:38912
    s_add_u32 s69, s87, 69632
    buffer_load_dwordx4 a[52:55], v4, s[32:35], s69 offen offset:0 sc1
    v_mul_f32 v117, v117, v63
    v_exp_f32 v116, v116
    s_waitcnt lgkmcnt(6)
    v_mfma_f32_32x32x16_bf16 v[24:39], a[128:131], v[72:75], v[24:39]
    ds_read_b64_tr_b16 v[100:101], v2 offset:39936
    ds_read_b64_tr_b16 v[102:103], v3 offset:39936
    ds_read_b32 v16, v9
    buffer_load_dwordx4 a[56:59], v4, s[32:35], s69 offen offset:1024 sc1
    v_mul_f32 v120, v120, v60
    v_mul_f32 v121, v121, v61
    v_exp_f32 v117, v117
    v_cvt_pk_bf16_f32 v58, v120, v121
    v_mfma_f32_32x32x16_bf16 v[24:39], a[132:135], v[76:79], v[24:39]
    v_mul_f32 v118, v64, v64
    v_fma_f32 v116, v116, v108, v108
    v_mul_f32 v119, v65, v65
    v_fma_f32 v117, v117, v108, v108
    v_rcp_f32 v116, v116
    v_fma_f32 v118, v118, v110, v109
    v_fma_f32 v119, v119, v110, v109
    v_mfma_f32_32x32x16_bf16 v[24:39], a[136:139], v[80:83], v[24:39]
    v_rcp_f32 v117, v117
    v_mul_f32 v118, v118, v64
    v_mul_f32 v119, v119, v65
    v_exp_f32 v118, v118
    v_mul_f32 v116, v116, v62
    v_mul_f32 v117, v117, v63
    v_mfma_f32_32x32x16_bf16 v[24:39], a[140:143], v[84:87], v[24:39]
    v_exp_f32 v119, v119
    v_cvt_pk_bf16_f32 v59, v116, v117
    s_waitcnt lgkmcnt(1)
    v_mfma_f32_32x32x16_bf16 v[24:39], a[144:147], v[88:91], v[24:39]
    s_add_u32 s65, s90, 229376
    buffer_store_dwordx4 v[56:59], v5, s[32:35], s65 offen offset:0 sc1
    v_mul_f32 v120, v66, v66
    v_fma_f32 v118, v118, v108, v108
    v_mul_f32 v121, v67, v67
    v_fma_f32 v119, v119, v108, v108
    v_rcp_f32 v118, v118
    v_fma_f32 v120, v120, v110, v109
    v_fma_f32 v121, v121, v110, v109
    v_mfma_f32_32x32x16_bf16 v[24:39], a[148:151], v[92:95], v[24:39]
    v_rcp_f32 v119, v119
    v_mul_f32 v120, v120, v66
    v_mul_f32 v121, v121, v67
    v_exp_f32 v120, v120
    v_mul_f32 v118, v118, v64
    v_mul_f32 v119, v119, v65
    v_mfma_f32_32x32x16_bf16 v[24:39], a[152:155], v[96:99], v[24:39]
    v_exp_f32 v121, v121
    v_cvt_pk_bf16_f32 v64, v118, v119
    v_mul_f32 v116, v68, v68
    v_fma_f32 v120, v120, v108, v108
    v_mul_f32 v117, v69, v69
    v_fma_f32 v121, v121, v108, v108
    v_rcp_f32 v120, v120
    v_fma_f32 v116, v116, v110, v109
    v_fma_f32 v117, v117, v110, v109
    v_mfma_f32_32x32x16_bf16 v[24:39], a[156:159], v[100:103], v[24:39]
    v_rcp_f32 v121, v121
    v_mul_f32 v116, v116, v68
    v_mul_f32 v117, v117, v69
    v_exp_f32 v116, v116
    v_mul_f32 v120, v120, v66
    v_mul_f32 v121, v121, v67
    s_waitcnt vmcnt(11)
    s_barrier
    s_mov_b64 s[16:17], 0
    s_load_dword s16, s[32:33], s89 offset:0
    s_cmp_lg_u32 s56, 0
    s_cbranch_scc1 L_nosig14
    s_atomic_add s19, s[32:33], s88 offset:512
L_nosig14:
    ds_read_b64 v[104:105], v6 offset:1040
    ds_read_b128 v[112:115], v6 offset:1024
    ds_read_b32 v16, v9
    ds_read_b32 v16, v9
    ds_read_b32 v16, v9
    v_exp_f32 v117, v117
    v_cvt_pk_bf16_f32 v65, v120, v121
    v_mul_f32 v118, v70, v70
    v_fma_f32 v116, v116, v108, v108
    v_mul_f32 v119, v71, v71
    v_fma_f32 v117, v117, v108, v108
    v_rcp_f32 v116, v116
    v_fma_f32 v118, v118, v110, v109
    v_fma_f32 v119, v119, v110, v109
    v_rcp_f32 v117, v117
    v_mul_f32 v118, v118, v70
    v_mul_f32 v119, v119, v71
    v_exp_f32 v118, v118
    s_waitcnt lgkmcnt(3)
    v_mfma_f32_32x32x16_bf16 v[24:39], a[160:163], v[104:107], v[24:39]
    v_mul_f32 v116, v116, v68
    v_mul_f32 v117, v117, v69
    v_exp_f32 v119, v119
    v_cvt_pk_bf16_f32 v66, v116, v117
    v_fma_f32 v118, v118, v108, v108
    v_fma_f32 v119, v119, v108, v108
    v_rcp_f32 v118, v118
    v_rcp_f32 v119, v119
    v_mul_f32 v118, v118, v70
    v_mul_f32 v119, v119, v71
    v_cvt_pk_bf16_f32 v67, v118, v119
    s_add_u32 s65, s90, 229376
    buffer_store_dwordx4 v[64:67], v5, s[32:35], s65 offen offset:512 sc1
    v_pk_mul_f32 v[116:117], v[24:25], v[24:25]
    v_pk_mul_f32 v[118:119], v[26:27], v[26:27]
    v_pk_mul_f32 v[120:121], v[28:29], v[28:29]
    v_pk_mul_f32 v[122:123], v[30:31], v[30:31]
    s_waitcnt lgkmcnt(3)
    v_pk_fma_f32 v[116:117], v[116:117], v[114:115], v[112:113] op_sel:[0,0,1] op_sel_hi:[1,0,1]
    v_pk_fma_f32 v[118:119], v[118:119], v[114:115], v[112:113] op_sel:[0,0,1] op_sel_hi:[1,0,1]
    v_pk_fma_f32 v[120:121], v[120:121], v[114:115], v[112:113] op_sel:[0,0,1] op_sel_hi:[1,0,1]
    v_pk_fma_f32 v[122:123], v[122:123], v[114:115], v[112:113] op_sel:[0,0,1] op_sel_hi:[1,0,1]
    v_pk_mul_f32 v[116:117], v[116:117], v[24:25]
    v_pk_mul_f32 v[118:119], v[118:119], v[26:27]
    v_pk_mul_f32 v[120:121], v[120:121], v[28:29]
    v_pk_mul_f32 v[122:123], v[122:123], v[30:31]
    v_exp_f32 v116, v116
    v_exp_f32 v117, v117
    v_exp_f32 v118, v118
    v_exp_f32 v119, v119
    v_exp_f32 v120, v120
    v_exp_f32 v121, v121
    v_exp_f32 v122, v122
    v_exp_f32 v123, v123
    v_pk_fma_f32 v[116:117], v[116:117], v[112:113], v[112:113] op_sel_hi:[1,0,0]
    v_pk_fma_f32 v[118:119], v[118:119], v[112:113], v[112:113] op_sel_hi:[1,0,0]
    v_pk_fma_f32 v[120:121], v[120:121], v[112:113], v[112:113] op_sel_hi:[1,0,0]
    v_pk_fma_f32 v[122:123], v[122:123], v[112:113], v[112:113] op_sel_hi:[1,0,0]
    v_rcp_f32 v116, v116
    v_rcp_f32 v117, v117
    v_rcp_f32 v118, v118
    v_rcp_f32 v119, v119
    v_rcp_f32 v120, v120
    v_rcp_f32 v121, v121
    v_rcp_f32 v122, v122
    v_rcp_f32 v123, v123
    v_pk_mul_f32 v[116:117], v[116:117], v[24:25]
    v_pk_mul_f32 v[118:119], v[118:119], v[26:27]
    v_pk_mul_f32 v[120:121], v[120:121], v[28:29]
    v_pk_mul_f32 v[122:123], v[122:123], v[30:31]
    v_cvt_pk_bf16_f32 v24, v116, v117
    v_cvt_pk_bf16_f32 v25, v118, v119
    v_cvt_pk_bf16_f32 v26, v120, v121
    v_cvt_pk_bf16_f32 v27, v122, v123
    s_add_u32 s65, s90, 344064
    buffer_store_dwordx4 v[24:27], v5, s[32:35], s65 offen offset:0 sc1
    v_pk_mul_f32 v[116:117], v[32:33], v[32:33]
    v_pk_mul_f32 v[118:119], v[34:35], v[34:35]
    v_pk_mul_f32 v[120:121], v[36:37], v[36:37]
    v_pk_mul_f32 v[122:123], v[38:39], v[38:39]
    v_pk_fma_f32 v[116:117], v[116:117], v[114:115], v[112:113] op_sel:[0,0,1] op_sel_hi:[1,0,1]
    v_pk_fma_f32 v[118:119], v[118:119], v[114:115], v[112:113] op_sel:[0,0,1] op_sel_hi:[1,0,1]
    v_pk_fma_f32 v[120:121], v[120:121], v[114:115], v[112:113] op_sel:[0,0,1] op_sel_hi:[1,0,1]
    v_pk_fma_f32 v[122:123], v[122:123], v[114:115], v[112:113] op_sel:[0,0,1] op_sel_hi:[1,0,1]
    v_pk_mul_f32 v[116:117], v[116:117], v[32:33]
    v_pk_mul_f32 v[118:119], v[118:119], v[34:35]
    v_pk_mul_f32 v[120:121], v[120:121], v[36:37]
    v_pk_mul_f32 v[122:123], v[122:123], v[38:39]
    v_exp_f32 v116, v116
    v_exp_f32 v117, v117
    v_exp_f32 v118, v118
    v_exp_f32 v119, v119
    v_exp_f32 v120, v120
    v_exp_f32 v121, v121
    v_exp_f32 v122, v122
    v_exp_f32 v123, v123
    v_pk_fma_f32 v[116:117], v[116:117], v[112:113], v[112:113] op_sel_hi:[1,0,0]
    v_pk_fma_f32 v[118:119], v[118:119], v[112:113], v[112:113] op_sel_hi:[1,0,0]
    v_pk_fma_f32 v[120:121], v[120:121], v[112:113], v[112:113] op_sel_hi:[1,0,0]
    v_pk_fma_f32 v[122:123], v[122:123], v[112:113], v[112:113] op_sel_hi:[1,0,0]
    v_rcp_f32 v116, v116
    v_rcp_f32 v117, v117
    v_rcp_f32 v118, v118
    v_rcp_f32 v119, v119
    v_rcp_f32 v120, v120
    v_rcp_f32 v121, v121
    v_rcp_f32 v122, v122
    v_rcp_f32 v123, v123
    v_pk_mul_f32 v[116:117], v[116:117], v[32:33]
    v_pk_mul_f32 v[118:119], v[118:119], v[34:35]
    v_pk_mul_f32 v[120:121], v[120:121], v[36:37]
    v_pk_mul_f32 v[122:123], v[122:123], v[38:39]
    v_cvt_pk_bf16_f32 v32, v116, v117
    v_cvt_pk_bf16_f32 v33, v118, v119
    v_cvt_pk_bf16_f32 v34, v120, v121
    v_cvt_pk_bf16_f32 v35, v122, v123
    s_add_u32 s65, s90, 344064
    buffer_store_dwordx4 v[32:35], v5, s[32:35], s65 offen offset:512 sc1
    s_nop 1
L_g2:
    s_cmp_lt_u32 s16, 16
    s_cbranch_scc1 L_slow15
L_ret15:
    s_add_u32 s66, s91, 0
    buffer_load_dwordx4 a[60:63], v4, s[32:35], s66 offen offset:0 sc1
    buffer_load_dwordx4 a[64:67], v4, s[32:35], s66 offen offset:1024 sc1
    buffer_load_dwordx4 a[68:71], v4, s[32:35], s66 offen offset:2048 sc1
    buffer_load_dwordx4 a[72:75], v4, s[32:35], s66 offen offset:3072 sc1
    s_add_u32 s66, s91, 4096
    buffer_load_dwordx4 a[76:79], v4, s[32:35], s66 offen offset:0 sc1
    buffer_load_dwordx4 a[80:83], v4, s[32:35], s66 offen offset:1024 sc1
    buffer_load_dwordx4 a[84:87], v4, s[32:35], s66 offen offset:2048 sc1
    buffer_load_dwordx4 a[88:91], v4, s[32:35], s66 offen offset:3072 sc1
    ds_read_b128 v[104:107], v14 offset:0
    ds_read_b32 v16, v9
    ds_read_b32 v16, v9
    s_waitcnt lgkmcnt(2)
    v_lshlrev_b32 v96, 16, v104
    v_and_b32 v97, s73, v104
    v_lshlrev_b32 v98, 16, v105
    v_and_b32 v99, s73, v105
    v_lshlrev_b32 v100, 16, v106
    v_and_b32 v101, s73, v106
    v_lshlrev_b32 v102, 16, v107
    v_and_b32 v103, s73, v107
    s_waitcnt vmcnt(8)
    s_barrier
    s_mov_b64 s[16:17], 0
    s_load_dword s16, s[32:33], s89 offset:512
    s_cmp_lg_u32 s56, 0
    s_cbranch_scc1 L_nosig16
    s_atomic_add s19, s[32:33], s88 offset:1024
L_nosig16:
    s_add_u32 s66, s91, 8192
    buffer_load_dwordx4 a[92:95], v4, s[32:35], s66 offen offset:0 sc1
    buffer_load_dwordx4 a[96:99], v4, s[32:35], s66 offen offset:1024 sc1
    buffer_load_dwordx4 a[100:103], v4, s[32:35], s66 offen offset:2048 sc1
    buffer_load_dwordx4 a[104:107], v4, s[32:35], s66 offen offset:3072 sc1
    s_add_u32 s66, s91, 12288
    buffer_load_dwordx2 a[108:109], v9, s[32:35], s66 offen offset:0 sc1
    buffer_load_dwordx2 a[110:111], v9, s[32:35], s66 offen offset:512 sc1
    buffer_load_dwordx2 a[112:113], v9, s[32:35], s66 offen offset:1024 sc1
    buffer_load_dwordx2 a[114:115], v9, s[32:35], s66 offen offset:1536 sc1
    s_waitcnt vmcnt(14)
    v_mfma_f32_16x16x32_bf16 v[44:47], a[228:231], a[60:63], 0
    v_mfma_f32_16x16x32_bf16 v[48:51], a[232:235], a[60:63], 0
    v_mfma_f32_16x16x32_bf16 v[52:55], a[236:239], a[60:63], 0
    v_mfma_f32_16x16x32_bf16 v[56:59], a[240:243], a[60:63], 0
    v_mfma_f32_16x16x32_bf16 v[60:63], a[244:247], a[60:63], 0
    v_mfma_f32_16x16x32_bf16 v[44:47], a[248:251], a[64:67], v[44:47]
    v_mfma_f32_16x16x32_bf16 v[48:51], a[252:255], a[64:67], v[48:51]
    v_mfma_f32_16x16x32_bf16 v[52:55], v[128:131], a[64:67], v[52:55]
    v_mfma_f32_16x16x32_bf16 v[56:59], v[132:135], a[64:67], v[56:59]
    v_mfma_f32_16x16x32_bf16 v[60:63], v[136:139], a[64:67], v[60:63]
    s_waitcnt vmcnt(12)
    v_mfma_f32_16x16x32_bf16 v[44:47], v[140:143], a[68:71], v[44:47]
    v_mfma_f32_16x16x32_bf16 v[48:51], v[144:147], a[68:71], v[48:51]
    v_mfma_f32_16x16x32_bf16 v[52:55], v[148:151], a[68:71], v[52:55]
    v_mfma_f32_16x16x32_bf16 v[56:59], v[152:155], a[68:71], v[56:59]
    s_cmp_lt_u32 s16, 16
    s_cbranch_scc1 L_slow17
L_ret17:
    v_mfma_f32_16x16x32_bf16 v[60:63], v[156:159], a[68:71], v[60:63]
    s_add_u32 s66, s91, 114688
    buffer_load_dwordx4 a[116:119], v4, s[32:35], s66 offen offset:0 sc1
    v_mfma_f32_16x16x32_bf16 v[44:47], a[164:167], a[72:75], v[44:47]
    v_mfma_f32_16x16x32_bf16 v[48:51], a[168:171], a[72:75], v[48:51]
    v_mfma_f32_16x16x32_bf16 v[52:55], a[172:175], a[72:75], v[52:55]
    v_mfma_f32_16x16x32_bf16 v[56:59], a[176:179], a[72:75], v[56:59]
    buffer_load_dwordx4 a[120:123], v4, s[32:35], s66 offen offset:1024 sc1
    v_mfma_f32_16x16x32_bf16 v[60:63], a[180:183], a[72:75], v[60:63]
    s_waitcnt vmcnt(12)
    v_mfma_f32_16x16x32_bf16 v[44:47], a[184:187], a[76:79], v[44:47]
    v_mfma_f32_16x16x32_bf16 v[48:51], a[188:191], a[76:79], v[48:51]
    v_mfma_f32_16x16x32_bf16 v[52:55], a[192:195], a[76:79], v[52:55]
    v_mfma_f32_16x16x32_bf16 v[56:59], a[196:199], a[76:79], v[56:59]
    buffer_load_dwordx4 a[124:127], v4, s[32:35], s66 offen offset:2048 sc1
    v_mfma_f32_16x16x32_bf16 v[60:63], a[200:203], a[76:79], v[60:63]
    v_mfma_f32_16x16x32_bf16 v[44:47], a[204:207], a[80:83], v[44:47]
    v_mfma_f32_16x16x32_bf16 v[48:51], a[208:211], a[80:83], v[48:51]
    v_mfma_f32_16x16x32_bf16 v[52:55], a[212:215], a[80:83], v[52:55]
    buffer_load_dwordx4 a[128:131], v4, s[32:35], s66 offen offset:3072 sc1
    v_mfma_f32_16x16x32_bf16 v[56:59], a[216:219], a[80:83], v[56:59]
    v_mfma_f32_16x16x32_bf16 v[60:63], a[220:223], a[80:83], v[60:63]
    s_waitcnt vmcnt(12)
    v_mfma_f32_16x16x32_bf16 v[44:47], a[224:227], a[84:87], v[44:47]
    v_mfma_f32_16x16x32_bf16 v[48:51], v[160:163], a[84:87], v[48:51]
    v_mfma_f32_16x16x32_bf16 v[52:55], v[164:167], a[84:87], v[52:55]
    s_add_u32 s66, s91, 118784
    buffer_load_dwordx4 a[132:135], v4, s[32:35], s66 offen offset:0 sc1
    v_mfma_f32_16x16x32_bf16 v[56:59], v[168:171], a[84:87], v[56:59]
    v_mfma_f32_16x16x32_bf16 v[60:63], v[172:175], a[84:87], v[60:63]
    v_mfma_f32_16x16x32_bf16 v[44:47], v[176:179], a[88:91], v[44:47]
    v_mfma_f32_16x16x32_bf16 v[48:51], v[180:183], a[88:91], v[48:51]
    v_mfma_f32_16x16x32_bf16 v[52:55], v[184:187], a[88:91], v[52:55]
    buffer_load_dwordx4 a[136:139], v4, s[32:35], s66 offen offset:1024 sc1
    v_mfma_f32_16x16x32_bf16 v[56:59], v[188:191], a[88:91], v[56:59]
    v_mfma_f32_16x16x32_bf16 v[60:63], v[192:195], a[88:91], v[60:63]
    s_waitcnt vmcnt(12)
    v_mfma_f32_16x16x32_bf16 v[44:47], v[196:199], a[92:95], v[44:47]
    v_mfma_f32_16x16x32_bf16 v[48:51], v[200:203], a[92:95], v[48:51]
    buffer_load_dwordx4 a[140:143], v4, s[32:35], s66 offen offset:2048 sc1
    v_mfma_f32_16x16x32_bf16 v[52:55], v[204:207], a[92:95], v[52:55]
    v_mfma_f32_16x16x32_bf16 v[56:59], v[208:211], a[92:95], v[56:59]
    v_mfma_f32_16x16x32_bf16 v[60:63], v[212:215], a[92:95], v[60:63]
    v_mfma_f32_16x16x32_bf16 v[44:47], v[216:219], a[96:99], v[44:47]
    v_mfma_f32_16x16x32_bf16 v[48:51], v[220:223], a[96:99], v[48:51]
    buffer_load_dwordx4 a[144:147], v4, s[32:35], s66 offen offset:3072 sc1
    v_mfma_f32_16x16x32_bf16 v[52:55], v[224:227], a[96:99], v[52:55]
    v_mfma_f32_16x16x32_bf16 v[56:59], v[228:231], a[96:99], v[56:59]
    v_mfma_f32_16x16x32_bf16 v[60:63], v[232:235], a[96:99], v[60:63]
    s_waitcnt vmcnt(12)
    v_mfma_f32_16x16x32_bf16 v[44:47], v[236:239], a[100:103], v[44:47]
    s_add_u32 s66, s91, 122880
    buffer_load_dwordx4 a[148:151], v4, s[32:35], s66 offen offset:0 sc1
    v_mfma_f32_16x16x32_bf16 v[48:51], v[240:243], a[100:103], v[48:51]
    v_mfma_f32_16x16x32_bf16 v[52:55], v[244:247], a[100:103], v[52:55]
    v_mfma_f32_16x16x32_bf16 v[56:59], v[248:251], a[100:103], v[56:59]
    s_mov_b64 s[16:17], 0
    s_load_dword s16, s[32:33], s89 offset:1024
    v_mfma_f32_16x16x32_bf16 v[60:63], v[252:255], a[100:103], v[60:63]
    v_mfma_f32_16x16x32_bf16 v[44:47], a[0:3], a[104:107], v[44:47]
    buffer_load_dwordx4 a[152:155], v4, s[32:35], s66 offen offset:1024 sc1
    v_mfma_f32_16x16x32_bf16 v[48:51], a[4:7], a[104:107], v[48:51]
    v_mfma_f32_16x16x32_bf16 v[52:55], a[8:11], a[104:107], v[52:55]
    v_mfma_f32_16x16x32_bf16 v[56:59], a[12:15], a[104:107], v[56:59]
    v_mfma_f32_16x16x32_bf16 v[60:63], a[16:19], a[104:107], v[60:63]
    s_waitcnt vmcnt(10)
    v_mfma_f32_16x16x32_bf16 v[44:47], a[20:23], a[108:111], v[44:47]
    buffer_load_dwordx4 a[156:159], v4, s[32:35], s66 offen offset:2048 sc1
    v_mfma_f32_16x16x32_bf16 v[48:51], a[24:27], a[108:111], v[48:51]
    v_mfma_f32_16x16x32_bf16 v[52:55], a[28:31], a[108:111], v[52:55]
    v_mfma_f32_16x16x32_bf16 v[56:59], a[32:35], a[108:111], v[56:59]
    v_mfma_f32_16x16x32_bf16 v[60:63], a[36:39], a[108:111], v[60:63]
    buffer_load_dwordx4 v[112:115], v4, s[32:35], s66 offen offset:3072 sc1
    v_mfma_f32_16x16x32_bf16 v[44:47], a[40:43], a[112:115], v[44:47]
    v_mfma_f32_16x16x32_bf16 v[48:51], a[44:47], a[112:115], v[48:51]
    v_mfma_f32_16x16x32_bf16 v[52:55], a[48:51], a[112:115], v[52:55]
    v_mfma_f32_16x16x32_bf16 v[56:59], a[52:55], a[112:115], v[56:59]
    v_mfma_f32_16x16x32_bf16 v[60:63], a[56:59], a[112:115], v[60:63]
    s_add_u32 s66, s91, 126976
    buffer_load_dwordx2 v[116:117], v9, s[32:35], s66 offen offset:0 sc1
    buffer_load_dwordx2 v[118:119], v9, s[32:35], s66 offen offset:512 sc1
    s_waitcnt vmcnt(12)
    v_mfma_f32_16x16x32_bf16 v[24:27], a[228:231], a[116:119], 0
    v_mfma_f32_16x16x32_bf16 v[28:31], a[232:235], a[116:119], 0
    v_mfma_f32_16x16x32_bf16 v[32:35], a[236:239], a[116:119], 0
    v_mfma_f32_16x16x32_bf16 v[36:39], a[240:243], a[116:119], 0
    buffer_load_dwordx2 v[120:121], v9, s[32:35], s66 offen offset:1024 sc1
    buffer_load_dwordx2 v[122:123], v9, s[32:35], s66 offen offset:1536 sc1
    v_mfma_f32_16x16x32_bf16 v[40:43], a[244:247], a[116:119], 0
    ds_write_b128 v12, v[44:47] offset:0
    v_mfma_f32_16x16x32_bf16 v[24:27], a[248:251], a[120:123], v[24:27]
    v_mfma_f32_16x16x32_bf16 v[28:31], a[252:255], a[120:123], v[28:31]
    ds_write_b128 v12, v[48:51] offset:64
    v_mfma_f32_16x16x32_bf16 v[32:35], v[128:131], a[120:123], v[32:35]
    v_mfma_f32_16x16x32_bf16 v[36:39], v[132:135], a[120:123], v[36:39]
    ds_write_b128 v12, v[52:55] offset:128
    v_mfma_f32_16x16x32_bf16 v[40:43], v[136:139], a[120:123], v[40:43]
    s_waitcnt vmcnt(12)
    v_mfma_f32_16x16x32_bf16 v[24:27], v[140:143], a[124:127], v[24:27]
    ds_write_b128 v12, v[56:59] offset:192
    v_mfma_f32_16x16x32_bf16 v[28:31], v[144:147], a[124:127], v[28:31]
    v_mfma_f32_16x16x32_bf16 v[32:35], v[148:151], a[124:127], v[32:35]
    ds_write_b128 v12, v[60:63] offset:256
    ds_read_b32 v16, v9
    ds_read_b32 v16, v9
    v_mfma_f32_16x16x32_bf16 v[36:39], v[152:155], a[124:127], v[36:39]
    v_mfma_f32_16x16x32_bf16 v[40:43], v[156:159], a[124:127], v[40:43]
    v_mfma_f32_16x16x32_bf16 v[24:27], a[164:167], a[128:131], v[24:27]
    s_waitcnt lgkmcnt(2)
    s_barrier
    v_mfma_f32_16x16x32_bf16 v[28:31], a[168:171], a[128:131], v[28:31]
    ds_read_b128 v[64:67], v13 offset:0
    ds_read_b128 v[68:71], v13 offset:16
    v_mfma_f32_16x16x32_bf16 v[32:35], a[172:175], a[128:131], v[32:35]
    s_cmp_lt_u32 s16, 16
    s_cbranch_scc1 L_slow18
L_ret18:
    v_mfma_f32_16x16x32_bf16 v[36:39], a[176:179], a[128:131], v[36:39]
    s_add_u32 s66, s91, 229376
    buffer_load_dwordx4 a[60:63], v4, s[32:35], s66 offen offset:0 sc1
    v_mfma_f32_16x16x32_bf16 v[40:43], a[180:183], a[128:131], v[40:43]
    ds_read_b128 v[72:75], v13 offset:5376
    s_waitcnt vmcnt(11)
    v_mfma_f32_16x16x32_bf16 v[24:27], a[184:187], a[132:135], v[24:27]
    ds_read_b128 v[76:79], v13 offset:5392
    ds_read_b128 v[80:83], v13 offset:10752
    v_mfma_f32_16x16x32_bf16 v[28:31], a[188:191], a[132:135], v[28:31]
    ds_read_b128 v[84:87], v13 offset:10768
    ds_read_b128 v[88:91], v13 offset:16128
    v_mfma_f32_16x16x32_bf16 v[32:35], a[192:195], a[132:135], v[32:35]
    buffer_load_dwordx4 a[64:67], v4, s[32:35], s66 offen offset:1024 sc1
    ds_read_b128 v[92:95], v13 offset:16144
    ds_read_b32 v16, v9
    v_mfma_f32_16x16x32_bf16 v[36:39], a[196:199], a[132:135], v[36:39]
    v_mfma_f32_16x16x32_bf16 v[40:43], a[200:203], a[132:135], v[40:43]
    v_mfma_f32_16x16x32_bf16 v[24:27], a[204:207], a[136:139], v[24:27]
    v_mfma_f32_16x16x32_bf16 v[28:31], a[208:211], a[136:139], v[28:31]
    v_mfma_f32_16x16x32_bf16 v[32:35], a[212:215], a[136:139], v[32:35]
    buffer_load_dwordx4 a[68:71], v4, s[32:35], s66 offen offset:2048 sc1
    v_mfma_f32_16x16x32_bf16 v[36:39], a[216:219], a[136:139], v[36:39]
    s_waitcnt lgkmcnt(4)
    v_add_f32 v96, v96, v64
    v_add_f32 v97, v97, v65
    v_mfma_f32_16x16x32_bf16 v[40:43], a[220:223], a[136:139], v[40:43]
    v_add_f32 v98, v98, v66
    s_waitcnt vmcnt(11)
    v_mfma_f32_16x16x32_bf16 v[24:27], a[224:227], a[140:143], v[24:27]
    v_add_f32 v99, v99, v67
    v_add_f32 v100, v100, v68
    v_mfma_f32_16x16x32_bf16 v[28:31], v[160:163], a[140:143], v[28:31]
    buffer_load_dwordx4 a[72:75], v4, s[32:35], s66 offen offset:3072 sc1
    v_add_f32 v101, v101, v69
    v_mfma_f32_16x16x32_bf16 v[32:35], v[164:167], a[140:143], v[32:35]
    v_add_f32 v102, v102, v70
    v_add_f32 v103, v103, v71
    v_mfma_f32_16x16x32_bf16 v[36:39], v[168:171], a[140:143], v[36:39]
    v_add_f32 v96, v96, v72
    v_add_f32 v97, v97, v73
    v_mfma_f32_16x16x32_bf16 v[40:43], v[172:175], a[140:143], v[40:43]
    v_add_f32 v98, v98, v74
    v_add_f32 v99, v99, v75
    v_mfma_f32_16x16x32_bf16 v[24:27], v[176:179], a[144:147], v[24:27]
    v_add_f32 v100, v100, v76
    v_add_f32 v101, v101, v77
    v_mfma_f32_16x16x32_bf16 v[28:31], v[180:183], a[144:147], v[28:31]
    s_add_u32 s66, s91, 233472
    buffer_load_dwordx4 a[76:79], v4, s[32:35], s66 offen offset:0 sc1
    v_mfma_f32_16x16x32_bf16 v[32:35], v[184:187], a[144:147], v[32:35]
    v_add_f32 v102, v102, v78
    v_add_f32 v103, v103, v79
    v_mfma_f32_16x16x32_bf16 v[36:39], v[188:191], a[144:147], v[36:39]
    s_waitcnt lgkmcnt(1)
    v_add_f32 v96, v96, v80
    v_add_f32 v97, v97, v81
    v_mfma_f32_16x16x32_bf16 v[40:43], v[192:195], a[144:147], v[40:43]
    v_add_f32 v98, v98, v82
    s_waitcnt vmcnt(11)
    v_mfma_f32_16x16x32_bf16 v[24:27], v[196:199], a[148:151], v[24:27]
    buffer_load_dwordx4 a[80:83], v4, s[32:35], s66 offen offset:1024 sc1
    v_add_f32 v99, v99, v83
    v_mfma_f32_16x16x32_bf16 v[28:31], v[200:203], a[148:151], v[28:31]
    v_add_f32 v100, v100, v84
    v_add_f32 v101, v101, v85
    v_mfma_f32_16x16x32_bf16 v[32:35], v[204:207], a[148:151], v[32:35]
    v_add_f32 v102, v102, v86
    v_add_f32 v103, v103, v87
    v_mfma_f32_16x16x32_bf16 v[36:39], v[208:211], a[148:151], v[36:39]
    v_add_f32 v96, v96, v88
    v_add_f32 v97, v97, v89
    v_mfma_f32_16x16x32_bf16 v[40:43], v[212:215], a[148:151], v[40:43]
    v_add_f32 v98, v98, v90
    v_add_f32 v99, v99, v91
    v_mfma_f32_16x16x32_bf16 v[24:27], v[216:219], a[152:155], v[24:27]
    buffer_load_dwordx4 a[84:87], v4, s[32:35], s66 offen offset:2048 sc1
    s_waitcnt lgkmcnt(1)
    v_add_f32 v100, v100, v92
    v_mfma_f32_16x16x32_bf16 v[28:31], v[220:223], a[152:155], v[28:31]
    v_add_f32 v101, v101, v93
    v_add_f32 v102, v102, v94
    v_mfma_f32_16x16x32_bf16 v[32:35], v[224:227], a[152:155], v[32:35]
    v_add_f32 v103, v103, v95
    v_cvt_pk_bf16_f32 v104, v96, v97
    v_mfma_f32_16x16x32_bf16 v[36:39], v[228:231], a[152:155], v[36:39]
    v_cvt_pk_bf16_f32 v105, v98, v99
    v_cvt_pk_bf16_f32 v106, v100, v101
    v_mfma_f32_16x16x32_bf16 v[40:43], v[232:235], a[152:155], v[40:43]
    v_cvt_pk_bf16_f32 v107, v102, v103
    s_waitcnt vmcnt(11)
    v_mfma_f32_16x16x32_bf16 v[24:27], v[236:239], a[156:159], v[24:27]
    buffer_load_dwordx4 a[88:91], v4, s[32:35], s66 offen offset:3072 sc1
    v_mfma_f32_16x16x32_bf16 v[28:31], v[240:243], a[156:159], v[28:31]
    s_add_u32 s65, s92, 0
    buffer_store_dwordx4 v[104:107], v15, s[28:31], s65 offen nt
    v_mfma_f32_16x16x32_bf16 v[32:35], v[244:247], a[156:159], v[32:35]
    s_nop 0
    ds_read_b128 v[104:107], v14 offset:2560
    v_mfma_f32_16x16x32_bf16 v[36:39], v[248:251], a[156:159], v[36:39]
    v_mfma_f32_16x16x32_bf16 v[40:43], v[252:255], a[156:159], v[40:43]
    s_add_u32 s66, s91, 237568
    buffer_load_dwordx4 a[92:95], v4, s[32:35], s66 offen offset:0 sc1
    v_mfma_f32_16x16x32_bf16 v[24:27], a[0:3], v[112:115], v[24:27]
    v_mfma_f32_16x16x32_bf16 v[28:31], a[4:7], v[112:115], v[28:31]
    v_mfma_f32_16x16x32_bf16 v[32:35], a[8:11], v[112:115], v[32:35]
    v_mfma_f32_16x16x32_bf16 v[36:39], a[12:15], v[112:115], v[36:39]
    s_waitcnt lgkmcnt(0)
    v_lshlrev_b32 v96, 16, v104
    v_and_b32 v97, s73, v104
    v_mfma_f32_16x16x32_bf16 v[40:43], a[16:19], v[112:115], v[40:43]
    buffer_load_dwordx4 a[96:99], v4, s[32:35], s66 offen offset:1024 sc1
    s_waitcnt vmcnt(11)
    v_mfma_f32_16x16x32_bf16 v[24:27], a[20:23], v[116:119], v[24:27]
    v_lshlrev_b32 v98, 16, v105
    v_and_b32 v99, s73, v105
    v_mfma_f32_16x16x32_bf16 v[28:31], a[24:27], v[116:119], v[28:31]
    v_lshlrev_b32 v100, 16, v106
    v_and_b32 v101, s73, v106
    v_mfma_f32_16x16x32_bf16 v[32:35], a[28:31], v[116:119], v[32:35]
    v_lshlrev_b32 v102, 16, v107
    v_and_b32 v103, s73, v107
    v_mfma_f32_16x16x32_bf16 v[36:39], a[32:35], v[116:119], v[36:39]
    buffer_load_dwordx4 a[100:103], v4, s[32:35], s66 offen offset:2048 sc1
    v_mfma_f32_16x16x32_bf16 v[40:43], a[36:39], v[116:119], v[40:43]
    v_mfma_f32_16x16x32_bf16 v[24:27], a[40:43], v[120:123], v[24:27]
    v_mfma_f32_16x16x32_bf16 v[28:31], a[44:47], v[120:123], v[28:31]
    v_mfma_f32_16x16x32_bf16 v[32:35], a[48:51], v[120:123], v[32:35]
    v_mfma_f32_16x16x32_bf16 v[36:39], a[52:55], v[120:123], v[36:39]
    buffer_load_dwordx4 a[104:107], v4, s[32:35], s66 offen offset:3072 sc1
    v_mfma_f32_16x16x32_bf16 v[40:43], a[56:59], v[120:123], v[40:43]
    s_waitcnt vmcnt(11)
    v_mfma_f32_16x16x32_bf16 v[44:47], a[228:231], a[60:63], 0
    v_mfma_f32_16x16x32_bf16 v[48:51], a[232:235], a[60:63], 0
    v_mfma_f32_16x16x32_bf16 v[52:55], a[236:239], a[60:63], 0
    v_mfma_f32_16x16x32_bf16 v[56:59], a[240:243], a[60:63], 0
    s_add_u32 s66, s91, 241664
    buffer_load_dwordx2 a[108:109], v9, s[32:35], s66 offen offset:0 sc1
    buffer_load_dwordx2 a[110:111], v9, s[32:35], s66 offen offset:512 sc1
    v_mfma_f32_16x16x32_bf16 v[60:63], a[244:247], a[60:63], 0
    ds_write_b128 v12, v[24:27] offset:21504
    v_mfma_f32_16x16x32_bf16 v[44:47], a[248:251], a[64:67], v[44:47]
    v_mfma_f32_16x16x32_bf16 v[48:51], a[252:255], a[64:67], v[48:51]
    ds_write_b128 v12, v[28:31] offset:21568
    v_mfma_f32_16x16x32_bf16 v[52:55], v[128:131], a[64:67], v[52:55]
    buffer_load_dwordx2 a[112:113], v9, s[32:35], s66 offen offset:1024 sc1
    buffer_load_dwordx2 a[114:115], v9, s[32:35], s66 offen offset:1536 sc1
    v_mfma_f32_16x16x32_bf16 v[56:59], v[132:135], a[64:67], v[56:59]
    ds_write_b128 v12, v[32:35] offset:21632
    v_mfma_f32_16x16x32_bf16 v[60:63], v[136:139], a[64:67], v[60:63]
    s_waitcnt vmcnt(13)
    v_mfma_f32_16x16x32_bf16 v[44:47], v[140:143], a[68:71], v[44:47]
    ds_write_b128 v12, v[36:39] offset:21696
    v_mfma_f32_16x16x32_bf16 v[48:51], v[144:147], a[68:71], v[48:51]
    v_mfma_f32_16x16x32_bf16 v[52:55], v[148:151], a[68:71], v[52:55]
    s_add_u32 s66, s91, 344064
    buffer_load_dwordx4 a[116:119], v4, s[32:35], s66 offen offset:0 sc1
    v_mfma_f32_16x16x32_bf16 v[56:59], v[152:155], a[68:71], v[56:59]
    ds_write_b128 v12, v[40:43] offset:21760
    v_mfma_f32_16x16x32_bf16 v[60:63], v[156:159], a[68:71], v[60:63]
    v_mfma_f32_16x16x32_bf16 v[44:47], a[164:167], a[72:75], v[44:47]
    v_mfma_f32_16x16x32_bf16 v[48:51], a[168:171], a[72:75], v[48:51]
    buffer_load_dwordx4 a[120:123], v4, s[32:35], s66 offen offset:1024 sc1
    v_mfma_f32_16x16x32_bf16 v[52:55], a[172:175], a[72:75], v[52:55]
    s_waitcnt lgkmcnt(0)
    s_barrier
    v_mfma_f32_16x16x32_bf16 v[56:59], a[176:179], a[72:75], v[56:59]
    ds_read_b128 v[64:67], v13 offset:21504
    ds_read_b128 v[68:71], v13 offset:21520
    v_mfma_f32_16x16x32_bf16 v[60:63], a[180:183], a[72:75], v[60:63]
    ds_read_b128 v[72:75], v13 offset:26880
    s_waitcnt vmcnt(13)
    v_mfma_f32_16x16x32_bf16 v[44:47], a[184:187], a[76:79], v[44:47]
    ds_read_b128 v[76:79], v13 offset:26896
    ds_read_b128 v[80:83], v13 offset:32256
    v_mfma_f32_16x16x32_bf16 v[48:51], a[188:191], a[76:79], v[48:51]
    buffer_load_dwordx4 a[124:127], v4, s[32:35], s66 offen offset:2048 sc1
    ds_read_b128 v[84:87], v13 offset:32272
    v_mfma_f32_16x16x32_bf16 v[52:55], a[192:195], a[76:79], v[52:55]
    ds_read_b128 v[88:91], v13 offset:37632
    ds_read_b128 v[92:95], v13 offset:37648
    v_mfma_f32_16x16x32_bf16 v[56:59], a[196:199], a[76:79], v[56:59]
    v_mfma_f32_16x16x32_bf16 v[60:63], a[200:203], a[76:79], v[60:63]
    v_mfma_f32_16x16x32_bf16 v[44:47], a[204:207], a[80:83], v[44:47]
    v_mfma_f32_16x16x32_bf16 v[48:51], a[208:211], a[80:83], v[48:51]
    buffer_load_dwordx4 a[128:131], v4, s[32:35], s66 offen offset:3072 sc1
    v_mfma_f32_16x16x32_bf16 v[52:55], a[212:215], a[80:83], v[52:55]
    v_mfma_f32_16x16x32_bf16 v[56:59], a[216:219], a[80:83], v[56:59]
    s_waitcnt lgkmcnt(4)
    v_add_f32 v96, v96, v64
    v_add_f32 v97, v97, v65
    v_mfma_f32_16x16x32_bf16 v[60:63], a[220:223], a[80:83], v[60:63]
    v_add_f32 v98, v98, v66
    s_waitcnt vmcnt(13)
    v_mfma_f32_16x16x32_bf16 v[44:47], a[224:227], a[84:87], v[44:47]
    s_add_u32 s66, s91, 348160
    buffer_load_dwordx4 a[132:135], v4, s[32:35], s66 offen offset:0 sc1
    v_mfma_f32_16x16x32_bf16 v[48:51], v[160:163], a[84:87], v[48:51]
    v_add_f32 v99, v99, v67
    v_add_f32 v100, v100, v68
    v_mfma_f32_16x16x32_bf16 v[52:55], v[164:167], a[84:87], v[52:55]
    v_add_f32 v101, v101, v69
    v_add_f32 v102, v102, v70
    v_mfma_f32_16x16x32_bf16 v[56:59], v[168:171], a[84:87], v[56:59]
    v_add_f32 v103, v103, v71
    v_add_f32 v96, v96, v72
    v_mfma_f32_16x16x32_bf16 v[60:63], v[172:175], a[84:87], v[60:63]
    v_add_f32 v97, v97, v73
    v_add_f32 v98, v98, v74
    v_mfma_f32_16x16x32_bf16 v[44:47], v[176:179], a[88:91], v[44:47]
    buffer_load_dwordx4 a[136:139], v4, s[32:35], s66 offen offset:1024 sc1
    v_add_f32 v99, v99, v75
    v_mfma_f32_16x16x32_bf16 v[48:51], v[180:183], a[88:91], v[48:51]
    v_add_f32 v100, v100, v76
    v_add_f32 v101, v101, v77
    v_mfma_f32_16x16x32_bf16 v[52:55], v[184:187], a[88:91], v[52:55]
    v_add_f32 v102, v102, v78
    v_add_f32 v103, v103, v79
    v_mfma_f32_16x16x32_bf16 v[56:59], v[188:191], a[88:91], v[56:59]
    s_waitcnt lgkmcnt(0)
    v_add_f32 v96, v96, v80
    v_add_f32 v97, v97, v81
    v_mfma_f32_16x16x32_bf16 v[60:63], v[192:195], a[88:91], v[60:63]
    buffer_load_dwordx4 a[140:143], v4, s[32:35], s66 offen offset:2048 sc1
    s_waitcnt vmcnt(13)
    v_mfma_f32_16x16x32_bf16 v[44:47], v[196:199], a[92:95], v[44:47]
    v_add_f32 v98, v98, v82
    v_add_f32 v99, v99, v83
    v_mfma_f32_16x16x32_bf16 v[48:51], v[200:203], a[92:95], v[48:51]
    v_add_f32 v100, v100, v84
    v_add_f32 v101, v101, v85
    v_mfma_f32_16x16x32_bf16 v[52:55], v[204:207], a[92:95], v[52:55]
    v_add_f32 v102, v102, v86
    v_add_f32 v103, v103, v87
    v_mfma_f32_16x16x32_bf16 v[56:59], v[208:211], a[92:95], v[56:59]
    v_add_f32 v96, v96, v88
    v_add_f32 v97, v97, v89
    v_mfma_f32_16x16x32_bf16 v[60:63], v[212:215], a[92:95], v[60:63]
    buffer_load_dwordx4 a[144:147], v4, s[32:35], s66 offen offset:3072 sc1
    v_add_f32 v98, v98, v90
    v_mfma_f32_16x16x32_bf16 v[44:47], v[216:219], a[96:99], v[44:47]
    v_add_f32 v99, v99, v91
    v_add_f32 v100, v100, v92
    v_mfma_f32_16x16x32_bf16 v[48:51], v[220:223], a[96:99], v[48:51]
    v_add_f32 v101, v101, v93
    v_add_f32 v102, v102, v94
    v_mfma_f32_16x16x32_bf16 v[52:55], v[224:227], a[96:99], v[52:55]
    v_add_f32 v103, v103, v95
    v_cvt_pk_bf16_f32 v104, v96, v97
    v_mfma_f32_16x16x32_bf16 v[56:59], v[228:231], a[96:99], v[56:59]
    v_cvt_pk_bf16_f32 v105, v98, v99
    v_cvt_pk_bf16_f32 v106, v100, v101
    v_mfma_f32_16x16x32_bf16 v[60:63], v[232:235], a[96:99], v[60:63]
    s_add_u32 s66, s91, 352256
    buffer_load_dwordx4 a[148:151], v4, s[32:35], s66 offen offset:0 sc1
    s_waitcnt vmcnt(13)
    v_mfma_f32_16x16x32_bf16 v[44:47], v[236:239], a[100:103], v[44:47]
    v_cvt_pk_bf16_f32 v107, v102, v103
    v_mfma_f32_16x16x32_bf16 v[48:51], v[240:243], a[100:103], v[48:51]
    s_add_u32 s65, s92, 655360
    buffer_store_dwordx4 v[104:107], v15, s[28:31], s65 offen nt
    v_mfma_f32_16x16x32_bf16 v[52:55], v[244:247], a[100:103], v[52:55]
    s_nop 0
    ds_read_b128 v[104:107], v14 offset:5120
    v_mfma_f32_16x16x32_bf16 v[56:59], v[248:251], a[100:103], v[56:59]
    buffer_load_dwordx4 a[152:155], v4, s[32:35], s66 offen offset:1024 sc1
    v_mfma_f32_16x16x32_bf16 v[60:63], v[252:255], a[100:103], v[60:63]
    v_mfma_f32_16x16x32_bf16 v[44:47], a[0:3], a[104:107], v[44:47]
    v_mfma_f32_16x16x32_bf16 v[48:51], a[4:7], a[104:107], v[48:51]
    v_mfma_f32_16x16x32_bf16 v[52:55], a[8:11], a[104:107], v[52:55]
    v_mfma_f32_16x16x32_bf16 v[56:59], a[12:15], a[104:107], v[56:59]
    buffer_load_dwordx4 a[156:159], v4, s[32:35], s66 offen offset:2048 sc1
    s_waitcnt lgkmcnt(0)
    v_lshlrev_b32 v96, 16, v104
    v_mfma_f32_16x16x32_bf16 v[60:63], a[16:19], a[104:107], v[60:63]
    v_and_b32 v97, s73, v104
    s_waitcnt vmcnt(12)
    v_mfma_f32_16x16x32_bf16 v[44:47], a[20:23], a[108:111], v[44:47]
    v_lshlrev_b32 v98, 16, v105
    v_and_b32 v99, s73, v105
    v_mfma_f32_16x16x32_bf16 v[48:51], a[24:27], a[108:111], v[48:51]
    v_lshlrev_b32 v100, 16, v106
    v_and_b32 v101, s73, v106
    v_mfma_f32_16x16x32_bf16 v[52:55], a[28:31], a[108:111], v[52:55]
    buffer_load_dwordx4 v[112:115], v4, s[32:35], s66 offen offset:3072 sc1
    v_lshlrev_b32 v102, 16, v107
    v_mfma_f32_16x16x32_bf16 v[56:59], a[32:35], a[108:111], v[56:59]
    v_and_b32 v103, s73, v107
    v_mfma_f32_16x16x32_bf16 v[60:63], a[36:39], a[108:111], v[60:63]
    v_mfma_f32_16x16x32_bf16 v[44:47], a[40:43], a[112:115], v[44:47]
    v_mfma_f32_16x16x32_bf16 v[48:51], a[44:47], a[112:115], v[48:51]
    v_mfma_f32_16x16x32_bf16 v[52:55], a[48:51], a[112:115], v[52:55]
    s_add_u32 s66, s91, 356352
    buffer_load_dwordx2 v[116:117], v9, s[32:35], s66 offen offset:0 sc1
    buffer_load_dwordx2 v[118:119], v9, s[32:35], s66 offen offset:512 sc1
    v_mfma_f32_16x16x32_bf16 v[56:59], a[52:55], a[112:115], v[56:59]
    v_mfma_f32_16x16x32_bf16 v[60:63], a[56:59], a[112:115], v[60:63]
    s_waitcnt vmcnt(13)
    v_mfma_f32_16x16x32_bf16 v[24:27], a[228:231], a[116:119], 0
    v_mfma_f32_16x16x32_bf16 v[28:31], a[232:235], a[116:119], 0
    v_mfma_f32_16x16x32_bf16 v[32:35], a[236:239], a[116:119], 0
    buffer_load_dwordx2 v[120:121], v9, s[32:35], s66 offen offset:1024 sc1
    buffer_load_dwordx2 v[122:123], v9, s[32:35], s66 offen offset:1536 sc1
    v_mfma_f32_16x16x32_bf16 v[36:39], a[240:243], a[116:119], 0
    v_mfma_f32_16x16x32_bf16 v[40:43], a[244:247], a[116:119], 0
    ds_write_b128 v12, v[44:47] offset:0
    v_mfma_f32_16x16x32_bf16 v[24:27], a[248:251], a[120:123], v[24:27]
    v_mfma_f32_16x16x32_bf16 v[28:31], a[252:255], a[120:123], v[28:31]
    ds_write_b128 v12, v[48:51] offset:64
    v_mfma_f32_16x16x32_bf16 v[32:35], v[128:131], a[120:123], v[32:35]
    v_mfma_f32_16x16x32_bf16 v[36:39], v[132:135], a[120:123], v[36:39]
    ds_write_b128 v12, v[52:55] offset:128
    v_mfma_f32_16x16x32_bf16 v[40:43], v[136:139], a[120:123], v[40:43]
    s_waitcnt vmcnt(13)
    v_mfma_f32_16x16x32_bf16 v[24:27], v[140:143], a[124:127], v[24:27]
    ds_write_b128 v12, v[56:59] offset:192
    v_mfma_f32_16x16x32_bf16 v[28:31], v[144:147], a[124:127], v[28:31]
    v_mfma_f32_16x16x32_bf16 v[32:35], v[148:151], a[124:127], v[32:35]
    ds_write_b128 v12, v[60:63] offset:256
    v_mfma_f32_16x16x32_bf16 v[36:39], v[152:155], a[124:127], v[36:39]
    v_mfma_f32_16x16x32_bf16 v[40:43], v[156:159], a[124:127], v[40:43]
    v_mfma_f32_16x16x32_bf16 v[24:27], a[164:167], a[128:131], v[24:27]
    s_waitcnt lgkmcnt(0)
    s_barrier
    v_mfma_f32_16x16x32_bf16 v[28:31], a[168:171], a[128:131], v[28:31]
    ds_read_b128 v[64:67], v13 offset:0
    ds_read_b128 v[68:71], v13 offset:16
    v_mfma_f32_16x16x32_bf16 v[32:35], a[172:175], a[128:131], v[32:35]
    ds_read_b128 v[72:75], v13 offset:5376
    ds_read_b128 v[76:79], v13 offset:5392
    v_mfma_f32_16x16x32_bf16 v[36:39], a[176:179], a[128:131], v[36:39]
    ds_read_b128 v[80:83], v13 offset:10752
    ds_read_b128 v[84:87], v13 offset:10768
    v_mfma_f32_16x16x32_bf16 v[40:43], a[180:183], a[128:131], v[40:43]
    ds_read_b128 v[88:91], v13 offset:16128
    s_waitcnt vmcnt(11)
    v_mfma_f32_16x16x32_bf16 v[24:27], a[184:187], a[132:135], v[24:27]
    ds_read_b128 v[92:95], v13 offset:16144
    v_mfma_f32_16x16x32_bf16 v[28:31], a[188:191], a[132:135], v[28:31]
    v_mfma_f32_16x16x32_bf16 v[32:35], a[192:195], a[132:135], v[32:35]
    v_mfma_f32_16x16x32_bf16 v[36:39], a[196:199], a[132:135], v[36:39]
    v_mfma_f32_16x16x32_bf16 v[40:43], a[200:203], a[132:135], v[40:43]
    v_mfma_f32_16x16x32_bf16 v[24:27], a[204:207], a[136:139], v[24:27]
    v_mfma_f32_16x16x32_bf16 v[28:31], a[208:211], a[136:139], v[28:31]
    s_waitcnt lgkmcnt(4)
    v_add_f32 v96, v96, v64
    v_add_f32 v97, v97, v65
    v_mfma_f32_16x16x32_bf16 v[32:35], a[212:215], a[136:139], v[32:35]
    v_add_f32 v98, v98, v66
    v_add_f32 v99, v99, v67
    v_mfma_f32_16x16x32_bf16 v[36:39], a[216:219], a[136:139], v[36:39]
    v_add_f32 v100, v100, v68
    v_add_f32 v101, v101, v69
    v_mfma_f32_16x16x32_bf16 v[40:43], a[220:223], a[136:139], v[40:43]
    v_add_f32 v102, v102, v70
    s_waitcnt vmcnt(9)
    v_mfma_f32_16x16x32_bf16 v[24:27], a[224:227], a[140:143], v[24:27]
    v_add_f32 v103, v103, v71
    v_add_f32 v96, v96, v72
    v_mfma_f32_16x16x32_bf16 v[28:31], v[160:163], a[140:143], v[28:31]
    v_add_f32 v97, v97, v73
    v_add_f32 v98, v98, v74
    v_mfma_f32_16x16x32_bf16 v[32:35], v[164:167], a[140:143], v[32:35]
    v_add_f32 v99, v99, v75
    v_add_f32 v100, v100, v76
    v_mfma_f32_16x16x32_bf16 v[36:39], v[168:171], a[140:143], v[36:39]
    v_add_f32 v101, v101, v77
    v_add_f32 v102, v102, v78
    v_mfma_f32_16x16x32_bf16 v[40:43], v[172:175], a[140:143], v[40:43]
    v_add_f32 v103, v103, v79
    s_waitcnt lgkmcnt(0)
    v_add_f32 v96, v96, v80
    v_mfma_f32_16x16x32_bf16 v[24:27], v[176:179], a[144:147], v[24:27]
    v_add_f32 v97, v97, v81
    v_add_f32 v98, v98, v82
    v_mfma_f32_16x16x32_bf16 v[28:31], v[180:183], a[144:147], v[28:31]
    v_add_f32 v99, v99, v83
    v_add_f32 v100, v100, v84
    v_mfma_f32_16x16x32_bf16 v[32:35], v[184:187], a[144:147], v[32:35]
    v_add_f32 v101, v101, v85
    v_add_f32 v102, v102, v86
    v_mfma_f32_16x16x32_bf16 v[36:39], v[188:191], a[144:147], v[36:39]
    v_add_f32 v103, v103, v87
    v_add_f32 v96, v96, v88
    v_mfma_f32_16x16x32_bf16 v[40:43], v[192:195], a[144:147], v[40:43]
    v_add_f32 v97, v97, v89
    s_waitcnt vmcnt(6)
    v_mfma_f32_16x16x32_bf16 v[24:27], v[196:199], a[148:151], v[24:27]
    v_add_f32 v98, v98, v90
    v_add_f32 v99, v99, v91
    v_mfma_f32_16x16x32_bf16 v[28:31], v[200:203], a[148:151], v[28:31]
    v_add_f32 v100, v100, v92
    v_add_f32 v101, v101, v93
    v_mfma_f32_16x16x32_bf16 v[32:35], v[204:207], a[148:151], v[32:35]
    v_add_f32 v102, v102, v94
    v_add_f32 v103, v103, v95
    v_mfma_f32_16x16x32_bf16 v[36:39], v[208:211], a[148:151], v[36:39]
    v_cvt_pk_bf16_f32 v104, v96, v97
    v_cvt_pk_bf16_f32 v105, v98, v99
    v_mfma_f32_16x16x32_bf16 v[40:43], v[212:215], a[148:151], v[40:43]
    v_cvt_pk_bf16_f32 v106, v100, v101
    v_cvt_pk_bf16_f32 v107, v102, v103
    v_mfma_f32_16x16x32_bf16 v[24:27], v[216:219], a[152:155], v[24:27]
    s_add_u32 s65, s92, 1310720
    buffer_store_dwordx4 v[104:107], v15, s[28:31], s65 offen nt
    v_mfma_f32_16x16x32_bf16 v[28:31], v[220:223], a[152:155], v[28:31]
    s_nop 0
    ds_read_b128 v[104:107], v14 offset:7680
    v_mfma_f32_16x16x32_bf16 v[32:35], v[224:227], a[152:155], v[32:35]
    v_mfma_f32_16x16x32_bf16 v[36:39], v[228:231], a[152:155], v[36:39]
    v_mfma_f32_16x16x32_bf16 v[40:43], v[232:235], a[152:155], v[40:43]
    s_waitcnt vmcnt(1)
    v_mfma_f32_16x16x32_bf16 v[24:27], v[236:239], a[156:159], v[24:27]
    v_mfma_f32_16x16x32_bf16 v[24:27], a[0:3], v[112:115], v[24:27]
    v_mfma_f32_16x16x32_bf16 v[24:27], a[20:23], v[116:119], v[24:27]
    s_waitcnt lgkmcnt(0)
    v_lshlrev_b32 v96, 16, v104
    v_and_b32 v97, s73, v104
    v_mfma_f32_16x16x32_bf16 v[24:27], a[40:43], v[120:123], v[24:27]
    v_lshlrev_b32 v98, 16, v105
    v_and_b32 v99, s73, v105
    v_mfma_f32_16x16x32_bf16 v[28:31], v[240:243], a[156:159], v[28:31]
    v_lshlrev_b32 v100, 16, v106
    v_and_b32 v101, s73, v106
    v_mfma_f32_16x16x32_bf16 v[28:31], a[4:7], v[112:115], v[28:31]
    v_lshlrev_b32 v102, 16, v107
    v_and_b32 v103, s73, v107
    v_mfma_f32_16x16x32_bf16 v[28:31], a[24:27], v[116:119], v[28:31]
    v_mfma_f32_16x16x32_bf16 v[28:31], a[44:47], v[120:123], v[28:31]
    ds_write_b128 v12, v[24:27] offset:21504
    v_mfma_f32_16x16x32_bf16 v[32:35], v[244:247], a[156:159], v[32:35]
    v_mfma_f32_16x16x32_bf16 v[32:35], a[8:11], v[112:115], v[32:35]
    v_mfma_f32_16x16x32_bf16 v[32:35], a[28:31], v[116:119], v[32:35]
    v_mfma_f32_16x16x32_bf16 v[32:35], a[48:51], v[120:123], v[32:35]
    s_nop 2
    ds_write_b128 v12, v[28:31] offset:21568
    v_mfma_f32_16x16x32_bf16 v[36:39], v[248:251], a[156:159], v[36:39]
    v_mfma_f32_16x16x32_bf16 v[36:39], a[12:15], v[112:115], v[36:39]
    v_mfma_f32_16x16x32_bf16 v[36:39], a[32:35], v[116:119], v[36:39]
    v_mfma_f32_16x16x32_bf16 v[36:39], a[52:55], v[120:123], v[36:39]
    ds_write_b128 v12, v[32:35] offset:21632
    v_mfma_f32_16x16x32_bf16 v[40:43], v[252:255], a[156:159], v[40:43]
    v_mfma_f32_16x16x32_bf16 v[40:43], a[16:19], v[112:115], v[40:43]
    v_mfma_f32_16x16x32_bf16 v[40:43], a[36:39], v[116:119], v[40:43]
    v_mfma_f32_16x16x32_bf16 v[40:43], a[56:59], v[120:123], v[40:43]
    s_nop 2
    ds_write_b128 v12, v[36:39] offset:21696
    s_nop 3
    ds_write_b128 v12, v[40:43] offset:21760
    s_waitcnt lgkmcnt(0)
    s_barrier
    ds_read_b128 v[64:67], v13 offset:21504
    ds_read_b128 v[68:71], v13 offset:21520
    ds_read_b128 v[72:75], v13 offset:26880
    ds_read_b128 v[76:79], v13 offset:26896
    ds_read_b128 v[80:83], v13 offset:32256
    ds_read_b128 v[84:87], v13 offset:32272
    ds_read_b128 v[88:91], v13 offset:37632
    ds_read_b128 v[92:95], v13 offset:37648
    s_waitcnt lgkmcnt(7)
    v_pk_add_f32 v[96:97], v[96:97], v[64:65]
    v_pk_add_f32 v[98:99], v[98:99], v[66:67]
    s_waitcnt lgkmcnt(6)
    v_pk_add_f32 v[100:101], v[100:101], v[68:69]
    v_pk_add_f32 v[102:103], v[102:103], v[70:71]
    s_waitcnt lgkmcnt(5)
    v_pk_add_f32 v[96:97], v[96:97], v[72:73]
    v_pk_add_f32 v[98:99], v[98:99], v[74:75]
    s_waitcnt lgkmcnt(4)
    v_pk_add_f32 v[100:101], v[100:101], v[76:77]
    v_pk_add_f32 v[102:103], v[102:103], v[78:79]
    s_waitcnt lgkmcnt(2)
    v_pk_add_f32 v[96:97], v[96:97], v[80:81]
    v_pk_add_f32 v[98:99], v[98:99], v[82:83]
    v_pk_add_f32 v[100:101], v[100:101], v[84:85]
    v_pk_add_f32 v[102:103], v[102:103], v[86:87]
    s_waitcnt lgkmcnt(0)
    v_pk_add_f32 v[96:97], v[96:97], v[88:89]
    v_pk_add_f32 v[98:99], v[98:99], v[90:91]
    v_pk_add_f32 v[100:101], v[100:101], v[92:93]
    v_pk_add_f32 v[102:103], v[102:103], v[94:95]
    v_cvt_pk_bf16_f32 v104, v96, v97
    v_cvt_pk_bf16_f32 v105, v98, v99
    v_cvt_pk_bf16_f32 v106, v100, v101
    v_cvt_pk_bf16_f32 v107, v102, v103
    s_add_u32 s65, s92, 1966080
    buffer_store_dwordx4 v[104:107], v15, s[28:31], s65 offen nt
    s_nop 1
L_end:
    s_endpgm
L_addr3:
    s_mul_i32 s94, s62, 20480
    s_add_u32 s94, s94, 20295680
    v_mov_b32 v20, 1073741824
    v_and_b32 v30, 3, v1
    v_lshlrev_b32 v30, 3, v30
    v_bfe_u32 v29, v1, 4, 1
    s_mul_i32 s91, s60, 458752
    s_add_u32 s91, s91, 7864320
    s_lshr_b32 s68, s62, 2
    s_lshl_b32 s89, s60, 11
    s_add_u32 s89, s89, 17563648
    s_lshl_b32 s69, s68, 7
    s_add_u32 s88, s89, s69
    s_lshl_b32 s69, s56, 7
    s_add_u32 s89, s89, s69
    s_mul_i32 s68, s68, 14336
    s_add_u32 s90, s91, s68
    s_and_b32 s68, s62, 3
    s_lshl_b32 s68, s68, 9
    s_add_u32 s68, s68, 12288
    s_add_u32 s90, s90, s68
    v_lshrrev_b32 v2, 2, v1
    v_lshl_add_u32 v2, v2, 6, v30
    v_lshl_add_u32 v2, v29, 5, v2
    v_xor_b32 v3, 32, v2
    v_mov_b32 v5, 0x3f80
    v_and_b32 v28, 15, v1
    v_lshlrev_b32 v6, 5, v28
    v_add_u32 v6, 158720, v6
    v_lshl_add_u32 v10, v29, 9, v6
    v_mov_b32 v30, 160768
    v_cmp_le_u32 s[82:83], 48, v1
    s_nop 1
    v_cndmask_b32 v7, v30, v6, s[82:83]
    v_lshrrev_b32 v29, 4, v1
    v_lshrrev_b32 v28, 2, v28
    v_cmp_eq_u32 vcc, v28, v29
    s_nop 1
    v_cndmask_b32 v8, v30, v6, vcc
    v_and_b32 v28, 3, v1
    v_cmp_eq_u32 s[76:77], 1, v28
    v_cmp_eq_u32 s[78:79], 2, v28
    v_cmp_eq_u32 s[80:81], 3, v28
    v_add_u32 v2, 117760, v2
    v_add_u32 v3, 117760, v3
    s_nop 1
    s_branch L_addr_c
L_stats:
    v_and_b32 v1, 63, v0
    v_lshrrev_b32 v2, 6, v0
    s_mov_b32 s10, 2621440
    s_mov_b32 s11, 0x20000
    s_mov_b64 s[6:7], s[10:11]
    v_readfirstlane_b32 s56, v2
    s_and_b32 s57, s2, 7
    s_and_b32 s70, s2, 31
    s_lshr_b32 s65, s70, 3
    s_lshl_b32 s65, s65, 1
    s_and_b32 s66, s70, 1
    s_add_u32 s65, s65, s66
    s_lshl_b32 s65, s65, 2
    s_add_u32 s65, s65, s56
    s_lshl_b32 s65, s65, 4
    s_and_b32 s66, s70, 6
    s_add_u32 s65, s65, s66
    s_mul_i32 s65, s65, 2560
    v_lshrrev_b32 v76, 5, v1
    v_bfe_u32 v78, v1, 3, 2
    v_lshl_add_u32 v76, v76, 4, v78
    v_mul_u32_u24 v76, 1280, v76
    v_and_b32 v81, 7, v1
    v_lshl_add_u32 v76, v81, 4, v76
    s_mul_i32 s66, s56, 10272
    s_waitcnt lgkmcnt(0)
    s_add_u32 m0, s66, 49152
    s_nop 0
    buffer_load_dwordx4 v76, s[4:7], s65 offen offset:0 lds
    s_add_u32 m0, s66, 50048
    s_nop 0
    buffer_load_dwordx4 v76, s[4:7], s65 offen offset:128 lds
    s_add_u32 m0, s66, 50944
    s_nop 0
    buffer_load_dwordx4 v76, s[4:7], s65 offen offset:256 lds
    s_add_u32 m0, s66, 51840
    s_nop 0
    buffer_load_dwordx4 v76, s[4:7], s65 offen offset:384 lds
    s_add_u32 m0, s66, 52736
    s_nop 0
    buffer_load_dwordx4 v76, s[4:7], s65 offen offset:512 lds
    s_add_u32 m0, s66, 53632
    s_nop 0
    buffer_load_dwordx4 v76, s[4:7], s65 offen offset:640 lds
    s_add_u32 m0, s66, 54528
    s_nop 0
    buffer_load_dwordx4 v76, s[4:7], s65 offen offset:768 lds
    s_add_u32 m0, s66, 55424
    s_nop 0
    buffer_load_dwordx4 v76, s[4:7], s65 offen offset:896 lds
    s_add_u32 m0, s66, 56320
    s_nop 0
    buffer_load_dwordx4 v76, s[4:7], s65 offen offset:1024 lds
    s_add_u32 m0, s66, 57216
    s_nop 0
    buffer_load_dwordx4 v76, s[4:7], s65 offen offset:1152 lds
    s_load_dwordx2 s[24:25], s[0:1], 72
    s_load_dwordx2 s[48:49], s[0:1], 80
    s_mov_b32 s26, 2211840
    s_mov_b32 s27, s11
    s_mov_b32 s50, 1280
    s_mov_b32 s51, s11
    s_mov_b32 s41, s70
    s_mov_b32 s3, 1
    s_branch L_addr
L_addr_r1:
    s_mov_b32 s15, 17683456
L_xjob:
    s_mul_i32 s65, s56, 5
    s_and_b32 s66, s65, 1
    s_lshr_b32 s65, s65, 1
    s_lshl_b32 s65, s65, 10
    s_lshl_b32 s68, s66, 6
    s_add_u32 s65, s65, s68
    s_add_u32 s65, s65, 49152
    s_mul_i32 s66, s66, 896
    s_add_u32 s66, s66, 64
    v_lshrrev_b32 v124, 4, v1
    v_mul_u32_u24 v124, 10272, v124
    v_bfe_u32 v125, v1, 2, 2
    v_lshl_add_u32 v124, v125, 7, v124
    v_and_b32 v125, 3, v1
    v_lshl_add_u32 v124, v125, 3, v124
    v_add_u32 v124, s65, v124
    v_add_u32 v125, s66, v124
    s_mul_i32 s66, s56, 10272
    s_add_u32 s66, s66, 49152
    v_add_u32 v126, s66, v4
    v_add_u32 v78, s70, v1
    v_and_b32 v78, 3, v78
    v_lshrrev_b32 v79, 4, v1
    v_lshl_add_u32 v78, v78, 2, v79
    v_bfe_u32 v79, v1, 2, 2
    v_lshl_add_u32 v78, v79, 10, v78
    v_lshlrev_b32 v83, 4, v78
    v_mov_b32 v72, 0
    v_mov_b32 v73, 0
    v_mov_b32 v74, 0
    v_mov_b32 v75, 0
    v_bfe_u32 v78, v1, 2, 3
    v_lshl_add_u32 v78, s70, 3, v78
    v_lshlrev_b32 v79, 7, v78
    v_lshlrev_b32 v78, 8, v78
    v_add_u32 v78, 32768, v78
    v_cmp_gt_u32 vcc, 32, v0
    s_nop 1
    v_cndmask_b32 v78, v78, v79, vcc
    v_and_b32 v79, 3, v1
    v_lshl_add_u32 v78, v79, 4, v78
    v_mov_b32 v80, 1073741824
    s_cmp_lt_u32 s70, 32
    s_cselect_b32 s65, 64, 0
    s_cselect_b32 s67, 0, 27648
    v_cmp_gt_u32 vcc, s65, v0
    s_nop 1
    v_cndmask_b32 v78, v80, v78, vcc
    s_mov_b32 s65, 17563648
    buffer_store_dwordx4 v[72:75], v78, s[32:35], s65 offen sc1
    v_lshrrev_b32 v78, 3, v0
    v_lshlrev_b32 v78, 2, v78
    v_bfe_u32 v79, v1, 2, 1
    v_lshl_add_u32 v78, v79, 7, v78
    v_add_u32 v78, 98304, v78
    s_and_b32 s65, s58, 3
    s_lshl_b32 s65, s65, 8
    s_add_u32 s65, s65, s67
    s_add_u32 s65, s65, 17667072
    s_lshl_b32 s19, s56, 10
    s_add_u32 s19, s19, s65
    v_mov_b32 v80, 1073741824
    v_lshlrev_b32 v76, 2, v1
    v_lshrrev_b32 v81, 5, v1
    v_and_b32 v82, 127, v76
    v_lshl_add_u32 v82, v81, 10, v82
    v_cmp_gt_u32 vcc, 64, v0
    s_nop 1
    v_cndmask_b32 v82, v80, v82, vcc
    v_add_u32 v76, 98304, v76
    s_mul_i32 s69, s56, 655360
    s_lshl_b32 s68, s70, 8
    s_add_u32 s69, s69, s68
    s_lshr_b32 s65, s70, 3
    s_lshl_b32 s65, s65, 10
    s_lshl_b32 s68, s70, 7
    s_add_u32 s65, s65, s68
    s_add_u32 s65, s65, 17498112
    s_mov_b32 s68, 0x3f803f80
    v_cmp_eq_u32 vcc, 0, v79
    s_cmp_ge_u32 s58, 24
    s_cbranch_scc1 L_xb
    s_waitcnt vmcnt(1)
L_xb:
        s_waitcnt vmcnt(11)
    s_barrier
    s_add_u32 s72, s101, 0
    buffer_load_dword v18, off, s[52:55], s72 sc1
    ds_read_b64_tr_b16 v[84:85], v124 offset:0
    ds_read_b64_tr_b16 v[86:87], v124 offset:512
    ds_read_b64_tr_b16 v[88:89], v124 offset:32
    ds_read_b64_tr_b16 v[90:91], v124 offset:544
    ds_read_b64_tr_b16 v[92:93], v125 offset:0
    ds_read_b64_tr_b16 v[94:95], v125 offset:512
    ds_read_b64_tr_b16 v[96:97], v125 offset:32
    ds_read_b64_tr_b16 v[98:99], v125 offset:544
    ds_read_b64_tr_b16 v[100:101], v124 offset:1024
    ds_read_b64_tr_b16 v[102:103], v124 offset:1536
    ds_read_b64_tr_b16 v[104:105], v124 offset:1056
    ds_read_b64_tr_b16 v[106:107], v124 offset:1568
    ds_read_b64_tr_b16 v[108:109], v125 offset:1024
    ds_read_b64_tr_b16 v[110:111], v125 offset:1536
    ds_read_b64_tr_b16 v[112:113], v125 offset:1056
    ds_read_b64_tr_b16 v[114:115], v125 offset:1568
    ds_read_b64_tr_b16 v[116:117], v124 offset:2048
    ds_read_b64_tr_b16 v[118:119], v124 offset:2560
    ds_read_b64_tr_b16 v[120:121], v124 offset:2080
    ds_read_b64_tr_b16 v[122:123], v124 offset:2592
    ds_read_b128 v[32:35], v126 offset:0
    ds_read_b128 v[36:39], v126 offset:1024
    ds_read_b128 v[40:43], v126 offset:2048
    ds_read_b128 v[44:47], v126 offset:3072
    ds_read_b128 v[48:51], v126 offset:4096
    ds_read_b128 v[52:55], v126 offset:5120
    ds_read_b128 v[56:59], v126 offset:6144
    ds_read_b128 v[60:63], v126 offset:7168
    ds_read_b128 v[64:67], v126 offset:8192
    ds_read_b128 v[68:71], v126 offset:9216
    s_add_u32 s66, s69, 2621440
    s_waitcnt lgkmcnt(0)
    buffer_store_dwordx4 v[84:87], v83, s[32:35], s66 offen sc1
    s_add_u32 s66, s69, 2686976
    buffer_store_dwordx4 v[88:91], v83, s[32:35], s66 offen sc1
    s_mov_b64 s[36:37], vcc
    s_waitcnt vmcnt(2)
    v_cmp_gt_u32 vcc, s100, v18
    s_nop 0
    s_cbranch_vccnz L_slow19
L_ret19:
    s_mov_b64 vcc, s[36:37]
    s_barrier
    s_cmp_lt_u32 s58, 24
    s_cbranch_scc1 L_xnoa
    s_cmp_ge_u32 s56, 2
    s_cbranch_scc1 L_nosig20
    s_atomic_add s12, s[32:33], s15 offset:0
L_nosig20:
L_xnoa:
    s_add_u32 s66, s69, 2752512
    buffer_store_dwordx4 v[92:95], v83, s[32:35], s66 offen sc1
    v_dot2_f32_bf16 v72, v32, s68, v72
    v_dot2_f32_bf16 v74, v32, v32, v74
    v_dot2_f32_bf16 v73, v33, s68, v73
    v_dot2_f32_bf16 v75, v33, v33, v75
    v_dot2_f32_bf16 v72, v34, s68, v72
    v_dot2_f32_bf16 v74, v34, v34, v74
    v_dot2_f32_bf16 v73, v35, s68, v73
    v_dot2_f32_bf16 v75, v35, v35, v75
    v_dot2_f32_bf16 v72, v36, s68, v72
    v_dot2_f32_bf16 v74, v36, v36, v74
    s_add_u32 s66, s69, 2818048
    buffer_store_dwordx4 v[96:99], v83, s[32:35], s66 offen sc1
    v_dot2_f32_bf16 v73, v37, s68, v73
    v_dot2_f32_bf16 v75, v37, v37, v75
    v_dot2_f32_bf16 v72, v38, s68, v72
    v_dot2_f32_bf16 v74, v38, v38, v74
    v_dot2_f32_bf16 v73, v39, s68, v73
    v_dot2_f32_bf16 v75, v39, v39, v75
    v_dot2_f32_bf16 v72, v40, s68, v72
    v_dot2_f32_bf16 v74, v40, v40, v74
    v_dot2_f32_bf16 v73, v41, s68, v73
    v_dot2_f32_bf16 v75, v41, v41, v75
    s_add_u32 s66, s69, 2883584
    buffer_store_dwordx4 v[100:103], v83, s[32:35], s66 offen sc1
    v_dot2_f32_bf16 v72, v42, s68, v72
    v_dot2_f32_bf16 v74, v42, v42, v74
    v_dot2_f32_bf16 v73, v43, s68, v73
    v_dot2_f32_bf16 v75, v43, v43, v75
    v_dot2_f32_bf16 v72, v44, s68, v72
    v_dot2_f32_bf16 v74, v44, v44, v74
    v_dot2_f32_bf16 v73, v45, s68, v73
    v_dot2_f32_bf16 v75, v45, v45, v75
    v_dot2_f32_bf16 v72, v46, s68, v72
    v_dot2_f32_bf16 v74, v46, v46, v74
    s_add_u32 s66, s69, 2949120
    buffer_store_dwordx4 v[104:107], v83, s[32:35], s66 offen sc1
    v_dot2_f32_bf16 v73, v47, s68, v73
    v_dot2_f32_bf16 v75, v47, v47, v75
    v_dot2_f32_bf16 v72, v48, s68, v72
    v_dot2_f32_bf16 v74, v48, v48, v74
    v_dot2_f32_bf16 v73, v49, s68, v73
    v_dot2_f32_bf16 v75, v49, v49, v75
    v_dot2_f32_bf16 v72, v50, s68, v72
    v_dot2_f32_bf16 v74, v50, v50, v74
    v_dot2_f32_bf16 v73, v51, s68, v73
    v_dot2_f32_bf16 v75, v51, v51, v75
    s_add_u32 s66, s69, 3014656
    buffer_store_dwordx4 v[108:111], v83, s[32:35], s66 offen sc1
    v_dot2_f32_bf16 v72, v52, s68, v72
    v_dot2_f32_bf16 v74, v52, v52, v74
    v_dot2_f32_bf16 v73, v53, s68, v73
    v_dot2_f32_bf16 v75, v53, v53, v75
    v_dot2_f32_bf16 v72, v54, s68, v72
    v_dot2_f32_bf16 v74, v54, v54, v74
    v_dot2_f32_bf16 v73, v55, s68, v73
    v_dot2_f32_bf16 v75, v55, v55, v75
    v_dot2_f32_bf16 v72, v56, s68, v72
    v_dot2_f32_bf16 v74, v56, v56, v74
    s_add_u32 s66, s69, 3080192
    buffer_store_dwordx4 v[112:115], v83, s[32:35], s66 offen sc1
    v_dot2_f32_bf16 v73, v57, s68, v73
    v_dot2_f32_bf16 v75, v57, v57, v75
    v_dot2_f32_bf16 v72, v58, s68, v72
    v_dot2_f32_bf16 v74, v58, v58, v74
    v_dot2_f32_bf16 v73, v59, s68, v73
    v_dot2_f32_bf16 v75, v59, v59, v75
    v_dot2_f32_bf16 v72, v60, s68, v72
    v_dot2_f32_bf16 v74, v60, v60, v74
    v_dot2_f32_bf16 v73, v61, s68, v73
    v_dot2_f32_bf16 v75, v61, v61, v75
    s_add_u32 s66, s69, 3145728
    buffer_store_dwordx4 v[116:119], v83, s[32:35], s66 offen sc1
    v_dot2_f32_bf16 v72, v62, s68, v72
    v_dot2_f32_bf16 v74, v62, v62, v74
    v_dot2_f32_bf16 v73, v63, s68, v73
    v_dot2_f32_bf16 v75, v63, v63, v75
    v_dot2_f32_bf16 v72, v64, s68, v72
    v_dot2_f32_bf16 v74, v64, v64, v74
    v_dot2_f32_bf16 v73, v65, s68, v73
    v_dot2_f32_bf16 v75, v65, v65, v75
    v_dot2_f32_bf16 v72, v66, s68, v72
    v_dot2_f32_bf16 v74, v66, v66, v74
    s_add_u32 s66, s69, 3211264
    buffer_store_dwordx4 v[120:123], v83, s[32:35], s66 offen sc1
    v_dot2_f32_bf16 v73, v67, s68, v73
    v_dot2_f32_bf16 v75, v67, v67, v75
    v_dot2_f32_bf16 v72, v68, s68, v72
    v_dot2_f32_bf16 v74, v68, v68, v74
    v_dot2_f32_bf16 v73, v69, s68, v73
    v_dot2_f32_bf16 v75, v69, v69, v75
    v_dot2_f32_bf16 v72, v70, s68, v72
    v_dot2_f32_bf16 v74, v70, v70, v74
    v_dot2_f32_bf16 v73, v71, s68, v73
    v_dot2_f32_bf16 v75, v71, v71, v75
    s_nop 1
    v_add_f32 v72, v72, v73
    v_add_f32 v74, v74, v75
    s_nop 0
    v_add_f32_dpp v72, v72, v72 quad_perm:[1,0,3,2] row_mask:0xf bank_mask:0xf
    v_add_f32_dpp v74, v74, v74 quad_perm:[1,0,3,2] row_mask:0xf bank_mask:0xf
    s_nop 0
    v_add_f32_dpp v72, v72, v72 quad_perm:[2,3,0,1] row_mask:0xf bank_mask:0xf
    v_add_f32_dpp v74, v74, v74 quad_perm:[2,3,0,1] row_mask:0xf bank_mask:0xf
    s_nop 0
    v_add_f32_dpp v72, v72, v72 row_half_mirror row_mask:0xf bank_mask:0xf
    v_add_f32_dpp v74, v74, v74 row_half_mirror row_mask:0xf bank_mask:0xf
    v_mul_f32 v72, 0x3acccccd, v72
    v_mul_f32 v74, 0x3acccccd, v74
    v_fma_f32 v74, -v72, v72, v74
    v_max_f32 v74, 0, v74
    v_add_f32 v74, 0x3727c5ac, v74
    v_rsq_f32 v74, v74
    s_nop 0
    v_mul_f32_e64 v72, -v72, v74
    v_cndmask_b32 v72, v72, v74, vcc
    ds_write_b32 v78, v72
    ds_read_b32 v16, v9
    s_waitcnt lgkmcnt(1)
    s_barrier
    ds_read_b32 v72, v76
    ds_read_b32 v16, v9
    s_waitcnt lgkmcnt(1)
    buffer_store_dword v72, v82, s[32:35], s65 offen sc1
    s_waitcnt vmcnt(0)
    v_cmp_gt_u32 vcc, s100, v18
    s_nop 0
    s_cbranch_vccnz L_slow21
L_ret21:
    s_barrier
    s_cmp_ge_u32 s56, 2
    s_cbranch_scc1 L_nosig22
    s_atomic_add s12, s[32:33], s19 offset:0
L_nosig22:
L_w2job:
    s_cmp_ge_u32 s41, 56
    s_cbranch_scc1 L_noconv
        s_waitcnt lgkmcnt(0)
    v_lshrrev_b32 v78, 3, v0
    v_lshl_add_u32 v77, s41, 5, v78
    s_cmp_lt_u32 s41, 48
    s_nop 0
    s_cbranch_scc1 L_w2reg0
    s_sub_u32 s65, s41, 48
    s_lshl_b32 s65, s65, 1
    s_and_b32 s66, s56, 1
    s_add_u32 s65, s65, s66
    s_mul_i32 s66, s65, 13108
    s_lshr_b32 s66, s66, 16
    s_lshl_b32 s66, s66, 2
    s_mul_i32 s68, s65, 12
    s_add_u32 s66, s66, s68
    s_add_u32 s66, s66, 1536
    s_lshr_b32 s68, s56, 1
    v_lshrrev_b32 v78, 3, v1
    v_lshl_add_u32 v78, s68, 3, v78
    v_add_u32 v77, s66, v78
    v_lshrrev_b32 v79, 2, v78
    v_mul_u32_u24 v79, 60, v79
    v_add_u32 v79, v79, v78
    v_add_u32 v79, 1596, v79
    s_cmp_eq_u32 s65, 15
    s_cselect_b64 vcc, -1, 0
    v_cndmask_b32 v77, v77, v79, vcc
    v_mov_b32 v79, 4096
    v_cmp_gt_u32 vcc, 12, v78
    s_nop 1
    v_cndmask_b32 v77, v79, v77, vcc
    s_nop 2
L_w2reg0:
    v_mul_u32_u24 v77, 1280, v77
    v_and_b32 v81, 7, v1
    v_lshl_add_u32 v77, v81, 4, v77
    s_add_u32 m0, s86, 117760
    s_nop 0
    buffer_load_dwordx4 v77, s[24:27], 0 offen offset:0 lds
    s_add_u32 m0, s86, 118656
    s_nop 0
    buffer_load_dwordx4 v77, s[24:27], 0 offen offset:128 lds
    s_add_u32 m0, s86, 119552
    s_nop 0
    buffer_load_dwordx4 v77, s[24:27], 0 offen offset:256 lds
    s_add_u32 m0, s86, 120448
    s_nop 0
    buffer_load_dwordx4 v77, s[24:27], 0 offen offset:384 lds
    s_add_u32 m0, s86, 121344
    s_nop 0
    buffer_load_dwordx4 v77, s[24:27], 0 offen offset:512 lds
    s_add_u32 m0, s86, 122240
    s_nop 0
    buffer_load_dwordx4 v77, s[24:27], 0 offen offset:640 lds
    s_add_u32 m0, s86, 123136
    s_nop 0
    buffer_load_dwordx4 v77, s[24:27], 0 offen offset:768 lds
    s_add_u32 m0, s86, 124032
    s_nop 0
    buffer_load_dwordx4 v77, s[24:27], 0 offen offset:896 lds
    s_add_u32 m0, s86, 124928
    s_nop 0
    buffer_load_dwordx4 v77, s[24:27], 0 offen offset:1024 lds
    s_add_u32 m0, s86, 125824
    s_nop 0
    buffer_load_dwordx4 v77, s[24:27], 0 offen offset:1152 lds
    v_lshlrev_b32 v78, 4, v0
    buffer_load_dwordx4 v[128:131], v78, s[48:51], 0 offen
    s_nop 1
L_w2conv:
    s_mul_i32 s65, s56, 5
    s_and_b32 s66, s65, 1
    s_lshr_b32 s65, s65, 1
    s_lshl_b32 s65, s65, 10
    s_lshl_b32 s68, s66, 6
    s_add_u32 s65, s65, s68
    s_add_u32 s65, s65, 117760
    s_mul_i32 s66, s66, 896
    s_add_u32 s66, s66, 64
    v_lshrrev_b32 v124, 5, v1
    v_mul_u32_u24 v124, 20480, v124
    v_bfe_u32 v125, v1, 2, 3
    v_lshl_add_u32 v124, v125, 7, v124
    v_and_b32 v125, 3, v1
    v_lshl_add_u32 v124, v125, 3, v124
    v_add_u32 v124, s65, v124
    v_add_u32 v125, s66, v124
    s_mul_i32 s65, s41, 5462
    s_lshr_b32 s65, s65, 16
    s_mul_i32 s66, s65, 12
    s_sub_u32 s66, s41, s66
    s_bfe_u32 s68, s41, 0x20001
    s_and_b32 s69, s41, 1
    s_add_u32 s69, s69, 12
    s_cmp_lt_u32 s41, 48
    s_cselect_b32 s65, s65, s68
    s_cselect_b32 s66, s66, s69
    s_lshl_b32 s68, s65, 8
    s_add_u32 s68, s68, 17675264
    s_lshl_b32 s40, s56, 10
    s_add_u32 s40, s40, s68
    s_lshl_b32 s68, s56, 3
    s_add_u32 s65, s65, s68
    s_mul_i32 s65, s65, 14
    s_add_u32 s65, s65, s66
    s_mul_i32 s65, s65, 5120
    s_waitcnt vmcnt(0)
    s_cmp_lg_u32 s56, 0
    s_cbranch_scc1 L_nochk23
    v_bfe_u32 v28, v1, 2, 1
    v_mad_u32_u24 v29, v28, 8, 8
    v_mul_u32_u24 v28, 16384, v28
    v_add_u32 v28, v28, v254
    s_add_u32 s72, s95, 17667072
    buffer_load_dword v18, v28, s[32:35], s72 offen sc1
    s_waitcnt vmcnt(0)
    v_cmp_gt_u32 vcc, v29, v18
    s_nop 0
    s_cbranch_vccnz L_slow24
L_ret24:
    s_nop 2
L_nochk23:
    s_barrier
    s_cmp_lg_u32 s43, 99
    s_cbranch_scc1 L_nosig25
    s_atomic_add s12, s[32:33], s42 offset:140288
L_nosig25:
L_w2nochk:
    s_cmp_lg_u32 s41, 48
    s_cbranch_scc1 L_nob2
    v_lshrrev_b32 v79, 3, v0
    v_and_b32 v80, 7, v0
    v_lshlrev_b32 v80, 4, v80
    v_lshl_add_u32 v79, v79, 10, v80
    v_add_u32 v79, 117760, v79
    v_mov_b32 v80, 142336
    v_cmp_gt_u32 vcc, 80, v0
    s_nop 1
    v_cndmask_b32 v79, v80, v79, vcc
    ds_write_b128 v79, v[128:131] offset:20992
    ds_read_b32 v16, v9
    s_waitcnt lgkmcnt(1)
    s_barrier
L_nob2:
    ds_read_b64_tr_b16 v[84:85], v124 offset:0
    ds_read_b64_tr_b16 v[86:87], v124 offset:10240
    ds_read_b64_tr_b16 v[88:89], v124 offset:32
    ds_read_b64_tr_b16 v[90:91], v124 offset:10272
    ds_read_b64_tr_b16 v[92:93], v125 offset:0
    ds_read_b64_tr_b16 v[94:95], v125 offset:10240
    ds_read_b64_tr_b16 v[96:97], v125 offset:32
    ds_read_b64_tr_b16 v[98:99], v125 offset:10272
    ds_read_b64_tr_b16 v[100:101], v124 offset:1024
    ds_read_b64_tr_b16 v[102:103], v124 offset:11264
    ds_read_b64_tr_b16 v[104:105], v124 offset:1056
    ds_read_b64_tr_b16 v[106:107], v124 offset:11296
    ds_read_b64_tr_b16 v[108:109], v125 offset:1024
    ds_read_b64_tr_b16 v[110:111], v125 offset:11264
    ds_read_b64_tr_b16 v[112:113], v125 offset:1056
    ds_read_b64_tr_b16 v[114:115], v125 offset:11296
    ds_read_b64_tr_b16 v[116:117], v124 offset:2048
    ds_read_b64_tr_b16 v[118:119], v124 offset:12288
    ds_read_b64_tr_b16 v[120:121], v124 offset:2080
    ds_read_b64_tr_b16 v[122:123], v124 offset:12320
    ds_read_b32 v16, v9
    s_add_u32 s66, s65, 15204352
    s_waitcnt lgkmcnt(13)
    buffer_store_dwordx4 v[84:87], v4, s[32:35], s66 offen sc1
    s_add_u32 s66, s65, 15205376
    buffer_store_dwordx4 v[88:91], v4, s[32:35], s66 offen sc1
    s_add_u32 s66, s65, 15206400
    buffer_store_dwordx4 v[92:95], v4, s[32:35], s66 offen sc1
    s_add_u32 s66, s65, 15207424
    s_waitcnt lgkmcnt(6)
    buffer_store_dwordx4 v[96:99], v4, s[32:35], s66 offen sc1
    s_add_u32 s66, s65, 15208448
    buffer_store_dwordx4 v[100:103], v4, s[32:35], s66 offen sc1
    s_add_u32 s66, s65, 15491072
    buffer_store_dwordx4 v[104:107], v4, s[32:35], s66 offen sc1
    s_add_u32 s66, s65, 15492096
    buffer_store_dwordx4 v[108:111], v4, s[32:35], s66 offen sc1
    s_add_u32 s66, s65, 15493120
    s_waitcnt lgkmcnt(1)
    buffer_store_dwordx4 v[112:115], v4, s[32:35], s66 offen sc1
    s_add_u32 s66, s65, 15494144
    buffer_store_dwordx4 v[116:119], v4, s[32:35], s66 offen sc1
    s_add_u32 s66, s65, 15495168
    s_waitcnt lgkmcnt(1)
    buffer_store_dwordx4 v[120:123], v4, s[32:35], s66 offen sc1
    s_add_u32 s69, s94, 0
    buffer_load_dwordx4 a[0:3], v20, s[32:35], s69 offen offset:0 sc1
    buffer_load_dwordx4 a[4:7], v20, s[32:35], s69 offen offset:1024 sc1
    buffer_load_dwordx4 a[8:11], v20, s[32:35], s69 offen offset:2048 sc1
    buffer_load_dwordx4 a[12:15], v20, s[32:35], s69 offen offset:3072 sc1
    s_add_u32 s69, s94, 4096
    buffer_load_dwordx4 a[16:19], v20, s[32:35], s69 offen offset:0 sc1
    buffer_load_dwordx4 a[20:23], v20, s[32:35], s69 offen offset:1024 sc1
    buffer_load_dwordx4 a[24:27], v20, s[32:35], s69 offen offset:2048 sc1
    buffer_load_dwordx4 a[28:31], v20, s[32:35], s69 offen offset:3072 sc1
    s_waitcnt vmcnt(8)
    s_barrier
    s_cmp_ge_u32 s56, 2
    s_cbranch_scc1 L_nosig26
    s_atomic_add s12, s[32:33], s40 offset:0
L_nosig26:
    s_branch L_w1rest
L_prep0:
    s_cmp_ge_u32 s58, 32
    s_cbranch_scc1 L_end2
    s_load_dwordx2 s[52:53], s[0:1], 96
    s_load_dwordx2 s[20:21], s[0:1], 56
    v_and_b32 v1, 63, v0
    v_lshrrev_b32 v2, 6, v0
    s_mov_b32 s10, 2621440
    s_mov_b32 s11, 0x20000
    s_mov_b32 s34, 20971520
    s_mov_b32 s35, s11
    s_mov_b32 s54, 256
    s_mov_b32 s55, s11
    s_mov_b32 s22, 2211840
    s_mov_b32 s23, s11
    v_readfirstlane_b32 s56, v2
    s_and_b32 s57, s2, 7
    s_cmp_lg_u32 s2, 255
    s_nop 1
    s_cbranch_scc1 L_noinit
    v_mov_b32 v40, 0
    v_mov_b32 v41, 0
    v_mov_b32 v42, 0
    v_mov_b32 v43, 0
    v_lshrrev_b32 v34, 2, v0
    v_and_b32 v35, 3, v0
    v_lshlrev_b32 v35, 4, v35
    v_lshl_add_u32 v34, v34, 8, v35
    s_mov_b32 s66, 17661952
    s_waitcnt lgkmcnt(0)
    buffer_store_dwordx4 v[40:43], v34, s[32:35], s66 offen sc1
    s_mov_b32 s66, 17678336
    buffer_store_dwordx4 v[40:43], v34, s[32:35], s66 offen sc1
    s_mov_b32 s66, 17694720
    buffer_store_dwordx4 v[40:43], v34, s[32:35], s66 offen sc1
    v_mov_b32 v35, 1
    v_min_u32 v36, 1, v0
    v_lshlrev_b32 v36, 30, v36
    s_waitcnt vmcnt(0) lgkmcnt(0)
    s_barrier
    buffer_store_dword v35, v36, s[52:55], 0 offen sc1
L_noinit:
    s_sub_u32 s59, s2, 192
    s_lshl_b32 s59, s59, 1
    s_cmp_lt_u32 s59, 120
    s_cselect_b32 s59, s59, 135
    s_sub_u32 s40, s2, 121
    s_cmp_ge_u32 s40, 120
    s_cselect_b32 s40, s40, 135
        s_waitcnt lgkmcnt(0)
    v_lshrrev_b32 v132, 3, v1
    v_mul_u32_u24 v132, 3456, v132
    v_and_b32 v133, 7, v1
    v_lshl_add_u32 v132, v133, 4, v132
    s_mul_i32 s75, s56, 12288
    s_cmp_lt_u32 s59, 135
    s_cselect_b32 s65, 0, 1073741824
    v_or_b32 v134, s65, v132
    s_add_u32 s69, s59, 0
    s_mul_i32 s68, s69, 13108
    s_lshr_b32 s68, s68, 16
    s_mul_i32 s67, s68, 5
    s_sub_u32 s69, s69, s67
    s_lshl_b32 s67, s69, 2
    s_add_u32 s67, s67, s56
    s_mul_i32 s65, s67, 110592
    s_lshl_b32 s66, s68, 7
    s_add_u32 s65, s65, s66
    s_add_u32 m0, s75, 0
    s_add_u32 s66, s65, 0
    buffer_load_dwordx4 v134, s[20:23], s66 offen lds
    s_add_u32 m0, s75, 1024
    s_add_u32 s66, s65, 27648
    buffer_load_dwordx4 v134, s[20:23], s66 offen lds
    s_add_u32 m0, s75, 2048
    s_add_u32 s66, s65, 55296
    buffer_load_dwordx4 v134, s[20:23], s66 offen lds
    s_add_u32 m0, s75, 3072
    s_add_u32 s66, s65, 82944
    buffer_load_dwordx4 v134, s[20:23], s66 offen lds
    s_add_u32 s69, s59, 1
    s_mul_i32 s68, s69, 13108
    s_lshr_b32 s68, s68, 16
    s_mul_i32 s67, s68, 5
    s_sub_u32 s69, s69, s67
    s_lshl_b32 s67, s69, 2
    s_add_u32 s67, s67, s56
    s_mul_i32 s65, s67, 110592
    s_lshl_b32 s66, s68, 7
    s_add_u32 s65, s65, s66
    s_add_u32 m0, s75, 4096
    s_add_u32 s66, s65, 0
    buffer_load_dwordx4 v134, s[20:23], s66 offen lds
    s_add_u32 m0, s75, 5120
    s_add_u32 s66, s65, 27648
    buffer_load_dwordx4 v134, s[20:23], s66 offen lds
    s_add_u32 m0, s75, 6144
    s_add_u32 s66, s65, 55296
    buffer_load_dwordx4 v134, s[20:23], s66 offen lds
    s_add_u32 m0, s75, 7168
    s_add_u32 s66, s65, 82944
    buffer_load_dwordx4 v134, s[20:23], s66 offen lds
    s_cmp_lt_u32 s40, 135
    s_cselect_b32 s65, 0, 1073741824
    v_or_b32 v134, s65, v132
    s_add_u32 s69, s40, 0
    s_mul_i32 s68, s69, 13108
    s_lshr_b32 s68, s68, 16
    s_mul_i32 s67, s68, 5
    s_sub_u32 s69, s69, s67
    s_lshl_b32 s67, s69, 2
    s_add_u32 s67, s67, s56
    s_mul_i32 s65, s67, 110592
    s_lshl_b32 s66, s68, 7
    s_add_u32 s65, s65, s66
    s_add_u32 m0, s75, 8192
    s_add_u32 s66, s65, 0
    buffer_load_dwordx4 v134, s[20:23], s66 offen lds
    s_add_u32 m0, s75, 9216
    s_add_u32 s66, s65, 27648
    buffer_load_dwordx4 v134, s[20:23], s66 offen lds
    s_add_u32 m0, s75, 10240
    s_add_u32 s66, s65, 55296
    buffer_load_dwordx4 v134, s[20:23], s66 offen lds
    s_add_u32 m0, s75, 11264
    s_add_u32 s66, s65, 82944
    buffer_load_dwordx4 v134, s[20:23], s66 offen lds
    s_load_dwordx2 s[24:25], s[0:1], 72
    s_load_dwordx2 s[48:49], s[0:1], 80
    s_mov_b64 s[6:7], s[10:11]
    s_mov_b32 s26, 2211840
    s_mov_b32 s27, s11
    s_mov_b32 s50, 1280
    s_mov_b32 s51, s11
    s_sub_u32 s70, s2, 160
    s_sub_u32 s41, s2, 192
    s_cmp_ge_u32 s58, 28
    s_cselect_b32 s41, s41, 56
    s_lshr_b32 s65, s70, 3
    s_lshl_b32 s65, s65, 1
    s_and_b32 s66, s70, 1
    s_add_u32 s65, s65, s66
    s_lshl_b32 s65, s65, 2
    s_add_u32 s65, s65, s56
    s_lshl_b32 s65, s65, 4
    s_and_b32 s66, s70, 6
    s_add_u32 s65, s65, s66
    s_mul_i32 s65, s65, 2560
    v_lshrrev_b32 v76, 5, v1
    v_bfe_u32 v78, v1, 3, 2
    v_lshl_add_u32 v76, v76, 4, v78
    v_mul_u32_u24 v76, 1280, v76
    v_and_b32 v81, 7, v1
    v_lshl_add_u32 v76, v81, 4, v76
    s_mul_i32 s66, s56, 10272
    s_add_u32 m0, s66, 49152
    s_nop 0
    buffer_load_dwordx4 v76, s[4:7], s65 offen offset:0 lds
    s_add_u32 m0, s66, 50048
    s_nop 0
    buffer_load_dwordx4 v76, s[4:7], s65 offen offset:128 lds
    s_add_u32 m0, s66, 50944
    s_nop 0
    buffer_load_dwordx4 v76, s[4:7], s65 offen offset:256 lds
    s_add_u32 m0, s66, 51840
    s_nop 0
    buffer_load_dwordx4 v76, s[4:7], s65 offen offset:384 lds
    s_add_u32 m0, s66, 52736
    s_nop 0
    buffer_load_dwordx4 v76, s[4:7], s65 offen offset:512 lds
    s_add_u32 m0, s66, 53632
    s_nop 0
    buffer_load_dwordx4 v76, s[4:7], s65 offen offset:640 lds
    s_add_u32 m0, s66, 54528
    s_nop 0
    buffer_load_dwordx4 v76, s[4:7], s65 offen offset:768 lds
    s_add_u32 m0, s66, 55424
    s_nop 0
    buffer_load_dwordx4 v76, s[4:7], s65 offen offset:896 lds
    s_add_u32 m0, s66, 56320
    s_nop 0
    buffer_load_dwordx4 v76, s[4:7], s65 offen offset:1024 lds
    s_add_u32 m0, s66, 57216
    s_nop 0
    buffer_load_dwordx4 v76, s[4:7], s65 offen offset:1152 lds
    s_mov_b32 s3, 2
    s_branch L_addr
L_addr_r2:
    s_and_b32 s65, s58, 3
    s_lshl_b32 s65, s65, 8
    s_add_u32 s65, s65, 17683456
    s_lshl_b32 s15, s56, 10
    s_add_u32 s15, s15, s65
    v_mov_b32 v140, 0x3f803f80
    v_mov_b32 v141, 0x3f803f80
    v_mov_b32 v142, 0x3f803f80
    v_mov_b32 v143, 0x3f803f80
    s_mul_i32 s75, s56, 12288
    v_and_b32 v133, 3, v1
    v_lshl_add_u32 v133, v133, 3, s75
    s_lshl_b32 s66, s56, 8
    s_add_u32 s74, s66, 158720
    s_waitcnt vmcnt(10)
    s_add_u32 s72, s101, 0
    buffer_load_dword v18, off, s[52:55], s72 sc1
    s_cmp_ge_u32 s59, 135
    s_cbranch_scc1 L_w1noreg
    v_lshrrev_b32 v132, 5, v1
    v_lshl_add_u32 v135, v132, 10, v133
    v_bfe_u32 v132, v1, 2, 2
    v_lshl_add_u32 v135, v132, 7, v135
    v_bfe_u32 v132, v1, 4, 1
    v_lshl_add_u32 v135, v132, 5, v135
    v_and_b32 v134, 31, v1
    v_lshl_add_u32 v132, v134, 2, s74
    ds_read_b64_tr_b16 v[176:177], v135 offset:0
    ds_read_b64_tr_b16 v[178:179], v135 offset:512
    ds_read_b64_tr_b16 v[180:181], v135 offset:64
    ds_read_b64_tr_b16 v[182:183], v135 offset:576
    ds_read_b64_tr_b16 v[184:185], v135 offset:2048
    ds_read_b64_tr_b16 v[186:187], v135 offset:2560
    ds_read_b64_tr_b16 v[188:189], v135 offset:2112
    ds_read_b64_tr_b16 v[190:191], v135 offset:2624
    s_waitcnt lgkmcnt(0)
    v_mfma_f32_32x32x16_bf16 v[144:159], v[140:143], v[176:179], 0
    v_mfma_f32_32x32x16_bf16 v[160:175], v[140:143], v[180:183], 0
    v_mfma_f32_32x32x16_bf16 v[144:159], v[140:143], v[184:187], v[144:159]
    v_mfma_f32_32x32x16_bf16 v[160:175], v[140:143], v[188:191], v[160:175]
    s_nop 10
    ds_write_b32 v132, v144 offset:0
    ds_write_b32 v132, v160 offset:128
    ds_read_b64_tr_b16 v[192:193], v135 offset:4096
    ds_read_b64_tr_b16 v[194:195], v135 offset:4608
    ds_read_b64_tr_b16 v[196:197], v135 offset:4160
    ds_read_b64_tr_b16 v[198:199], v135 offset:4672
    ds_read_b64_tr_b16 v[200:201], v135 offset:6144
    ds_read_b64_tr_b16 v[202:203], v135 offset:6656
    ds_read_b64_tr_b16 v[204:205], v135 offset:6208
    ds_read_b64_tr_b16 v[206:207], v135 offset:6720
    s_waitcnt lgkmcnt(6)
    v_mfma_f32_32x32x16_bf16 v[144:159], v[140:143], v[192:195], 0
    s_waitcnt lgkmcnt(4)
    v_mfma_f32_32x32x16_bf16 v[160:175], v[140:143], v[196:199], 0
    s_waitcnt lgkmcnt(2)
    v_mfma_f32_32x32x16_bf16 v[144:159], v[140:143], v[200:203], v[144:159]
    s_waitcnt lgkmcnt(0)
    v_mfma_f32_32x32x16_bf16 v[160:175], v[140:143], v[204:207], v[160:175]
    s_nop 9
    ds_write_b32 v132, v144 offset:1024
    s_nop 0
    ds_write_b32 v132, v160 offset:1152
    s_add_u32 s69, s59, 0
    s_mul_i32 s68, s69, 13108
    s_lshr_b32 s68, s68, 16
    s_mul_i32 s67, s68, 5
    s_sub_u32 s69, s69, s67
    s_lshl_b32 s67, s69, 2
    s_add_u32 s67, s67, s56
    s_mul_i32 s65, s68, 40
    s_add_u32 s65, s65, s67
    s_lshl_b32 s65, s65, 11
    s_add_u32 s66, s65, 18350080
    buffer_store_dwordx4 v[176:179], v4, s[32:35], s66 offen sc1
    s_add_u32 s66, s65, 18391040
    buffer_store_dwordx4 v[180:183], v4, s[32:35], s66 offen sc1
    s_add_u32 s66, s65, 18351104
    buffer_store_dwordx4 v[184:187], v4, s[32:35], s66 offen sc1
    s_add_u32 s66, s65, 18392064
    buffer_store_dwordx4 v[188:191], v4, s[32:35], s66 offen sc1
    s_add_u32 s69, s59, 1
    s_mul_i32 s68, s69, 13108
    s_lshr_b32 s68, s68, 16
    s_mul_i32 s67, s68, 5
    s_sub_u32 s69, s69, s67
    s_lshl_b32 s67, s69, 2
    s_add_u32 s67, s67, s56
    s_mul_i32 s65, s68, 40
    s_add_u32 s65, s65, s67
    s_lshl_b32 s65, s65, 11
    s_add_u32 s66, s65, 18350080
    buffer_store_dwordx4 v[192:195], v4, s[32:35], s66 offen sc1
    s_add_u32 s66, s65, 18391040
    buffer_store_dwordx4 v[196:199], v4, s[32:35], s66 offen sc1
    s_add_u32 s66, s65, 18351104
    buffer_store_dwordx4 v[200:203], v4, s[32:35], s66 offen sc1
    s_add_u32 s66, s65, 18392064
    buffer_store_dwordx4 v[204:207], v4, s[32:35], s66 offen sc1
    s_nop 1
L_w1noreg:
    s_cmp_ge_u32 s40, 135
    s_cbranch_scc1 L_w1norem
    s_add_u32 s69, s40, 0
    s_mul_i32 s68, s69, 13108
    s_lshr_b32 s68, s68, 16
    s_mul_i32 s67, s68, 5
    s_sub_u32 s69, s69, s67
    s_lshl_b32 s67, s69, 2
    s_add_u32 s67, s67, s56
    v_lshrrev_b32 v132, 2, v1
    v_lshl_add_u32 v135, v132, 7, v133
    v_lshl_add_u32 v136, v132, 7, s75
    ds_read_b64_tr_b16 v[208:209], v135 offset:8192
    ds_read_b64_tr_b16 v[210:211], v135 offset:10240
    ds_read_b64_tr_b16 v[212:213], v135 offset:8216
    ds_read_b64_tr_b16 v[214:215], v135 offset:10264
    ds_read_b64_tr_b16 v[216:217], v135 offset:8240
    ds_read_b64_tr_b16 v[218:219], v135 offset:10288
    ds_read_b64_tr_b16 v[220:221], v135 offset:8264
    ds_read_b64_tr_b16 v[222:223], v135 offset:10312
    ds_read_b64_tr_b16 v[224:225], v135 offset:8288
    ds_read_b64_tr_b16 v[226:227], v135 offset:10336
    ds_read_b64_tr_b16 v[228:229], v136 offset:8312
    ds_read_b64_tr_b16 v[230:231], v136 offset:10360
    s_sub_u32 s66, s68, 24
    v_and_b32 v134, 15, v1
    v_cmp_eq_u32 vcc, 12, v134
    s_nop 1
    v_cndmask_b32 v137, 0, v140, vcc
    v_lshrrev_b32 v132, 2, v134
    v_cmp_eq_u32 vcc, s66, v132
    v_mov_b32 v132, 1073741824
    s_nop 0
    v_cndmask_b32 v138, v132, v4, vcc
    v_lshl_add_u32 v132, v134, 2, s74
    v_mov_b32 v133, 160768
    v_cmp_gt_u32 vcc, 4, v134
    s_nop 1
    v_cndmask_b32 v139, v133, v132, vcc
    v_cmp_le_u32 vcc, 12, v134
    s_nop 1
    v_cndmask_b32 v138, v138, v4, vcc
    v_cndmask_b32 v132, v132, v133, vcc
    s_lshl_b32 s67, s67, 10
    s_mul_i32 s65, s66, 102400
    s_add_u32 s65, s65, s67
    s_waitcnt lgkmcnt(0)
    v_cndmask_b32 v208, v208, v137, vcc
    v_cndmask_b32 v209, v209, v137, vcc
    v_cndmask_b32 v210, v210, v137, vcc
    v_cndmask_b32 v211, v211, v137, vcc
    s_add_u32 s66, s65, 20316160
    buffer_store_dwordx4 v[208:211], v4, s[32:35], s66 offen sc1
    v_mfma_f32_16x16x32_bf16 v[144:147], v[140:143], v[208:211], 0
    v_cndmask_b32 v212, v212, v137, vcc
    v_cndmask_b32 v213, v213, v137, vcc
    v_cndmask_b32 v214, v214, v137, vcc
    v_cndmask_b32 v215, v215, v137, vcc
    s_add_u32 s66, s65, 20336640
    buffer_store_dwordx4 v[212:215], v4, s[32:35], s66 offen sc1
    v_mfma_f32_16x16x32_bf16 v[148:151], v[140:143], v[212:215], 0
    v_cndmask_b32 v216, v216, v137, vcc
    v_cndmask_b32 v217, v217, v137, vcc
    v_cndmask_b32 v218, v218, v137, vcc
    v_cndmask_b32 v219, v219, v137, vcc
    s_add_u32 s66, s65, 20357120
    buffer_store_dwordx4 v[216:219], v4, s[32:35], s66 offen sc1
    v_mfma_f32_16x16x32_bf16 v[152:155], v[140:143], v[216:219], 0
    v_cndmask_b32 v220, v220, v137, vcc
    v_cndmask_b32 v221, v221, v137, vcc
    v_cndmask_b32 v222, v222, v137, vcc
    v_cndmask_b32 v223, v223, v137, vcc
    s_add_u32 s66, s65, 20377600
    buffer_store_dwordx4 v[220:223], v4, s[32:35], s66 offen sc1
    v_mfma_f32_16x16x32_bf16 v[156:159], v[140:143], v[220:223], 0
    v_cndmask_b32 v224, v224, v137, vcc
    v_cndmask_b32 v225, v225, v137, vcc
    v_cndmask_b32 v226, v226, v137, vcc
    v_cndmask_b32 v227, v227, v137, vcc
    s_add_u32 s66, s65, 20398080
    buffer_store_dwordx4 v[224:227], v4, s[32:35], s66 offen sc1
    v_mfma_f32_16x16x32_bf16 v[160:163], v[140:143], v[224:227], 0
    v_cndmask_b32 v228, v228, v137, vcc
    v_cndmask_b32 v229, v229, v137, vcc
    v_cndmask_b32 v230, v230, v137, vcc
    v_cndmask_b32 v231, v231, v137, vcc
    s_add_u32 s66, s67, 20623360
    buffer_store_dwordx4 v[228:231], v138, s[32:35], s66 offen sc1
    v_mfma_f32_16x16x32_bf16 v[164:167], v[140:143], v[228:231], 0
    ds_write_b32 v132, v144 offset:2048
    ds_write_b32 v132, v148 offset:2096
    ds_write_b32 v132, v152 offset:2144
    ds_write_b32 v132, v156 offset:2192
    ds_write_b32 v132, v160 offset:2240
    s_nop 2
    ds_write_b32 v139, v164 offset:2288
L_w1norem:
        s_waitcnt lgkmcnt(0)
    s_barrier
    s_add_u32 s75, s59, s56
    s_cmp_lt_u32 s56, 2
    s_cselect_b32 s75, s75, s40
    s_cmp_lt_u32 s56, 3
    s_cselect_b32 s75, s75, 135
    s_add_u32 s69, s75, 0
    s_mul_i32 s68, s69, 13108
    s_lshr_b32 s68, s68, 16
    s_mul_i32 s67, s68, 5
    s_sub_u32 s69, s69, s67
    s_lshl_b32 s67, s69, 2
    s_add_u32 s67, s67, s56
    v_lshlrev_b32 v132, 2, v1
    s_lshl_b32 s65, s56, 10
    s_add_u32 s65, s65, 158720
    v_add_u32 v133, s65, v132
    ds_read_b32 v144, v133 offset:0
    ds_read_b32 v145, v133 offset:256
    ds_read_b32 v146, v133 offset:512
    ds_read_b32 v147, v133 offset:768
    s_cmp_lt_u32 s75, 135
    s_cselect_b32 s66, 0, 1073741824
    v_or_b32 v132, s66, v132
    s_lshl_b32 s65, s69, 13
    s_lshl_b32 s66, s68, 8
    s_add_u32 s66, s66, s65
    s_add_u32 s66, s66, 17514496
    s_waitcnt lgkmcnt(2)
    v_add_f32 v144, v144, v145
    s_waitcnt lgkmcnt(0)
    v_add_f32 v146, v146, v147
    v_add_f32 v144, v144, v146
    buffer_store_dword v144, v132, s[32:35], s66 offen sc1
    s_cmp_lt_u32 s58, 28
    s_cbranch_scc1 L_xjob
    s_waitcnt vmcnt(0)
    v_cmp_gt_u32 vcc, s100, v18
    s_nop 0
    s_cbranch_vccnz L_slow27
L_ret27:
    s_barrier
    s_cmp_ge_u32 s56, 2
    s_cbranch_scc1 L_nosig28
    s_atomic_add s12, s[32:33], s15 offset:0
L_nosig28:
    s_cmp_ge_u32 s58, 28
    s_cbranch_scc1 L_w2job
    s_branch L_xjob
L_end2:
    s_endpgm
L_noconv:
        s_waitcnt vmcnt(0) lgkmcnt(0)
    s_cmp_ge_u32 s58, 28
    s_cselect_b32 s75, s100, 0
    s_cbranch_scc0 L_nof1
    s_add_u32 s72, s42, 140288
    buffer_load_dword v18, off, s[32:35], s72 sc1
    s_waitcnt vmcnt(0)
    v_cmp_gt_u32 vcc, s75, v18
    s_nop 0
    s_cbranch_vccnz L_slow29
L_ret29:
    s_nop 2
L_nof1:
    s_cmp_lg_u32 s56, 0
    s_cbranch_scc1 L_nochk30
    v_bfe_u32 v28, v1, 2, 1
    v_mad_u32_u24 v29, v28, 8, 8
    v_mul_u32_u24 v28, 16384, v28
    v_add_u32 v28, v28, v254
    s_add_u32 s72, s95, 17667072
    buffer_load_dword v18, v28, s[32:35], s72 offen sc1
    s_waitcnt vmcnt(0)
    v_cmp_gt_u32 vcc, v29, v18
    s_nop 0
    s_cbranch_vccnz L_slow31
L_ret31:
    s_nop 2
L_nochk30:
    s_barrier
    s_cmp_lg_u32 s43, 99
    s_cbranch_scc1 L_nosig32
    s_atomic_add s12, s[32:33], s42 offset:140288
L_nosig32:
    s_add_u32 s69, s94, 0
    buffer_load_dwordx4 a[0:3], v20, s[32:35], s69 offen offset:0 sc1
    buffer_load_dwordx4 a[4:7], v20, s[32:35], s69 offen offset:1024 sc1
    buffer_load_dwordx4 a[8:11], v20, s[32:35], s69 offen offset:2048 sc1
    buffer_load_dwordx4 a[12:15], v20, s[32:35], s69 offen offset:3072 sc1
    s_add_u32 s69, s94, 4096
    buffer_load_dwordx4 a[16:19], v20, s[32:35], s69 offen offset:0 sc1
    buffer_load_dwordx4 a[20:23], v20, s[32:35], s69 offen offset:1024 sc1
    buffer_load_dwordx4 a[24:27], v20, s[32:35], s69 offen offset:2048 sc1
    buffer_load_dwordx4 a[28:31], v20, s[32:35], s69 offen offset:3072 sc1
L_w1rest:
    s_add_u32 s69, s94, 8192
    buffer_load_dwordx4 a[32:35], v20, s[32:35], s69 offen offset:0 sc1
    buffer_load_dwordx4 a[36:39], v20, s[32:35], s69 offen offset:1024 sc1
    buffer_load_dwordx4 a[40:43], v20, s[32:35], s69 offen offset:2048 sc1
    buffer_load_dwordx4 a[44:47], v20, s[32:35], s69 offen offset:3072 sc1
    s_add_u32 s69, s94, 12288
    buffer_load_dwordx4 a[48:51], v20, s[32:35], s69 offen offset:0 sc1
    buffer_load_dwordx4 a[52:55], v20, s[32:35], s69 offen offset:1024 sc1
    buffer_load_dwordx4 a[56:59], v20, s[32:35], s69 offen offset:2048 sc1
    buffer_load_dwordx4 a[60:63], v20, s[32:35], s69 offen offset:3072 sc1
    s_add_u32 s69, s94, 16384
    buffer_load_dwordx4 a[64:67], v20, s[32:35], s69 offen offset:0 sc1
    buffer_load_dwordx4 a[68:71], v20, s[32:35], s69 offen offset:1024 sc1
    buffer_load_dwordx4 a[72:75], v20, s[32:35], s69 offen offset:2048 sc1
    buffer_load_dwordx4 a[76:79], v20, s[32:35], s69 offen offset:3072 sc1
    s_add_u32 s69, s94, 20480
    buffer_load_dwordx4 a[80:83], v4, s[32:35], s69 offen offset:0 sc1
    buffer_load_dwordx4 a[84:87], v4, s[32:35], s69 offen offset:1024 sc1
    buffer_load_dwordx4 a[88:91], v4, s[32:35], s69 offen offset:2048 sc1
    buffer_load_dwordx4 a[92:95], v4, s[32:35], s69 offen offset:3072 sc1
    s_add_u32 s69, s94, 24576
    buffer_load_dwordx4 a[96:99], v4, s[32:35], s69 offen offset:0 sc1
    buffer_load_dwordx4 a[100:103], v4, s[32:35], s69 offen offset:1024 sc1
    buffer_load_dwordx4 a[104:107], v4, s[32:35], s69 offen offset:2048 sc1
    buffer_load_dwordx4 a[108:111], v4, s[32:35], s69 offen offset:3072 sc1
    s_add_u32 s69, s94, 28672
    buffer_load_dwordx4 a[112:115], v4, s[32:35], s69 offen offset:0 sc1
    buffer_load_dwordx4 a[116:119], v4, s[32:35], s69 offen offset:1024 sc1
    buffer_load_dwordx4 a[120:123], v4, s[32:35], s69 offen offset:2048 sc1
    buffer_load_dwordx4 a[124:127], v4, s[32:35], s69 offen offset:3072 sc1
    s_add_u32 s69, s94, 32768
    buffer_load_dwordx4 a[128:131], v4, s[32:35], s69 offen offset:0 sc1
    buffer_load_dwordx4 a[132:135], v4, s[32:35], s69 offen offset:1024 sc1
    buffer_load_dwordx4 a[136:139], v4, s[32:35], s69 offen offset:2048 sc1
    buffer_load_dwordx4 a[140:143], v4, s[32:35], s69 offen offset:3072 sc1
    s_add_u32 s69, s94, 36864
    buffer_load_dwordx4 a[144:147], v4, s[32:35], s69 offen offset:0 sc1
    buffer_load_dwordx4 a[148:151], v4, s[32:35], s69 offen offset:1024 sc1
    buffer_load_dwordx4 a[152:155], v4, s[32:35], s69 offen offset:2048 sc1
    buffer_load_dwordx4 a[156:159], v4, s[32:35], s69 offen offset:3072 sc1
    s_cmp_lg_u32 s56, 0
    s_cbranch_scc1 L_nopoll2
    s_mov_b32 s72, 17596416
    buffer_load_dword v18, v17, s[32:35], s72 offen sc1
    s_waitcnt vmcnt(0)
    v_cmp_gt_u32 vcc, 20, v18
    s_nop 0
    s_cbranch_vccnz L_slow33
L_ret33:
    s_nop 2
L_nopoll2:
    s_barrier
    s_add_u32 m0, s86, 117760
    s_add_u32 s66, s85, 0
    buffer_load_dwordx4 v4, s[32:35], s66 offen offset:0 sc1 lds
    buffer_load_dwordx4 v4, s[32:35], s66 offen offset:1024 sc1 lds
    buffer_load_dwordx4 v4, s[32:35], s66 offen offset:2048 sc1 lds
    buffer_load_dwordx4 v4, s[32:35], s66 offen offset:3072 sc1 lds
    s_add_u32 m0, s86, 121856
    s_add_u32 s66, s85, 4096
    buffer_load_dwordx4 v4, s[32:35], s66 offen offset:0 sc1 lds
    buffer_load_dwordx4 v4, s[32:35], s66 offen offset:1024 sc1 lds
    buffer_load_dwordx4 v4, s[32:35], s66 offen offset:2048 sc1 lds
    buffer_load_dwordx4 v4, s[32:35], s66 offen offset:3072 sc1 lds
    s_add_u32 m0, s86, 125952
    s_add_u32 s66, s85, 8192
    buffer_load_dwordx4 v4, s[32:35], s66 offen offset:0 sc1 lds
    buffer_load_dwordx4 v4, s[32:35], s66 offen offset:1024 sc1 lds
    s_branch L_g1
L_g1w3:
    s_mov_b32 s74, 0x2edbe6ff
    s_mov_b32 s19, 4
    v_mov_b32 v106, 0
    v_mov_b32 v107, 0
    v_mov_b32 v110, 0
    v_mov_b32 v111, 0
    s_mov_b64 s[16:17], 0
    s_load_dword s16, s[32:33], s18 offset:111616
    v_and_b32 v56, 15, v1
    s_mul_i32 s67, s62, 13108
    s_lshr_b32 s67, s67, 14
    s_and_b32 s67, s67, 12
    s_mul_i32 s68, s62, 12
    s_add_u32 s67, s67, s68
    s_cmp_eq_u32 s62, 15
    s_cselect_b32 s67, 60, s67
    s_cselect_b32 s68, 60, 0
    s_add_u32 s67, s67, 1536
    v_lshrrev_b32 v64, 2, v56
    v_mad_u32_u24 v56, v64, s68, v56
    v_add_u32 v56, s67, v56
    v_min_u32 v56, 1727, v56
    v_lshlrev_b32 v57, 1, v56
    v_lshlrev_b32 v56, 2, v56
    buffer_load_ushort v63, v57, s[44:47], 0 offen
    s_mov_b32 s67, 17514496
    buffer_load_dword v58, v56, s[32:35], s67 offen sc1
    s_mov_b32 s67, 17522688
    buffer_load_dword v59, v56, s[32:35], s67 offen sc1
    s_mov_b32 s67, 17530880
    buffer_load_dword v60, v56, s[32:35], s67 offen sc1
    s_mov_b32 s67, 17539072
    buffer_load_dword v61, v56, s[32:35], s67 offen sc1
    s_mov_b32 s67, 17547264
    buffer_load_dword v62, v56, s[32:35], s67 offen sc1
    s_waitcnt vmcnt(6)
    s_barrier
    s_cmp_lg_u32 s3, 0
    s_cbranch_scc1 L_nosig35
    s_cmp_ge_u32 s56, 2
    s_cbranch_scc1 L_nosig34
    s_atomic_add s12, s[32:33], s13 offset:16384
L_nosig34:
L_nosig35:
    ds_read_b64_tr_b16 v[72:73], v2 offset:0
    ds_read_b64_tr_b16 v[74:75], v2 offset:1024
    ds_read_b64_tr_b16 v[76:77], v3 offset:0
    ds_read_b64_tr_b16 v[78:79], v3 offset:1024
    ds_read_b64_tr_b16 v[80:81], v2 offset:2048
    ds_read_b64_tr_b16 v[82:83], v2 offset:3072
    ds_read_b64_tr_b16 v[84:85], v3 offset:2048
    ds_read_b64_tr_b16 v[86:87], v3 offset:3072
    ds_read_b64_tr_b16 v[88:89], v2 offset:4096
    ds_read_b64_tr_b16 v[90:91], v2 offset:5120
    ds_read_b64_tr_b16 v[92:93], v3 offset:4096
    ds_read_b64_tr_b16 v[94:95], v3 offset:5120
    ds_read_b64_tr_b16 v[96:97], v2 offset:6144
    ds_read_b64_tr_b16 v[98:99], v2 offset:7168
    s_waitcnt lgkmcnt(12)
    v_mfma_f32_16x16x32_bf16 v[24:27], a[80:83], v[72:75], 0
    ds_read_b64_tr_b16 v[100:101], v3 offset:6144
    ds_read_b64_tr_b16 v[102:103], v3 offset:7168
    v_mfma_f32_16x16x32_bf16 v[28:31], v[72:75], v[72:75], 0
    s_add_u32 m0, s86, 0
    s_add_u32 s66, s85, 40960
    buffer_load_dwordx4 v4, s[32:35], s66 offen offset:0 sc1 lds
    s_waitcnt lgkmcnt(8)
    v_mfma_f32_16x16x32_bf16 v[32:35], a[80:83], v[76:79], 0
    ds_read_b64_tr_b16 v[72:73], v2 offset:8192
    ds_read_b64_tr_b16 v[74:75], v2 offset:9216
    v_mfma_f32_16x16x32_bf16 v[36:39], v[76:79], v[76:79], 0
    buffer_load_dwordx4 v4, s[32:35], s66 offen offset:1024 sc1 lds
    v_mfma_f32_16x16x32_bf16 v[24:27], a[84:87], v[80:83], v[24:27]
    ds_read_b64_tr_b16 v[76:77], v3 offset:8192
    ds_read_b64_tr_b16 v[78:79], v3 offset:9216
    v_mfma_f32_16x16x32_bf16 v[28:31], v[80:83], v[80:83], v[28:31]
    v_mfma_f32_16x16x32_bf16 v[32:35], a[84:87], v[84:87], v[32:35]
    ds_read_b64_tr_b16 v[80:81], v2 offset:10240
    ds_read_b64_tr_b16 v[82:83], v2 offset:11264
    v_mfma_f32_16x16x32_bf16 v[36:39], v[84:87], v[84:87], v[36:39]
    buffer_load_dwordx4 v4, s[32:35], s66 offen offset:2048 sc1 lds
    s_waitcnt lgkmcnt(6)
    v_mfma_f32_16x16x32_bf16 v[24:27], a[88:91], v[88:91], v[24:27]
    ds_read_b64_tr_b16 v[84:85], v3 offset:10240
    ds_read_b64_tr_b16 v[86:87], v3 offset:11264
    v_mfma_f32_16x16x32_bf16 v[28:31], v[88:91], v[88:91], v[28:31]
    buffer_load_dwordx4 v4, s[32:35], s66 offen offset:3072 sc1 lds
    v_mfma_f32_16x16x32_bf16 v[32:35], a[88:91], v[92:95], v[32:35]
    ds_read_b64_tr_b16 v[88:89], v2 offset:12288
    ds_read_b64_tr_b16 v[90:91], v2 offset:13312
    v_mfma_f32_16x16x32_bf16 v[36:39], v[92:95], v[92:95], v[36:39]
    v_mfma_f32_16x16x32_bf16 v[24:27], a[92:95], v[96:99], v[24:27]
    ds_read_b64_tr_b16 v[92:93], v3 offset:12288
    ds_read_b64_tr_b16 v[94:95], v3 offset:13312
    v_mfma_f32_16x16x32_bf16 v[28:31], v[96:99], v[96:99], v[28:31]
    s_add_u32 m0, s86, 4096
    s_add_u32 s66, s85, 45056
    buffer_load_dwordx4 v4, s[32:35], s66 offen offset:0 sc1 lds
    v_mfma_f32_16x16x32_bf16 v[32:35], a[92:95], v[100:103], v[32:35]
    ds_read_b64_tr_b16 v[96:97], v2 offset:14336
    ds_read_b64_tr_b16 v[98:99], v2 offset:15360
    v_mfma_f32_16x16x32_bf16 v[36:39], v[100:103], v[100:103], v[36:39]
    buffer_load_dwordx4 v4, s[32:35], s66 offen offset:1024 sc1 lds
    s_waitcnt lgkmcnt(6)
    v_mfma_f32_16x16x32_bf16 v[24:27], a[96:99], v[72:75], v[24:27]
    ds_read_b64_tr_b16 v[100:101], v3 offset:14336
    ds_read_b64_tr_b16 v[102:103], v3 offset:15360
    v_mfma_f32_16x16x32_bf16 v[28:31], v[72:75], v[72:75], v[28:31]
    v_mfma_f32_16x16x32_bf16 v[32:35], a[96:99], v[76:79], v[32:35]
    ds_read_b64_tr_b16 v[72:73], v2 offset:16384
    ds_read_b64_tr_b16 v[74:75], v2 offset:17408
    v_mfma_f32_16x16x32_bf16 v[36:39], v[76:79], v[76:79], v[36:39]
    buffer_load_dwordx4 v4, s[32:35], s66 offen offset:2048 sc1 lds
    v_mfma_f32_16x16x32_bf16 v[24:27], a[100:103], v[80:83], v[24:27]
    ds_read_b64_tr_b16 v[76:77], v3 offset:16384
    ds_read_b64_tr_b16 v[78:79], v3 offset:17408
    v_mfma_f32_16x16x32_bf16 v[28:31], v[80:83], v[80:83], v[28:31]
    buffer_load_dwordx4 v4, s[32:35], s66 offen offset:3072 sc1 lds
    v_mfma_f32_16x16x32_bf16 v[32:35], a[100:103], v[84:87], v[32:35]
    ds_read_b64_tr_b16 v[80:81], v2 offset:18432
    ds_read_b64_tr_b16 v[82:83], v2 offset:19456
    v_mfma_f32_16x16x32_bf16 v[36:39], v[84:87], v[84:87], v[36:39]
    s_waitcnt lgkmcnt(6)
    v_mfma_f32_16x16x32_bf16 v[24:27], a[104:107], v[88:91], v[24:27]
    ds_read_b64_tr_b16 v[84:85], v3 offset:18432
    ds_read_b64_tr_b16 v[86:87], v3 offset:19456
    v_mfma_f32_16x16x32_bf16 v[28:31], v[88:91], v[88:91], v[28:31]
    s_add_u32 m0, s86, 8192
    s_add_u32 s66, s85, 49152
    buffer_load_dwordx4 v4, s[32:35], s66 offen offset:0 sc1 lds
    v_mfma_f32_16x16x32_bf16 v[32:35], a[104:107], v[92:95], v[32:35]
    ds_read_b64_tr_b16 v[88:89], v2 offset:20480
    ds_read_b64_tr_b16 v[90:91], v2 offset:21504
    v_mfma_f32_16x16x32_bf16 v[36:39], v[92:95], v[92:95], v[36:39]
    buffer_load_dwordx4 v4, s[32:35], s66 offen offset:1024 sc1 lds
    v_mfma_f32_16x16x32_bf16 v[24:27], a[108:111], v[96:99], v[24:27]
    ds_read_b64_tr_b16 v[92:93], v3 offset:20480
    ds_read_b64_tr_b16 v[94:95], v3 offset:21504
    v_mfma_f32_16x16x32_bf16 v[28:31], v[96:99], v[96:99], v[28:31]
    s_cmp_lt_u32 s16, 14
    s_cbranch_scc1 L_slow37
L_ret37:
    v_mfma_f32_16x16x32_bf16 v[32:35], a[108:111], v[100:103], v[32:35]
    ds_read_b64_tr_b16 v[96:97], v2 offset:22528
    ds_read_b64_tr_b16 v[98:99], v2 offset:23552
    v_mfma_f32_16x16x32_bf16 v[36:39], v[100:103], v[100:103], v[36:39]
    s_add_u32 s69, s87, 0
    buffer_load_dwordx4 a[228:231], v4, s[32:35], s69 offen offset:0 sc1
    s_waitcnt lgkmcnt(6)
    v_mfma_f32_16x16x32_bf16 v[24:27], a[112:115], v[72:75], v[24:27]
    ds_read_b64_tr_b16 v[100:101], v3 offset:22528
    ds_read_b64_tr_b16 v[102:103], v3 offset:23552
    v_mfma_f32_16x16x32_bf16 v[28:31], v[72:75], v[72:75], v[28:31]
    buffer_load_dwordx4 a[232:235], v4, s[32:35], s69 offen offset:1024 sc1
    v_mfma_f32_16x16x32_bf16 v[32:35], a[112:115], v[76:79], v[32:35]
    ds_read_b64_tr_b16 v[72:73], v2 offset:24576
    ds_read_b64_tr_b16 v[74:75], v2 offset:25600
    v_mfma_f32_16x16x32_bf16 v[36:39], v[76:79], v[76:79], v[36:39]
    v_mfma_f32_16x16x32_bf16 v[24:27], a[116:119], v[80:83], v[24:27]
    ds_read_b64_tr_b16 v[76:77], v3 offset:24576
    ds_read_b64_tr_b16 v[78:79], v3 offset:25600
    v_mfma_f32_16x16x32_bf16 v[28:31], v[80:83], v[80:83], v[28:31]
    buffer_load_dwordx4 a[236:239], v4, s[32:35], s69 offen offset:2048 sc1
    v_mfma_f32_16x16x32_bf16 v[32:35], a[116:119], v[84:87], v[32:35]
    ds_read_b64_tr_b16 v[80:81], v2 offset:26624
    ds_read_b64_tr_b16 v[82:83], v2 offset:27648
    v_mfma_f32_16x16x32_bf16 v[36:39], v[84:87], v[84:87], v[36:39]
    buffer_load_dwordx4 a[240:243], v4, s[32:35], s69 offen offset:3072 sc1
    s_waitcnt lgkmcnt(6)
    v_mfma_f32_16x16x32_bf16 v[24:27], a[120:123], v[88:91], v[24:27]
    ds_read_b64_tr_b16 v[84:85], v3 offset:26624
    ds_read_b64_tr_b16 v[86:87], v3 offset:27648
    v_mfma_f32_16x16x32_bf16 v[28:31], v[88:91], v[88:91], v[28:31]
    s_waitcnt vmcnt(17)
    v_add_f32 v58, v58, v59
    s_waitcnt vmcnt(16)
    v_add_f32 v58, v58, v60
    v_mfma_f32_16x16x32_bf16 v[32:35], a[120:123], v[92:95], v[32:35]
    ds_read_b64_tr_b16 v[88:89], v2 offset:28672
    ds_read_b64_tr_b16 v[90:91], v2 offset:29696
    v_mfma_f32_16x16x32_bf16 v[36:39], v[92:95], v[92:95], v[36:39]
    s_add_u32 s69, s87, 4096
    buffer_load_dwordx4 a[244:247], v4, s[32:35], s69 offen offset:0 sc1
    v_mfma_f32_16x16x32_bf16 v[24:27], a[124:127], v[96:99], v[24:27]
    ds_read_b64_tr_b16 v[92:93], v3 offset:28672
    ds_read_b64_tr_b16 v[94:95], v3 offset:29696
    v_mfma_f32_16x16x32_bf16 v[28:31], v[96:99], v[96:99], v[28:31]
    buffer_load_dwordx4 a[248:251], v4, s[32:35], s69 offen offset:1024 sc1
    s_waitcnt vmcnt(17)
    v_add_f32 v58, v58, v61
    v_mfma_f32_16x16x32_bf16 v[32:35], a[124:127], v[100:103], v[32:35]
    ds_read_b64_tr_b16 v[96:97], v2 offset:30720
    ds_read_b64_tr_b16 v[98:99], v2 offset:31744
    v_mfma_f32_16x16x32_bf16 v[36:39], v[100:103], v[100:103], v[36:39]
    s_waitcnt vmcnt(16)
    v_add_f32 v58, v58, v62
    s_waitcnt lgkmcnt(6)
    v_mfma_f32_16x16x32_bf16 v[24:27], a[128:131], v[72:75], v[24:27]
    ds_read_b64_tr_b16 v[100:101], v3 offset:30720
    ds_read_b64_tr_b16 v[102:103], v3 offset:31744
    v_mfma_f32_16x16x32_bf16 v[28:31], v[72:75], v[72:75], v[28:31]
    buffer_load_dwordx4 a[252:255], v4, s[32:35], s69 offen offset:2048 sc1
    v_mul_f32 v58, 0xbacccccd, v58
    v_mfma_f32_16x16x32_bf16 v[32:35], a[128:131], v[76:79], v[32:35]
    ds_read_b64_tr_b16 v[72:73], v2 offset:32768
    ds_read_b64_tr_b16 v[74:75], v2 offset:33792
    v_mfma_f32_16x16x32_bf16 v[36:39], v[76:79], v[76:79], v[36:39]
    buffer_load_dwordx4 v[128:131], v4, s[32:35], s69 offen offset:3072 sc1
    v_lshl_or_b32 v63, v63, 16, v63
    v_mfma_f32_16x16x32_bf16 v[24:27], a[132:135], v[80:83], v[24:27]
    ds_read_b64_tr_b16 v[76:77], v3 offset:32768
    ds_read_b64_tr_b16 v[78:79], v3 offset:33792
    v_mfma_f32_16x16x32_bf16 v[28:31], v[80:83], v[80:83], v[28:31]
    v_cmp_gt_u32 s[98:99], 16, v1
    v_and_b32 v64, s73, v58
    v_mfma_f32_16x16x32_bf16 v[32:35], a[132:135], v[84:87], v[32:35]
    ds_read_b64_tr_b16 v[80:81], v2 offset:34816
    ds_read_b64_tr_b16 v[82:83], v2 offset:35840
    v_mfma_f32_16x16x32_bf16 v[36:39], v[84:87], v[84:87], v[36:39]
    s_add_u32 s69, s87, 8192
    buffer_load_dwordx4 v[132:135], v4, s[32:35], s69 offen offset:0 sc1
    s_waitcnt lgkmcnt(6)
    v_mfma_f32_16x16x32_bf16 v[24:27], a[136:139], v[88:91], v[24:27]
    ds_read_b64_tr_b16 v[84:85], v3 offset:34816
    ds_read_b64_tr_b16 v[86:87], v3 offset:35840
    v_mfma_f32_16x16x32_bf16 v[28:31], v[88:91], v[88:91], v[28:31]
    buffer_load_dwordx4 v[136:139], v4, s[32:35], s69 offen offset:1024 sc1
    v_sub_f32 v58, v58, v64
    v_mfma_f32_16x16x32_bf16 v[32:35], a[136:139], v[92:95], v[32:35]
    ds_read_b64_tr_b16 v[88:89], v2 offset:36864
    ds_read_b64_tr_b16 v[90:91], v2 offset:37888
    v_mfma_f32_16x16x32_bf16 v[36:39], v[92:95], v[92:95], v[36:39]
    v_cndmask_b32 v63, 0, v63, s[98:99]
    v_cndmask_b32 v64, v58, v64, s[98:99]
    v_mfma_f32_16x16x32_bf16 v[24:27], a[140:143], v[96:99], v[24:27]
    ds_read_b64_tr_b16 v[92:93], v3 offset:36864
    ds_read_b64_tr_b16 v[94:95], v3 offset:37888
    v_mfma_f32_16x16x32_bf16 v[28:31], v[96:99], v[96:99], v[28:31]
    buffer_load_dwordx4 v[140:143], v4, s[32:35], s69 offen offset:2048 sc1
    v_cmp_gt_u32 s[98:99], 32, v1
    v_mfma_f32_16x16x32_bf16 v[32:35], a[140:143], v[100:103], v[32:35]
    ds_read_b64_tr_b16 v[96:97], v2 offset:38912
    ds_read_b64_tr_b16 v[98:99], v2 offset:39936
    v_mfma_f32_16x16x32_bf16 v[36:39], v[100:103], v[100:103], v[36:39]
    v_accvgpr_write_b32 a162, 0
    s_waitcnt lgkmcnt(6)
    v_mfma_f32_16x16x32_bf16 v[24:27], a[144:147], v[72:75], v[24:27]
    ds_read_b64_tr_b16 v[100:101], v3 offset:38912
    ds_read_b64_tr_b16 v[102:103], v3 offset:39936
    v_mfma_f32_16x16x32_bf16 v[28:31], v[72:75], v[72:75], v[28:31]
    buffer_load_dwordx4 v[144:147], v4, s[32:35], s69 offen offset:3072 sc1
    v_add_u32 v2, 4294849536, v2
    v_add_u32 v3, 4294849536, v3
    s_waitcnt vmcnt(12)
    s_barrier
    s_mov_b64 s[16:17], 0
    s_load_dword s16, s[32:33], s14 offset:16384
    s_load_dword s17, s[32:33], s14 offset:16640
    v_mfma_f32_16x16x32_bf16 v[32:35], a[144:147], v[76:79], v[32:35]
    ds_read_b64_tr_b16 v[72:73], v2 offset:0
    ds_read_b64_tr_b16 v[74:75], v2 offset:1024
    v_mfma_f32_16x16x32_bf16 v[36:39], v[76:79], v[76:79], v[36:39]
    s_add_u32 s69, s87, 12288
    buffer_load_dwordx4 v[148:151], v4, s[32:35], s69 offen offset:0 sc1
    v_mfma_f32_16x16x32_bf16 v[24:27], a[148:151], v[80:83], v[24:27]
    ds_read_b64_tr_b16 v[76:77], v3 offset:0
    ds_read_b64_tr_b16 v[78:79], v3 offset:1024
    v_mfma_f32_16x16x32_bf16 v[28:31], v[80:83], v[80:83], v[28:31]
    v_accvgpr_write_b32 a163, 0
    v_cndmask_b32 v64, 0, v64, s[98:99]
    v_mfma_f32_16x16x32_bf16 v[32:35], a[148:151], v[84:87], v[32:35]
    ds_read_b64_tr_b16 v[80:81], v2 offset:2048
    ds_read_b64_tr_b16 v[82:83], v2 offset:3072
    v_mfma_f32_16x16x32_bf16 v[36:39], v[84:87], v[84:87], v[36:39]
    buffer_load_dwordx4 v[152:155], v4, s[32:35], s69 offen offset:1024 sc1
    s_waitcnt lgkmcnt(6)
    v_mfma_f32_16x16x32_bf16 v[24:27], a[152:155], v[88:91], v[24:27]
    ds_read_b64_tr_b16 v[84:85], v3 offset:2048
    ds_read_b64_tr_b16 v[86:87], v3 offset:3072
    v_mfma_f32_16x16x32_bf16 v[28:31], v[88:91], v[88:91], v[28:31]
    buffer_load_dwordx4 v[156:159], v4, s[32:35], s69 offen offset:2048 sc1
    v_cvt_pk_bf16_f32 v64, v64, v64
    v_mfma_f32_16x16x32_bf16 v[32:35], a[152:155], v[92:95], v[32:35]
    ds_read_b64_tr_b16 v[88:89], v2 offset:4096
    ds_read_b64_tr_b16 v[90:91], v2 offset:5120
    v_mfma_f32_16x16x32_bf16 v[36:39], v[92:95], v[92:95], v[36:39]
    v_accvgpr_write_b32 a161, v63
    v_accvgpr_write_b32 a160, v64
    v_mfma_f32_16x16x32_bf16 v[24:27], a[156:159], v[96:99], v[24:27]
    ds_read_b64_tr_b16 v[92:93], v3 offset:4096
    ds_read_b64_tr_b16 v[94:95], v3 offset:5120
    v_mfma_f32_16x16x32_bf16 v[28:31], v[96:99], v[96:99], v[28:31]
    buffer_load_dwordx4 a[164:167], v4, s[32:35], s69 offen offset:3072 sc1
    v_mfma_f32_16x16x32_bf16 v[32:35], a[156:159], v[100:103], v[32:35]
    ds_read_b64_tr_b16 v[96:97], v2 offset:6144
    ds_read_b64_tr_b16 v[98:99], v2 offset:7168
    v_mfma_f32_16x16x32_bf16 v[36:39], v[100:103], v[100:103], v[36:39]
    s_add_u32 s69, s87, 16384
    buffer_load_dwordx4 a[168:171], v4, s[32:35], s69 offen offset:0 sc1
    s_waitcnt lgkmcnt(6)
    v_mfma_f32_16x16x32_bf16 v[40:43], a[80:83], v[72:75], 0
    ds_read_b64_tr_b16 v[100:101], v3 offset:6144
    ds_read_b64_tr_b16 v[102:103], v3 offset:7168
    v_mfma_f32_16x16x32_bf16 v[44:47], v[72:75], v[72:75], 0
    v_mfma_f32_16x16x32_bf16 v[48:51], a[80:83], v[76:79], 0
    ds_read_b64_tr_b16 v[72:73], v2 offset:8192
    ds_read_b64_tr_b16 v[74:75], v2 offset:9216
    v_mfma_f32_16x16x32_bf16 v[52:55], v[76:79], v[76:79], 0
    buffer_load_dwordx4 a[172:175], v4, s[32:35], s69 offen offset:1024 sc1
    v_cndmask_b32 v28, v28, v29, s[76:77]
    v_cndmask_b32 v36, v36, v37, s[76:77]
    v_mfma_f32_16x16x32_bf16 v[40:43], a[84:87], v[80:83], v[40:43]
    ds_read_b64_tr_b16 v[76:77], v3 offset:8192
    ds_read_b64_tr_b16 v[78:79], v3 offset:9216
    v_cndmask_b32 v28, v28, v30, s[78:79]
    v_mfma_f32_16x16x32_bf16 v[44:47], v[80:83], v[80:83], v[44:47]
    buffer_load_dwordx4 a[176:179], v4, s[32:35], s69 offen offset:2048 sc1
    v_cndmask_b32 v36, v36, v38, s[78:79]
    v_mfma_f32_16x16x32_bf16 v[48:51], a[84:87], v[84:87], v[48:51]
    ds_read_b64_tr_b16 v[80:81], v2 offset:10240
    ds_read_b64_tr_b16 v[82:83], v2 offset:11264
    v_cndmask_b32 v28, v28, v31, s[80:81]
    v_mfma_f32_16x16x32_bf16 v[52:55], v[84:87], v[84:87], v[52:55]
    v_cndmask_b32 v36, v36, v39, s[80:81]
    s_waitcnt lgkmcnt(6)
    v_mfma_f32_16x16x32_bf16 v[40:43], a[88:91], v[88:91], v[40:43]
    ds_read_b64_tr_b16 v[84:85], v3 offset:10240
    ds_read_b64_tr_b16 v[86:87], v3 offset:11264
    ds_write_b32 v7, v24 offset:24
    ds_write_b32 v8, v28 offset:28
    v_mfma_f32_16x16x32_bf16 v[44:47], v[88:91], v[88:91], v[44:47]
    buffer_load_dwordx4 a[180:183], v4, s[32:35], s69 offen offset:3072 sc1
    ds_write_b32 v7, v32 offset:536
    ds_write_b32 v8, v36 offset:540
    v_mfma_f32_16x16x32_bf16 v[48:51], a[88:91], v[92:95], v[48:51]
    ds_read_b64_tr_b16 v[88:89], v2 offset:12288
    ds_read_b64_tr_b16 v[90:91], v2 offset:13312
    v_mfma_f32_16x16x32_bf16 v[52:55], v[92:95], v[92:95], v[52:55]
    ds_read_b64 v[112:113], v10 offset:24
    v_mfma_f32_16x16x32_bf16 v[40:43], a[92:95], v[96:99], v[40:43]
    ds_read_b64_tr_b16 v[92:93], v3 offset:12288
    ds_read_b64_tr_b16 v[94:95], v3 offset:13312
    v_mfma_f32_16x16x32_bf16 v[44:47], v[96:99], v[96:99], v[44:47]
    s_min_u32 s72, s16, s17
    s_cmp_lt_u32 s72, 20
    s_cbranch_scc1 L_slow38
L_ret38:
    s_barrier
    v_mfma_f32_16x16x32_bf16 v[48:51], a[92:95], v[100:103], v[48:51]
    ds_read_b64_tr_b16 v[96:97], v2 offset:14336
    ds_read_b64_tr_b16 v[98:99], v2 offset:15360
    v_mfma_f32_16x16x32_bf16 v[52:55], v[100:103], v[100:103], v[52:55]
    s_waitcnt lgkmcnt(11)
    v_mfma_f32_16x16x32_bf16 v[40:43], a[96:99], v[72:75], v[40:43]
    ds_read_b64_tr_b16 v[100:101], v3 offset:14336
    ds_read_b64_tr_b16 v[102:103], v3 offset:15360
    s_waitcnt lgkmcnt(5)
    v_mul_f32 v114, v112, v112
    v_mul_f32 v113, 0x3acccd53, v113
    v_and_b32 v115, s73, v112
    v_mfma_f32_16x16x32_bf16 v[44:47], v[72:75], v[72:75], v[44:47]
    v_fmac_f32 v113, 0xb623d776, v114
    v_sub_f32 v112, v112, v115
    v_add_f32_e64 v113, |v113|, s74
    v_mfma_f32_16x16x32_bf16 v[48:51], a[96:99], v[76:79], v[48:51]
    ds_read_b64_tr_b16 v[72:73], v2 offset:16384
    ds_read_b64_tr_b16 v[74:75], v2 offset:17408
    v_cvt_pk_bf16_f32 v124, v115, v112
    v_mfma_f32_16x16x32_bf16 v[52:55], v[76:79], v[76:79], v[52:55]
    v_rsq_f32 v114, v113
    s_nop 0
    v_mul_f32 v112, v113, v114
    v_mul_f32 v113, 0xc0135761, v114
    v_mfma_f32_16x16x32_bf16 v[40:43], a[100:103], v[80:83], v[40:43]
    ds_read_b64_tr_b16 v[76:77], v3 offset:16384
    ds_read_b64_tr_b16 v[78:79], v3 offset:17408
    v_and_b32 v115, s73, v112
    v_mfma_f32_16x16x32_bf16 v[44:47], v[80:83], v[80:83], v[44:47]
    v_mul_f32 v114, v114, v114
    v_sub_f32 v125, v112, v115
    v_mul_f32 v114, v114, v113
    v_cvt_pk_bf16_f32 v125, v115, v125
    v_mfma_f32_16x16x32_bf16 v[48:51], a[100:103], v[84:87], v[48:51]
    ds_read_b64_tr_b16 v[80:81], v2 offset:18432
    ds_read_b64_tr_b16 v[82:83], v2 offset:19456
    v_mul_f32 v114, 0x3d372713, v114
    v_mfma_f32_16x16x32_bf16 v[52:55], v[84:87], v[84:87], v[52:55]
    ds_write_b64 v10, v[124:125] offset:16
    s_waitcnt lgkmcnt(7)
    v_mfma_f32_16x16x32_bf16 v[40:43], a[104:107], v[88:91], v[40:43]
    ds_read_b64_tr_b16 v[84:85], v3 offset:18432
    ds_read_b64_tr_b16 v[86:87], v3 offset:19456
    ds_write_b128 v10, v[112:115] offset:0
    v_mfma_f32_16x16x32_bf16 v[44:47], v[88:91], v[88:91], v[44:47]
    v_mfma_f32_16x16x32_bf16 v[48:51], a[104:107], v[92:95], v[48:51]
    ds_read_b64_tr_b16 v[88:89], v2 offset:20480
    ds_read_b64_tr_b16 v[90:91], v2 offset:21504
    v_mfma_f32_16x16x32_bf16 v[52:55], v[92:95], v[92:95], v[52:55]
    s_waitcnt lgkmcnt(2)
    s_barrier
    v_mfma_f32_16x16x32_bf16 v[40:43], a[108:111], v[96:99], v[40:43]
    ds_read_b64_tr_b16 v[92:93], v3 offset:20480
    ds_read_b64_tr_b16 v[94:95], v3 offset:21504
    ds_read_b64 v[104:105], v6 offset:16
    v_mfma_f32_16x16x32_bf16 v[44:47], v[96:99], v[96:99], v[44:47]
    ds_read_b64 v[108:109], v6 offset:528
    ds_read_b128 v[28:31], v6 offset:0
    v_mfma_f32_16x16x32_bf16 v[48:51], a[108:111], v[100:103], v[48:51]
    ds_read_b64_tr_b16 v[96:97], v2 offset:22528
    ds_read_b64_tr_b16 v[98:99], v2 offset:23552
    v_mfma_f32_16x16x32_bf16 v[52:55], v[100:103], v[100:103], v[52:55]
    ds_read_b128 v[36:39], v6 offset:512
    v_mfma_f32_16x16x32_bf16 v[40:43], a[112:115], v[72:75], v[40:43]
    ds_read_b64_tr_b16 v[100:101], v3 offset:22528
    ds_read_b64_tr_b16 v[102:103], v3 offset:23552
    v_mfma_f32_16x16x32_bf16 v[44:47], v[72:75], v[72:75], v[44:47]
    v_mfma_f32_16x16x32_bf16 v[48:51], a[112:115], v[76:79], v[48:51]
    ds_read_b64_tr_b16 v[72:73], v2 offset:24576
    ds_read_b64_tr_b16 v[74:75], v2 offset:25600
    v_mfma_f32_16x16x32_bf16 v[52:55], v[76:79], v[76:79], v[52:55]
    s_waitcnt lgkmcnt(8)
    v_mfma_f32_16x16x32_bf16 v[24:27], a[160:163], v[104:107], v[24:27]
    v_mfma_f32_16x16x32_bf16 v[32:35], a[160:163], v[108:111], v[32:35]
    v_mfma_f32_16x16x32_bf16 v[40:43], a[116:119], v[80:83], v[40:43]
    ds_read_b64_tr_b16 v[76:77], v3 offset:24576
    ds_read_b64_tr_b16 v[78:79], v3 offset:25600
    v_mfma_f32_16x16x32_bf16 v[44:47], v[80:83], v[80:83], v[44:47]
    v_mfma_f32_16x16x32_bf16 v[48:51], a[116:119], v[84:87], v[48:51]
    ds_read_b64_tr_b16 v[80:81], v2 offset:26624
    ds_read_b64_tr_b16 v[82:83], v2 offset:27648
    v_mfma_f32_16x16x32_bf16 v[52:55], v[84:87], v[84:87], v[52:55]
    s_waitcnt lgkmcnt(6)
    v_mfma_f32_16x16x32_bf16 v[40:43], a[120:123], v[88:91], v[40:43]
    ds_read_b64_tr_b16 v[84:85], v3 offset:26624
    ds_read_b64_tr_b16 v[86:87], v3 offset:27648
    v_mul_f32 v116, v24, v24
    v_mul_f32 v117, v25, v25
    v_mfma_f32_16x16x32_bf16 v[44:47], v[88:91], v[88:91], v[44:47]
    v_fma_f32 v116, v116, v30, v29
    v_fma_f32 v117, v117, v30, v29
    v_mul_f32 v116, v116, v24
    v_mul_f32 v117, v117, v25
    v_mfma_f32_16x16x32_bf16 v[48:51], a[120:123], v[92:95], v[48:51]
    ds_read_b64_tr_b16 v[88:89], v2 offset:28672
    ds_read_b64_tr_b16 v[90:91], v2 offset:29696
    v_mfma_f32_16x16x32_bf16 v[52:55], v[92:95], v[92:95], v[52:55]
    v_exp_f32 v116, v116
    v_exp_f32 v117, v117
    v_mfma_f32_16x16x32_bf16 v[40:43], a[124:127], v[96:99], v[40:43]
    ds_read_b64_tr_b16 v[92:93], v3 offset:28672
    ds_read_b64_tr_b16 v[94:95], v3 offset:29696
    v_mul_f32 v118, v26, v26
    v_fma_f32 v116, v116, v28, v28
    v_mfma_f32_16x16x32_bf16 v[44:47], v[96:99], v[96:99], v[44:47]
    s_add_u32 s69, s87, 20480
    buffer_load_dwordx4 a[184:187], v4, s[32:35], s69 offen offset:0 sc1
    v_mul_f32 v119, v27, v27
    v_mfma_f32_16x16x32_bf16 v[48:51], a[124:127], v[100:103], v[48:51]
    ds_read_b64_tr_b16 v[96:97], v2 offset:30720
    ds_read_b64_tr_b16 v[98:99], v2 offset:31744
    v_fma_f32 v117, v117, v28, v28
    v_mfma_f32_16x16x32_bf16 v[52:55], v[100:103], v[100:103], v[52:55]
    buffer_load_dwordx4 a[188:191], v4, s[32:35], s69 offen offset:1024 sc1
    v_rcp_f32 v116, v116
    s_waitcnt lgkmcnt(6)
    v_mfma_f32_16x16x32_bf16 v[40:43], a[128:131], v[72:75], v[40:43]
    ds_read_b64_tr_b16 v[100:101], v3 offset:30720
    ds_read_b64_tr_b16 v[102:103], v3 offset:31744
    v_fma_f32 v118, v118, v30, v29
    v_mfma_f32_16x16x32_bf16 v[44:47], v[72:75], v[72:75], v[44:47]
    v_fma_f32 v119, v119, v30, v29
    v_rcp_f32 v117, v117
    v_mul_f32 v118, v118, v26
    v_mfma_f32_16x16x32_bf16 v[48:51], a[128:131], v[76:79], v[48:51]
    ds_read_b64_tr_b16 v[72:73], v2 offset:32768
    ds_read_b64_tr_b16 v[74:75], v2 offset:33792
    v_mul_f32 v119, v119, v27
    v_mfma_f32_16x16x32_bf16 v[52:55], v[76:79], v[76:79], v[52:55]
    buffer_load_dwordx4 a[192:195], v4, s[32:35], s69 offen offset:2048 sc1
    v_exp_f32 v118, v118
    v_mfma_f32_16x16x32_bf16 v[40:43], a[132:135], v[80:83], v[40:43]
    ds_read_b64_tr_b16 v[76:77], v3 offset:32768
    ds_read_b64_tr_b16 v[78:79], v3 offset:33792
    v_mul_f32 v116, v116, v24
    v_mul_f32 v117, v117, v25
    v_mfma_f32_16x16x32_bf16 v[44:47], v[80:83], v[80:83], v[44:47]
    buffer_load_dwordx4 a[196:199], v4, s[32:35], s69 offen offset:3072 sc1
    v_exp_f32 v119, v119
    v_mfma_f32_16x16x32_bf16 v[48:51], a[132:135], v[84:87], v[48:51]
    ds_read_b64_tr_b16 v[80:81], v2 offset:34816
    ds_read_b64_tr_b16 v[82:83], v2 offset:35840
    v_cvt_pk_bf16_f32 v24, v116, v117
    v_mfma_f32_16x16x32_bf16 v[52:55], v[84:87], v[84:87], v[52:55]
    v_fma_f32 v118, v118, v28, v28
    v_fma_f32 v119, v119, v28, v28
    s_waitcnt lgkmcnt(6)
    v_mfma_f32_16x16x32_bf16 v[40:43], a[136:139], v[88:91], v[40:43]
    ds_read_b64_tr_b16 v[84:85], v3 offset:34816
    ds_read_b64_tr_b16 v[86:87], v3 offset:35840
    v_rcp_f32 v118, v118
    v_mfma_f32_16x16x32_bf16 v[44:47], v[88:91], v[88:91], v[44:47]
    s_add_u32 s69, s87, 24576
    buffer_load_dwordx4 a[200:203], v4, s[32:35], s69 offen offset:0 sc1
    v_rcp_f32 v119, v119
    v_mfma_f32_16x16x32_bf16 v[48:51], a[136:139], v[92:95], v[48:51]
    ds_read_b64_tr_b16 v[88:89], v2 offset:36864
    ds_read_b64_tr_b16 v[90:91], v2 offset:37888
    v_mul_f32 v118, v118, v26
    v_mfma_f32_16x16x32_bf16 v[52:55], v[92:95], v[92:95], v[52:55]
    buffer_load_dwordx4 a[204:207], v4, s[32:35], s69 offen offset:1024 sc1
    v_mul_f32 v119, v119, v27
    v_cvt_pk_bf16_f32 v25, v118, v119
    v_mfma_f32_16x16x32_bf16 v[40:43], a[140:143], v[96:99], v[40:43]
    ds_read_b64_tr_b16 v[92:93], v3 offset:36864
    ds_read_b64_tr_b16 v[94:95], v3 offset:37888
    v_cndmask_b32 v24, v24, v5, s[82:83]
    v_cndmask_b32 v25, v25, 0, s[82:83]
    v_mfma_f32_16x16x32_bf16 v[44:47], v[96:99], v[96:99], v[44:47]
    s_add_u32 s65, s90, 0
    buffer_store_dwordx2 v[24:25], v9, s[32:35], s65 offen sc1
    v_mul_f32 v116, v32, v32
    v_mfma_f32_16x16x32_bf16 v[48:51], a[140:143], v[100:103], v[48:51]
    ds_read_b64_tr_b16 v[96:97], v2 offset:38912
    ds_read_b64_tr_b16 v[98:99], v2 offset:39936
    v_mul_f32 v117, v33, v33
    v_mfma_f32_16x16x32_bf16 v[52:55], v[100:103], v[100:103], v[52:55]
    buffer_load_dwordx4 a[208:211], v4, s[32:35], s69 offen offset:2048 sc1
    v_fma_f32 v116, v116, v38, v37
    v_fma_f32 v117, v117, v38, v37
    s_waitcnt lgkmcnt(6)
    v_mfma_f32_16x16x32_bf16 v[40:43], a[144:147], v[72:75], v[40:43]
    ds_read_b64_tr_b16 v[100:101], v3 offset:38912
    ds_read_b64_tr_b16 v[102:103], v3 offset:39936
    v_mul_f32 v116, v116, v32
    v_mfma_f32_16x16x32_bf16 v[44:47], v[72:75], v[72:75], v[44:47]
    buffer_load_dwordx4 a[212:215], v4, s[32:35], s69 offen offset:3072 sc1
    v_add_u32 v2, 40960, v2
    v_add_u32 v3, 40960, v3
    s_barrier
    v_mfma_f32_16x16x32_bf16 v[48:51], a[144:147], v[76:79], v[48:51]
    ds_read_b64_tr_b16 v[72:73], v2 offset:0
    ds_read_b64_tr_b16 v[74:75], v2 offset:1024
    v_mul_f32 v117, v117, v33
    v_mfma_f32_16x16x32_bf16 v[52:55], v[76:79], v[76:79], v[52:55]
    v_exp_f32 v116, v116
    v_mfma_f32_16x16x32_bf16 v[40:43], a[148:151], v[80:83], v[40:43]
    ds_read_b64_tr_b16 v[76:77], v3 offset:0
    ds_read_b64_tr_b16 v[78:79], v3 offset:1024
    v_exp_f32 v117, v117
    v_mul_f32 v118, v34, v34
    v_mfma_f32_16x16x32_bf16 v[44:47], v[80:83], v[80:83], v[44:47]
    s_add_u32 s69, s87, 28672
    buffer_load_dwordx4 a[216:219], v4, s[32:35], s69 offen offset:0 sc1
    v_fma_f32 v116, v116, v36, v36
    v_mfma_f32_16x16x32_bf16 v[48:51], a[148:151], v[84:87], v[48:51]
    ds_read_b64_tr_b16 v[80:81], v2 offset:2048
    ds_read_b64_tr_b16 v[82:83], v2 offset:3072
    v_mul_f32 v119, v35, v35
    v_fma_f32 v117, v117, v36, v36
    v_mfma_f32_16x16x32_bf16 v[52:55], v[84:87], v[84:87], v[52:55]
    buffer_load_dwordx4 a[220:223], v4, s[32:35], s69 offen offset:1024 sc1
    s_waitcnt lgkmcnt(6)
    v_mfma_f32_16x16x32_bf16 v[40:43], a[152:155], v[88:91], v[40:43]
    ds_read_b64_tr_b16 v[84:85], v3 offset:2048
    ds_read_b64_tr_b16 v[86:87], v3 offset:3072
    v_rcp_f32 v116, v116
    v_fma_f32 v118, v118, v38, v37
    v_mfma_f32_16x16x32_bf16 v[44:47], v[88:91], v[88:91], v[44:47]
    v_fma_f32 v119, v119, v38, v37
    v_rcp_f32 v117, v117
    v_mfma_f32_16x16x32_bf16 v[48:51], a[152:155], v[92:95], v[48:51]
    ds_read_b64_tr_b16 v[88:89], v2 offset:4096
    ds_read_b64_tr_b16 v[90:91], v2 offset:5120
    v_mul_f32 v118, v118, v34
    v_mul_f32 v119, v119, v35
    v_mfma_f32_16x16x32_bf16 v[52:55], v[92:95], v[92:95], v[52:55]
    buffer_load_dwordx4 a[224:227], v4, s[32:35], s69 offen offset:2048 sc1
    v_exp_f32 v118, v118
    v_mfma_f32_16x16x32_bf16 v[40:43], a[156:159], v[96:99], v[40:43]
    ds_read_b64_tr_b16 v[92:93], v3 offset:4096
    ds_read_b64_tr_b16 v[94:95], v3 offset:5120
    v_mul_f32 v116, v116, v32
    v_mfma_f32_16x16x32_bf16 v[44:47], v[96:99], v[96:99], v[44:47]
    v_mul_f32 v117, v117, v33
    v_exp_f32 v119, v119
    v_cvt_pk_bf16_f32 v32, v116, v117
    v_mfma_f32_16x16x32_bf16 v[48:51], a[156:159], v[100:103], v[48:51]
    ds_read_b64_tr_b16 v[96:97], v2 offset:6144
    ds_read_b64_tr_b16 v[98:99], v2 offset:7168
    v_fma_f32 v118, v118, v36, v36
    v_fma_f32 v119, v119, v36, v36
    v_mfma_f32_16x16x32_bf16 v[52:55], v[100:103], v[100:103], v[52:55]
    buffer_load_dwordx4 v[160:163], v4, s[32:35], s69 offen offset:3072 sc1
    s_waitcnt lgkmcnt(6)
    v_mfma_f32_16x16x32_bf16 v[56:59], a[80:83], v[72:75], 0
    ds_read_b64_tr_b16 v[100:101], v3 offset:6144
    ds_read_b64_tr_b16 v[102:103], v3 offset:7168
    v_rcp_f32 v118, v118
    v_mfma_f32_16x16x32_bf16 v[60:63], v[72:75], v[72:75], 0
    v_rcp_f32 v119, v119
    v_mul_f32 v118, v118, v34
    v_mul_f32 v119, v119, v35
    v_mfma_f32_16x16x32_bf16 v[64:67], a[80:83], v[76:79], 0
    ds_read_b64_tr_b16 v[72:73], v2 offset:8192
    ds_read_b64_tr_b16 v[74:75], v2 offset:9216
    v_cvt_pk_bf16_f32 v33, v118, v119
    v_cndmask_b32 v32, v32, v5, s[82:83]
    v_mfma_f32_16x16x32_bf16 v[68:71], v[76:79], v[76:79], 0
    v_cndmask_b32 v44, v44, v45, s[76:77]
    v_cndmask_b32 v52, v52, v53, s[76:77]
    v_cndmask_b32 v44, v44, v46, s[78:79]
    v_cndmask_b32 v33, v33, 0, s[82:83]
    s_add_u32 s65, s90, 57344
    buffer_store_dwordx2 v[32:33], v9, s[32:35], s65 offen sc1
    v_mfma_f32_16x16x32_bf16 v[56:59], a[84:87], v[80:83], v[56:59]
    ds_read_b64_tr_b16 v[76:77], v3 offset:8192
    ds_read_b64_tr_b16 v[78:79], v3 offset:9216
    v_mfma_f32_16x16x32_bf16 v[60:63], v[80:83], v[80:83], v[60:63]
    v_cndmask_b32 v52, v52, v54, s[78:79]
    v_cndmask_b32 v44, v44, v47, s[80:81]
    v_cndmask_b32 v52, v52, v55, s[80:81]
    v_mfma_f32_16x16x32_bf16 v[64:67], a[84:87], v[84:87], v[64:67]
    ds_read_b64_tr_b16 v[80:81], v2 offset:10240
    ds_read_b64_tr_b16 v[82:83], v2 offset:11264
    v_mfma_f32_16x16x32_bf16 v[68:71], v[84:87], v[84:87], v[68:71]
    ds_write_b32 v7, v40 offset:1048
    ds_write_b32 v8, v44 offset:1052
    s_waitcnt lgkmcnt(8)
    v_mfma_f32_16x16x32_bf16 v[56:59], a[88:91], v[88:91], v[56:59]
    ds_read_b64_tr_b16 v[84:85], v3 offset:10240
    ds_read_b64_tr_b16 v[86:87], v3 offset:11264
    v_mfma_f32_16x16x32_bf16 v[60:63], v[88:91], v[88:91], v[60:63]
    ds_write_b32 v7, v48 offset:1560
    ds_write_b32 v8, v52 offset:1564
    ds_read_b64 v[112:113], v10 offset:1048
    v_mfma_f32_16x16x32_bf16 v[64:67], a[88:91], v[92:95], v[64:67]
    ds_read_b64_tr_b16 v[88:89], v2 offset:12288
    ds_read_b64_tr_b16 v[90:91], v2 offset:13312
    v_mfma_f32_16x16x32_bf16 v[68:71], v[92:95], v[92:95], v[68:71]
    v_mfma_f32_16x16x32_bf16 v[56:59], a[92:95], v[96:99], v[56:59]
    ds_read_b64_tr_b16 v[92:93], v3 offset:12288
    ds_read_b64_tr_b16 v[94:95], v3 offset:13312
    v_mfma_f32_16x16x32_bf16 v[60:63], v[96:99], v[96:99], v[60:63]
    v_mfma_f32_16x16x32_bf16 v[64:67], a[92:95], v[100:103], v[64:67]
    ds_read_b64_tr_b16 v[96:97], v2 offset:14336
    ds_read_b64_tr_b16 v[98:99], v2 offset:15360
    s_waitcnt lgkmcnt(6)
    v_mul_f32 v114, v112, v112
    v_mul_f32 v113, 0x3acccd53, v113
    v_mfma_f32_16x16x32_bf16 v[68:71], v[100:103], v[100:103], v[68:71]
    v_and_b32 v115, s73, v112
    v_fmac_f32 v113, 0xb623d776, v114
    v_mfma_f32_16x16x32_bf16 v[56:59], a[96:99], v[72:75], v[56:59]
    ds_read_b64_tr_b16 v[100:101], v3 offset:14336
    ds_read_b64_tr_b16 v[102:103], v3 offset:15360
    v_sub_f32 v112, v112, v115
    v_mfma_f32_16x16x32_bf16 v[60:63], v[72:75], v[72:75], v[60:63]
    v_add_f32_e64 v113, |v113|, s74
    v_cvt_pk_bf16_f32 v124, v115, v112
    v_rsq_f32 v114, v113
    v_mfma_f32_16x16x32_bf16 v[64:67], a[96:99], v[76:79], v[64:67]
    ds_read_b64_tr_b16 v[72:73], v2 offset:16384
    ds_read_b64_tr_b16 v[74:75], v2 offset:17408
    v_mul_f32 v112, v113, v114
    v_mfma_f32_16x16x32_bf16 v[68:71], v[76:79], v[76:79], v[68:71]
    v_mul_f32 v113, 0xc0135761, v114
    v_and_b32 v115, s73, v112
    v_mul_f32 v114, v114, v114
    v_mfma_f32_16x16x32_bf16 v[56:59], a[100:103], v[80:83], v[56:59]
    ds_read_b64_tr_b16 v[76:77], v3 offset:16384
    ds_read_b64_tr_b16 v[78:79], v3 offset:17408
    v_sub_f32 v125, v112, v115
    v_mfma_f32_16x16x32_bf16 v[60:63], v[80:83], v[80:83], v[60:63]
    v_mul_f32 v114, v114, v113
    v_cvt_pk_bf16_f32 v125, v115, v125
    v_mul_f32 v114, 0x3d372713, v114
    v_mfma_f32_16x16x32_bf16 v[64:67], a[100:103], v[84:87], v[64:67]
    ds_read_b64_tr_b16 v[80:81], v2 offset:18432
    ds_read_b64_tr_b16 v[82:83], v2 offset:19456
    ds_write_b64 v10, v[124:125] offset:1040
    v_mfma_f32_16x16x32_bf16 v[68:71], v[84:87], v[84:87], v[68:71]
    ds_write_b128 v10, v[112:115] offset:1024
    s_waitcnt lgkmcnt(8)
    v_mfma_f32_16x16x32_bf16 v[56:59], a[104:107], v[88:91], v[56:59]
    ds_read_b64_tr_b16 v[84:85], v3 offset:18432
    ds_read_b64_tr_b16 v[86:87], v3 offset:19456
    v_mfma_f32_16x16x32_bf16 v[60:63], v[88:91], v[88:91], v[60:63]
    v_mfma_f32_16x16x32_bf16 v[64:67], a[104:107], v[92:95], v[64:67]
    ds_read_b64_tr_b16 v[88:89], v2 offset:20480
    ds_read_b64_tr_b16 v[90:91], v2 offset:21504
    v_mfma_f32_16x16x32_bf16 v[68:71], v[92:95], v[92:95], v[68:71]
    s_waitcnt lgkmcnt(4)
    s_barrier
    v_mfma_f32_16x16x32_bf16 v[56:59], a[108:111], v[96:99], v[56:59]
    ds_read_b64_tr_b16 v[92:93], v3 offset:20480
    ds_read_b64_tr_b16 v[94:95], v3 offset:21504
    v_mfma_f32_16x16x32_bf16 v[60:63], v[96:99], v[96:99], v[60:63]
    ds_read_b64 v[104:105], v6 offset:1040
    ds_read_b64 v[108:109], v6 offset:1552
    ds_read_b128 v[44:47], v6 offset:1024
    v_mfma_f32_16x16x32_bf16 v[64:67], a[108:111], v[100:103], v[64:67]
    ds_read_b64_tr_b16 v[96:97], v2 offset:22528
    ds_read_b64_tr_b16 v[98:99], v2 offset:23552
    v_mfma_f32_16x16x32_bf16 v[68:71], v[100:103], v[100:103], v[68:71]
    s_add_u32 s69, s87, 32768
    buffer_load_dwordx4 v[164:167], v4, s[32:35], s69 offen offset:0 sc1
    s_waitcnt lgkmcnt(9)
    v_mfma_f32_16x16x32_bf16 v[56:59], a[112:115], v[72:75], v[56:59]
    ds_read_b64_tr_b16 v[100:101], v3 offset:22528
    ds_read_b64_tr_b16 v[102:103], v3 offset:23552
    v_mfma_f32_16x16x32_bf16 v[60:63], v[72:75], v[72:75], v[60:63]
    ds_read_b128 v[52:55], v6 offset:1536
    v_mfma_f32_16x16x32_bf16 v[64:67], a[112:115], v[76:79], v[64:67]
    ds_read_b64_tr_b16 v[72:73], v2 offset:24576
    ds_read_b64_tr_b16 v[74:75], v2 offset:25600
    v_mfma_f32_16x16x32_bf16 v[68:71], v[76:79], v[76:79], v[68:71]
    buffer_load_dwordx4 v[168:171], v4, s[32:35], s69 offen offset:1024 sc1
    s_waitcnt lgkmcnt(5)
    v_mfma_f32_16x16x32_bf16 v[40:43], a[160:163], v[104:107], v[40:43]
    v_mfma_f32_16x16x32_bf16 v[48:51], a[160:163], v[108:111], v[48:51]
    v_mfma_f32_16x16x32_bf16 v[56:59], a[116:119], v[80:83], v[56:59]
    ds_read_b64_tr_b16 v[76:77], v3 offset:24576
    ds_read_b64_tr_b16 v[78:79], v3 offset:25600
    v_mfma_f32_16x16x32_bf16 v[60:63], v[80:83], v[80:83], v[60:63]
    buffer_load_dwordx4 v[172:175], v4, s[32:35], s69 offen offset:2048 sc1
    v_mfma_f32_16x16x32_bf16 v[64:67], a[116:119], v[84:87], v[64:67]
    ds_read_b64_tr_b16 v[80:81], v2 offset:26624
    ds_read_b64_tr_b16 v[82:83], v2 offset:27648
    v_mfma_f32_16x16x32_bf16 v[68:71], v[84:87], v[84:87], v[68:71]
    s_waitcnt lgkmcnt(7)
    v_mfma_f32_16x16x32_bf16 v[56:59], a[120:123], v[88:91], v[56:59]
    ds_read_b64_tr_b16 v[84:85], v3 offset:26624
    ds_read_b64_tr_b16 v[86:87], v3 offset:27648
    v_mul_f32 v116, v40, v40
    v_mul_f32 v117, v41, v41
    v_mfma_f32_16x16x32_bf16 v[60:63], v[88:91], v[88:91], v[60:63]
    buffer_load_dwordx4 v[176:179], v4, s[32:35], s69 offen offset:3072 sc1
    v_fma_f32 v116, v116, v46, v45
    v_fma_f32 v117, v117, v46, v45
    v_mul_f32 v116, v116, v40
    v_mfma_f32_16x16x32_bf16 v[64:67], a[120:123], v[92:95], v[64:67]
    ds_read_b64_tr_b16 v[88:89], v2 offset:28672
    ds_read_b64_tr_b16 v[90:91], v2 offset:29696
    v_mul_f32 v117, v117, v41
    v_mfma_f32_16x16x32_bf16 v[68:71], v[92:95], v[92:95], v[68:71]
    s_add_u32 s69, s87, 36864
    buffer_load_dwordx4 v[180:183], v4, s[32:35], s69 offen offset:0 sc1
    v_exp_f32 v116, v116
    v_mfma_f32_16x16x32_bf16 v[56:59], a[124:127], v[96:99], v[56:59]
    ds_read_b64_tr_b16 v[92:93], v3 offset:28672
    ds_read_b64_tr_b16 v[94:95], v3 offset:29696
    v_mfma_f32_16x16x32_bf16 v[60:63], v[96:99], v[96:99], v[60:63]
    v_exp_f32 v117, v117
    v_mul_f32 v118, v42, v42
    v_fma_f32 v116, v116, v44, v44
    v_mfma_f32_16x16x32_bf16 v[64:67], a[124:127], v[100:103], v[64:67]
    ds_read_b64_tr_b16 v[96:97], v2 offset:30720
    ds_read_b64_tr_b16 v[98:99], v2 offset:31744
    v_mul_f32 v119, v43, v43
    v_fma_f32 v117, v117, v44, v44
    v_mfma_f32_16x16x32_bf16 v[68:71], v[100:103], v[100:103], v[68:71]
    buffer_load_dwordx4 v[184:187], v4, s[32:35], s69 offen offset:1024 sc1
    s_waitcnt lgkmcnt(6)
    v_mfma_f32_16x16x32_bf16 v[56:59], a[128:131], v[72:75], v[56:59]
    ds_read_b64_tr_b16 v[100:101], v3 offset:30720
    ds_read_b64_tr_b16 v[102:103], v3 offset:31744
    v_rcp_f32 v116, v116
    v_mfma_f32_16x16x32_bf16 v[60:63], v[72:75], v[72:75], v[60:63]
    buffer_load_dwordx4 v[188:191], v4, s[32:35], s69 offen offset:2048 sc1
    v_fma_f32 v118, v118, v46, v45
    v_fma_f32 v119, v119, v46, v45
    v_mfma_f32_16x16x32_bf16 v[64:67], a[128:131], v[76:79], v[64:67]
    ds_read_b64_tr_b16 v[72:73], v2 offset:32768
    ds_read_b64_tr_b16 v[74:75], v2 offset:33792
    v_rcp_f32 v117, v117
    v_mfma_f32_16x16x32_bf16 v[68:71], v[76:79], v[76:79], v[68:71]
    v_mul_f32 v118, v118, v42
    v_mul_f32 v119, v119, v43
    v_exp_f32 v118, v118
    v_mfma_f32_16x16x32_bf16 v[56:59], a[132:135], v[80:83], v[56:59]
    ds_read_b64_tr_b16 v[76:77], v3 offset:32768
    ds_read_b64_tr_b16 v[78:79], v3 offset:33792
    v_mul_f32 v116, v116, v40
    v_mfma_f32_16x16x32_bf16 v[60:63], v[80:83], v[80:83], v[60:63]
    buffer_load_dwordx4 v[192:195], v4, s[32:35], s69 offen offset:3072 sc1
    v_mul_f32 v117, v117, v41
    v_exp_f32 v119, v119
    v_mfma_f32_16x16x32_bf16 v[64:67], a[132:135], v[84:87], v[64:67]
    ds_read_b64_tr_b16 v[80:81], v2 offset:34816
    ds_read_b64_tr_b16 v[82:83], v2 offset:35840
    v_cvt_pk_bf16_f32 v40, v116, v117
    v_mfma_f32_16x16x32_bf16 v[68:71], v[84:87], v[84:87], v[68:71]
    s_add_u32 s69, s87, 40960
    buffer_load_dwordx4 v[196:199], v4, s[32:35], s69 offen offset:0 sc1
    v_fma_f32 v118, v118, v44, v44
    s_waitcnt lgkmcnt(6)
    v_mfma_f32_16x16x32_bf16 v[56:59], a[136:139], v[88:91], v[56:59]
    ds_read_b64_tr_b16 v[84:85], v3 offset:34816
    ds_read_b64_tr_b16 v[86:87], v3 offset:35840
    v_fma_f32 v119, v119, v44, v44
    v_mfma_f32_16x16x32_bf16 v[60:63], v[88:91], v[88:91], v[60:63]
    v_rcp_f32 v118, v118
    v_rcp_f32 v119, v119
    v_mfma_f32_16x16x32_bf16 v[64:67], a[136:139], v[92:95], v[64:67]
    ds_read_b64_tr_b16 v[88:89], v2 offset:36864
    ds_read_b64_tr_b16 v[90:91], v2 offset:37888
    v_mul_f32 v118, v118, v42
    v_mfma_f32_16x16x32_bf16 v[68:71], v[92:95], v[92:95], v[68:71]
    buffer_load_dwordx4 v[200:203], v4, s[32:35], s69 offen offset:1024 sc1
    v_mul_f32 v119, v119, v43
    v_cvt_pk_bf16_f32 v41, v118, v119
    v_cndmask_b32 v40, v40, v5, s[82:83]
    v_mfma_f32_16x16x32_bf16 v[56:59], a[140:143], v[96:99], v[56:59]
    ds_read_b64_tr_b16 v[92:93], v3 offset:36864
    ds_read_b64_tr_b16 v[94:95], v3 offset:37888
    v_cndmask_b32 v41, v41, 0, s[82:83]
    v_mfma_f32_16x16x32_bf16 v[60:63], v[96:99], v[96:99], v[60:63]
    s_add_u32 s65, s90, 114688
    buffer_store_dwordx2 v[40:41], v9, s[32:35], s65 offen sc1
    v_mul_f32 v116, v48, v48
    v_mfma_f32_16x16x32_bf16 v[64:67], a[140:143], v[100:103], v[64:67]
    ds_read_b64_tr_b16 v[96:97], v2 offset:38912
    ds_read_b64_tr_b16 v[98:99], v2 offset:39936
    v_mul_f32 v117, v49, v49
    v_fma_f32 v116, v116, v54, v53
    v_mfma_f32_16x16x32_bf16 v[68:71], v[100:103], v[100:103], v[68:71]
    buffer_load_dwordx4 v[204:207], v4, s[32:35], s69 offen offset:2048 sc1
    v_fma_f32 v117, v117, v54, v53
    s_waitcnt lgkmcnt(6)
    v_mfma_f32_16x16x32_bf16 v[56:59], a[144:147], v[72:75], v[56:59]
    ds_read_b64_tr_b16 v[100:101], v3 offset:38912
    ds_read_b64_tr_b16 v[102:103], v3 offset:39936
    v_mul_f32 v116, v116, v48
    v_mul_f32 v117, v117, v49
    v_mfma_f32_16x16x32_bf16 v[60:63], v[72:75], v[72:75], v[60:63]
    buffer_load_dwordx4 v[208:211], v4, s[32:35], s69 offen offset:3072 sc1
    v_add_u32 v2, 76800, v2
    v_add_u32 v3, 76800, v3
    s_barrier
    v_mfma_f32_16x16x32_bf16 v[64:67], a[144:147], v[76:79], v[64:67]
    ds_read_b64_tr_b16 v[72:73], v2 offset:0
    ds_read_b64_tr_b16 v[74:75], v2 offset:1024
    v_mfma_f32_16x16x32_bf16 v[68:71], v[76:79], v[76:79], v[68:71]
    v_exp_f32 v116, v116
    v_exp_f32 v117, v117
    v_mul_f32 v118, v50, v50
    v_mfma_f32_16x16x32_bf16 v[56:59], a[148:151], v[80:83], v[56:59]
    ds_read_b64_tr_b16 v[76:77], v3 offset:0
    ds_read_b64_tr_b16 v[78:79], v3 offset:1024
    v_fma_f32 v116, v116, v52, v52
    v_mfma_f32_16x16x32_bf16 v[60:63], v[80:83], v[80:83], v[60:63]
    s_add_u32 s69, s87, 45056
    buffer_load_dwordx4 v[212:215], v4, s[32:35], s69 offen offset:0 sc1
    v_mul_f32 v119, v51, v51
    v_fma_f32 v117, v117, v52, v52
    v_mfma_f32_16x16x32_bf16 v[64:67], a[148:151], v[84:87], v[64:67]
    ds_read_b64_tr_b16 v[80:81], v2 offset:2048
    ds_read_b64_tr_b16 v[82:83], v2 offset:3072
    v_mfma_f32_16x16x32_bf16 v[68:71], v[84:87], v[84:87], v[68:71]
    buffer_load_dwordx4 v[216:219], v4, s[32:35], s69 offen offset:1024 sc1
    v_rcp_f32 v116, v116
    v_fma_f32 v118, v118, v54, v53
    s_waitcnt lgkmcnt(6)
    v_mfma_f32_16x16x32_bf16 v[56:59], a[152:155], v[88:91], v[56:59]
    ds_read_b64_tr_b16 v[84:85], v3 offset:2048
    ds_read_b64_tr_b16 v[86:87], v3 offset:3072
    v_fma_f32 v119, v119, v54, v53
    v_mfma_f32_16x16x32_bf16 v[60:63], v[88:91], v[88:91], v[60:63]
    v_rcp_f32 v117, v117
    v_mul_f32 v118, v118, v50
    v_mul_f32 v119, v119, v51
    v_mfma_f32_16x16x32_bf16 v[64:67], a[152:155], v[92:95], v[64:67]
    ds_read_b64_tr_b16 v[88:89], v2 offset:4096
    ds_read_b64_tr_b16 v[90:91], v2 offset:5120
    v_exp_f32 v118, v118
    v_mfma_f32_16x16x32_bf16 v[68:71], v[92:95], v[92:95], v[68:71]
    buffer_load_dwordx4 v[220:223], v4, s[32:35], s69 offen offset:2048 sc1
    v_mul_f32 v116, v116, v48
    v_mul_f32 v117, v117, v49
    v_mfma_f32_16x16x32_bf16 v[56:59], a[156:159], v[96:99], v[56:59]
    ds_read_b64_tr_b16 v[92:93], v3 offset:4096
    ds_read_b64_tr_b16 v[94:95], v3 offset:5120
    v_exp_f32 v119, v119
    v_mfma_f32_16x16x32_bf16 v[60:63], v[96:99], v[96:99], v[60:63]
    buffer_load_dwordx4 v[224:227], v4, s[32:35], s69 offen offset:3072 sc1
    v_cvt_pk_bf16_f32 v48, v116, v117
    v_fma_f32 v118, v118, v52, v52
    v_mfma_f32_16x16x32_bf16 v[64:67], a[156:159], v[100:103], v[64:67]
    ds_read_b64_tr_b16 v[96:97], v2 offset:6144
    ds_read_b64_tr_b16 v[98:99], v2 offset:7168
    v_fma_f32 v119, v119, v52, v52
    v_mfma_f32_16x16x32_bf16 v[68:71], v[100:103], v[100:103], v[68:71]
    v_rcp_f32 v118, v118
    v_rcp_f32 v119, v119
    s_waitcnt lgkmcnt(6)
    v_mfma_f32_16x16x32_bf16 v[24:27], a[80:83], v[72:75], 0
    ds_read_b64_tr_b16 v[100:101], v3 offset:6144
    ds_read_b64_tr_b16 v[102:103], v3 offset:7168
    v_mul_f32 v118, v118, v50
    v_mfma_f32_16x16x32_bf16 v[28:31], v[72:75], v[72:75], 0
    s_add_u32 s69, s87, 49152
    buffer_load_dwordx4 v[228:231], v4, s[32:35], s69 offen offset:0 sc1
    v_mul_f32 v119, v119, v51
    v_cvt_pk_bf16_f32 v49, v118, v119
    v_mfma_f32_16x16x32_bf16 v[32:35], a[80:83], v[76:79], 0
    ds_read_b64_tr_b16 v[72:73], v2 offset:8192
    ds_read_b64_tr_b16 v[74:75], v2 offset:9216
    v_cndmask_b32 v48, v48, v5, s[82:83]
    v_mfma_f32_16x16x32_bf16 v[36:39], v[76:79], v[76:79], 0
    buffer_load_dwordx4 v[232:235], v4, s[32:35], s69 offen offset:1024 sc1
    v_cndmask_b32 v60, v60, v61, s[76:77]
    v_cndmask_b32 v68, v68, v69, s[76:77]
    v_cndmask_b32 v60, v60, v62, s[78:79]
    v_cndmask_b32 v49, v49, 0, s[82:83]
    s_add_u32 s65, s90, 172032
    buffer_store_dwordx2 v[48:49], v9, s[32:35], s65 offen sc1
    v_mfma_f32_16x16x32_bf16 v[24:27], a[84:87], v[80:83], v[24:27]
    ds_read_b64_tr_b16 v[76:77], v3 offset:8192
    ds_read_b64_tr_b16 v[78:79], v3 offset:9216
    v_mfma_f32_16x16x32_bf16 v[28:31], v[80:83], v[80:83], v[28:31]
    v_cndmask_b32 v68, v68, v70, s[78:79]
    v_cndmask_b32 v60, v60, v63, s[80:81]
    v_cndmask_b32 v68, v68, v71, s[80:81]
    v_mfma_f32_16x16x32_bf16 v[32:35], a[84:87], v[84:87], v[32:35]
    ds_read_b64_tr_b16 v[80:81], v2 offset:10240
    ds_read_b64_tr_b16 v[82:83], v2 offset:11264
    ds_write_b32 v7, v56 offset:24
    v_mfma_f32_16x16x32_bf16 v[36:39], v[84:87], v[84:87], v[36:39]
    buffer_load_dwordx4 v[236:239], v4, s[32:35], s69 offen offset:2048 sc1
    ds_write_b32 v8, v60 offset:28
    s_waitcnt lgkmcnt(8)
    v_mfma_f32_16x16x32_bf16 v[24:27], a[88:91], v[88:91], v[24:27]
    ds_read_b64_tr_b16 v[84:85], v3 offset:10240
    ds_read_b64_tr_b16 v[86:87], v3 offset:11264
    ds_write_b32 v7, v64 offset:536
    v_mfma_f32_16x16x32_bf16 v[28:31], v[88:91], v[88:91], v[28:31]
    ds_write_b32 v8, v68 offset:540
    ds_read_b64 v[112:113], v10 offset:24
    v_mfma_f32_16x16x32_bf16 v[32:35], a[88:91], v[92:95], v[32:35]
    ds_read_b64_tr_b16 v[88:89], v2 offset:12288
    ds_read_b64_tr_b16 v[90:91], v2 offset:13312
    v_mfma_f32_16x16x32_bf16 v[36:39], v[92:95], v[92:95], v[36:39]
    buffer_load_dwordx4 v[240:243], v4, s[32:35], s69 offen offset:3072 sc1
    v_mfma_f32_16x16x32_bf16 v[24:27], a[92:95], v[96:99], v[24:27]
    ds_read_b64_tr_b16 v[92:93], v3 offset:12288
    ds_read_b64_tr_b16 v[94:95], v3 offset:13312
    v_mfma_f32_16x16x32_bf16 v[28:31], v[96:99], v[96:99], v[28:31]
    s_add_u32 s69, s87, 53248
    buffer_load_dwordx4 v[244:247], v4, s[32:35], s69 offen offset:0 sc1
    v_mfma_f32_16x16x32_bf16 v[32:35], a[92:95], v[100:103], v[32:35]
    ds_read_b64_tr_b16 v[96:97], v2 offset:14336
    ds_read_b64_tr_b16 v[98:99], v2 offset:15360
    s_waitcnt lgkmcnt(6)
    v_mul_f32 v114, v112, v112
    v_mul_f32 v113, 0x3acccd53, v113
    v_mfma_f32_16x16x32_bf16 v[36:39], v[100:103], v[100:103], v[36:39]
    v_and_b32 v115, s73, v112
    v_fmac_f32 v113, 0xb623d776, v114
    v_sub_f32 v112, v112, v115
    v_mfma_f32_16x16x32_bf16 v[24:27], a[96:99], v[72:75], v[24:27]
    ds_read_b64_tr_b16 v[100:101], v3 offset:14336
    ds_read_b64_tr_b16 v[102:103], v3 offset:15360
    v_add_f32_e64 v113, |v113|, s74
    v_mfma_f32_16x16x32_bf16 v[28:31], v[72:75], v[72:75], v[28:31]
    buffer_load_dwordx4 v[248:251], v4, s[32:35], s69 offen offset:1024 sc1
    v_cvt_pk_bf16_f32 v124, v115, v112
    v_rsq_f32 v114, v113
    v_mfma_f32_16x16x32_bf16 v[32:35], a[96:99], v[76:79], v[32:35]
    ds_read_b64_tr_b16 v[72:73], v2 offset:16384
    ds_read_b64_tr_b16 v[74:75], v2 offset:17408
    v_mul_f32 v112, v113, v114
    v_mfma_f32_16x16x32_bf16 v[36:39], v[76:79], v[76:79], v[36:39]
    buffer_load_dwordx4 v[252:255], v4, s[32:35], s69 offen offset:2048 sc1
    v_mul_f32 v113, 0xc0135761, v114
    v_and_b32 v115, s73, v112
    v_mfma_f32_16x16x32_bf16 v[24:27], a[100:103], v[80:83], v[24:27]
    ds_read_b64_tr_b16 v[76:77], v3 offset:16384
    ds_read_b64_tr_b16 v[78:79], v3 offset:17408
    v_mul_f32 v114, v114, v114
    v_sub_f32 v125, v112, v115
    v_mfma_f32_16x16x32_bf16 v[28:31], v[80:83], v[80:83], v[28:31]
    v_mul_f32 v114, v114, v113
    v_cvt_pk_bf16_f32 v125, v115, v125
    v_mul_f32 v114, 0x3d372713, v114
    v_mfma_f32_16x16x32_bf16 v[32:35], a[100:103], v[84:87], v[32:35]
    ds_read_b64_tr_b16 v[80:81], v2 offset:18432
    ds_read_b64_tr_b16 v[82:83], v2 offset:19456
    ds_write_b64 v10, v[124:125] offset:16
    v_mfma_f32_16x16x32_bf16 v[36:39], v[84:87], v[84:87], v[36:39]
    buffer_load_dwordx4 a[0:3], v4, s[32:35], s69 offen offset:3072 sc1
    ds_write_b128 v10, v[112:115] offset:0
    s_waitcnt lgkmcnt(8)
    v_mfma_f32_16x16x32_bf16 v[24:27], a[104:107], v[88:91], v[24:27]
    ds_read_b64_tr_b16 v[84:85], v3 offset:18432
    ds_read_b64_tr_b16 v[86:87], v3 offset:19456
    v_mfma_f32_16x16x32_bf16 v[28:31], v[88:91], v[88:91], v[28:31]
    s_add_u32 s69, s87, 57344
    buffer_load_dwordx4 a[4:7], v4, s[32:35], s69 offen offset:0 sc1
    v_mfma_f32_16x16x32_bf16 v[32:35], a[104:107], v[92:95], v[32:35]
    ds_read_b64_tr_b16 v[88:89], v2 offset:20480
    ds_read_b64_tr_b16 v[90:91], v2 offset:21504
    v_mfma_f32_16x16x32_bf16 v[36:39], v[92:95], v[92:95], v[36:39]
    s_waitcnt lgkmcnt(4)
    s_waitcnt vmcnt(27)
    s_barrier
    s_cmp_lg_u32 s56, 0
    s_cbranch_scc1 L_nosig36
    s_atomic_add s19, s[32:33], s88 offset:0
L_nosig36:
    v_mfma_f32_16x16x32_bf16 v[24:27], a[108:111], v[96:99], v[24:27]
    ds_read_b64_tr_b16 v[92:93], v3 offset:20480
    ds_read_b64_tr_b16 v[94:95], v3 offset:21504
    ds_read_b64 v[104:105], v6 offset:16
    v_mfma_f32_16x16x32_bf16 v[28:31], v[96:99], v[96:99], v[28:31]
    buffer_load_dwordx4 a[8:11], v4, s[32:35], s69 offen offset:1024 sc1
    ds_read_b64 v[108:109], v6 offset:528
    v_mfma_f32_16x16x32_bf16 v[32:35], a[108:111], v[100:103], v[32:35]
    ds_read_b64_tr_b16 v[96:97], v2 offset:22528
    ds_read_b64_tr_b16 v[98:99], v2 offset:23552
    ds_read_b128 v[60:63], v6 offset:0
    v_mfma_f32_16x16x32_bf16 v[36:39], v[100:103], v[100:103], v[36:39]
    buffer_load_dwordx4 a[12:15], v4, s[32:35], s69 offen offset:2048 sc1
    s_waitcnt lgkmcnt(9)
    v_mfma_f32_16x16x32_bf16 v[24:27], a[112:115], v[72:75], v[24:27]
    ds_read_b64_tr_b16 v[100:101], v3 offset:22528
    ds_read_b64_tr_b16 v[102:103], v3 offset:23552
    ds_read_b128 v[68:71], v6 offset:512
    v_mfma_f32_16x16x32_bf16 v[28:31], v[72:75], v[72:75], v[28:31]
    v_mfma_f32_16x16x32_bf16 v[32:35], a[112:115], v[76:79], v[32:35]
    ds_read_b64_tr_b16 v[72:73], v2 offset:24576
    ds_read_b64_tr_b16 v[74:75], v2 offset:25600
    v_mfma_f32_16x16x32_bf16 v[36:39], v[76:79], v[76:79], v[36:39]
    buffer_load_dwordx4 a[16:19], v4, s[32:35], s69 offen offset:3072 sc1
    s_waitcnt lgkmcnt(6)
    v_mfma_f32_16x16x32_bf16 v[56:59], a[160:163], v[104:107], v[56:59]
    v_mfma_f32_16x16x32_bf16 v[64:67], a[160:163], v[108:111], v[64:67]
    v_mfma_f32_16x16x32_bf16 v[24:27], a[116:119], v[80:83], v[24:27]
    ds_read_b64_tr_b16 v[76:77], v3 offset:24576
    ds_read_b64_tr_b16 v[78:79], v3 offset:25600
    v_mfma_f32_16x16x32_bf16 v[28:31], v[80:83], v[80:83], v[28:31]
    v_mfma_f32_16x16x32_bf16 v[32:35], a[116:119], v[84:87], v[32:35]
    ds_read_b64_tr_b16 v[80:81], v2 offset:26624
    ds_read_b64_tr_b16 v[82:83], v2 offset:27648
    v_mfma_f32_16x16x32_bf16 v[36:39], v[84:87], v[84:87], v[36:39]
    s_add_u32 s69, s87, 61440
    buffer_load_dwordx4 a[20:23], v4, s[32:35], s69 offen offset:0 sc1
    s_waitcnt lgkmcnt(7)
    v_mfma_f32_16x16x32_bf16 v[24:27], a[120:123], v[88:91], v[24:27]
    ds_read_b64_tr_b16 v[84:85], v3 offset:26624
    ds_read_b64_tr_b16 v[86:87], v3 offset:27648
    v_mfma_f32_16x16x32_bf16 v[28:31], v[88:91], v[88:91], v[28:31]
    buffer_load_dwordx4 a[24:27], v4, s[32:35], s69 offen offset:1024 sc1
    v_mfma_f32_16x16x32_bf16 v[32:35], a[120:123], v[92:95], v[32:35]
    ds_read_b64_tr_b16 v[88:89], v2 offset:28672
    ds_read_b64_tr_b16 v[90:91], v2 offset:29696
    v_mfma_f32_16x16x32_bf16 v[36:39], v[92:95], v[92:95], v[36:39]
    v_mfma_f32_16x16x32_bf16 v[24:27], a[124:127], v[96:99], v[24:27]
    ds_read_b64_tr_b16 v[92:93], v3 offset:28672
    ds_read_b64_tr_b16 v[94:95], v3 offset:29696
    v_mfma_f32_16x16x32_bf16 v[28:31], v[96:99], v[96:99], v[28:31]
    buffer_load_dwordx4 a[28:31], v4, s[32:35], s69 offen offset:2048 sc1
    v_mfma_f32_16x16x32_bf16 v[32:35], a[124:127], v[100:103], v[32:35]
    ds_read_b64_tr_b16 v[96:97], v2 offset:30720
    ds_read_b64_tr_b16 v[98:99], v2 offset:31744
    v_mfma_f32_16x16x32_bf16 v[36:39], v[100:103], v[100:103], v[36:39]
    buffer_load_dwordx4 a[32:35], v4, s[32:35], s69 offen offset:3072 sc1
    s_waitcnt lgkmcnt(6)
    v_mfma_f32_16x16x32_bf16 v[24:27], a[128:131], v[72:75], v[24:27]
    ds_read_b64_tr_b16 v[100:101], v3 offset:30720
    ds_read_b64_tr_b16 v[102:103], v3 offset:31744
    v_mfma_f32_16x16x32_bf16 v[28:31], v[72:75], v[72:75], v[28:31]
    v_mfma_f32_16x16x32_bf16 v[32:35], a[128:131], v[76:79], v[32:35]
    ds_read_b64_tr_b16 v[72:73], v2 offset:32768
    ds_read_b64_tr_b16 v[74:75], v2 offset:33792
    v_mfma_f32_16x16x32_bf16 v[36:39], v[76:79], v[76:79], v[36:39]
    s_add_u32 s69, s87, 65536
    buffer_load_dwordx4 a[36:39], v4, s[32:35], s69 offen offset:0 sc1
    v_mfma_f32_16x16x32_bf16 v[24:27], a[132:135], v[80:83], v[24:27]
    ds_read_b64_tr_b16 v[76:77], v3 offset:32768
    ds_read_b64_tr_b16 v[78:79], v3 offset:33792
    v_mfma_f32_16x16x32_bf16 v[28:31], v[80:83], v[80:83], v[28:31]
    buffer_load_dwordx4 a[40:43], v4, s[32:35], s69 offen offset:1024 sc1
    v_mfma_f32_16x16x32_bf16 v[32:35], a[132:135], v[84:87], v[32:35]
    ds_read_b64_tr_b16 v[80:81], v2 offset:34816
    ds_read_b64_tr_b16 v[82:83], v2 offset:35840
    v_mfma_f32_16x16x32_bf16 v[36:39], v[84:87], v[84:87], v[36:39]
    s_waitcnt lgkmcnt(6)
    v_mfma_f32_16x16x32_bf16 v[24:27], a[136:139], v[88:91], v[24:27]
    ds_read_b64_tr_b16 v[84:85], v3 offset:34816
    ds_read_b64_tr_b16 v[86:87], v3 offset:35840
    v_mfma_f32_16x16x32_bf16 v[28:31], v[88:91], v[88:91], v[28:31]
    buffer_load_dwordx4 a[44:47], v4, s[32:35], s69 offen offset:2048 sc1
    v_mfma_f32_16x16x32_bf16 v[32:35], a[136:139], v[92:95], v[32:35]
    ds_read_b64_tr_b16 v[88:89], v2 offset:36864
    ds_read_b64_tr_b16 v[90:91], v2 offset:37888
    v_mfma_f32_16x16x32_bf16 v[36:39], v[92:95], v[92:95], v[36:39]
    buffer_load_dwordx4 a[48:51], v4, s[32:35], s69 offen offset:3072 sc1
    v_mfma_f32_16x16x32_bf16 v[24:27], a[140:143], v[96:99], v[24:27]
    ds_read_b64_tr_b16 v[92:93], v3 offset:36864
    ds_read_b64_tr_b16 v[94:95], v3 offset:37888
    v_mfma_f32_16x16x32_bf16 v[28:31], v[96:99], v[96:99], v[28:31]
    v_mfma_f32_16x16x32_bf16 v[32:35], a[140:143], v[100:103], v[32:35]
    ds_read_b64_tr_b16 v[96:97], v2 offset:38912
    ds_read_b64_tr_b16 v[98:99], v2 offset:39936
    v_mfma_f32_16x16x32_bf16 v[36:39], v[100:103], v[100:103], v[36:39]
    s_add_u32 s69, s87, 69632
    buffer_load_dwordx4 a[52:55], v4, s[32:35], s69 offen offset:0 sc1
    s_waitcnt lgkmcnt(6)
    v_mfma_f32_16x16x32_bf16 v[24:27], a[144:147], v[72:75], v[24:27]
    ds_read_b64_tr_b16 v[100:101], v3 offset:38912
    ds_read_b64_tr_b16 v[102:103], v3 offset:39936
    ds_read_b32 v16, v9
    v_mfma_f32_16x16x32_bf16 v[28:31], v[72:75], v[72:75], v[28:31]
    buffer_load_dwordx4 a[56:59], v4, s[32:35], s69 offen offset:1024 sc1
    v_mfma_f32_16x16x32_bf16 v[32:35], a[144:147], v[76:79], v[32:35]
    v_mfma_f32_16x16x32_bf16 v[36:39], v[76:79], v[76:79], v[36:39]
    v_mfma_f32_16x16x32_bf16 v[24:27], a[148:151], v[80:83], v[24:27]
    v_mfma_f32_16x16x32_bf16 v[28:31], v[80:83], v[80:83], v[28:31]
    v_mfma_f32_16x16x32_bf16 v[32:35], a[148:151], v[84:87], v[32:35]
    v_mfma_f32_16x16x32_bf16 v[36:39], v[84:87], v[84:87], v[36:39]
    s_waitcnt lgkmcnt(1)
    v_mfma_f32_16x16x32_bf16 v[24:27], a[152:155], v[88:91], v[24:27]
    v_mfma_f32_16x16x32_bf16 v[28:31], v[88:91], v[88:91], v[28:31]
    v_mfma_f32_16x16x32_bf16 v[32:35], a[152:155], v[92:95], v[32:35]
    v_mfma_f32_16x16x32_bf16 v[36:39], v[92:95], v[92:95], v[36:39]
    v_mfma_f32_16x16x32_bf16 v[24:27], a[156:159], v[96:99], v[24:27]
    v_mfma_f32_16x16x32_bf16 v[28:31], v[96:99], v[96:99], v[28:31]
    v_mfma_f32_16x16x32_bf16 v[32:35], a[156:159], v[100:103], v[32:35]
    v_mfma_f32_16x16x32_bf16 v[36:39], v[100:103], v[100:103], v[36:39]
    s_nop 5
    v_cndmask_b32 v28, v28, v29, s[76:77]
    s_nop 0
    v_cndmask_b32 v36, v36, v37, s[76:77]
    v_cndmask_b32 v28, v28, v30, s[78:79]
    v_cndmask_b32 v36, v36, v38, s[78:79]
    v_cndmask_b32 v28, v28, v31, s[80:81]
    v_cndmask_b32 v36, v36, v39, s[80:81]
    ds_write_b32 v7, v24 offset:1048
    ds_write_b32 v8, v28 offset:1052
    ds_write_b32 v7, v32 offset:1560
    ds_write_b32 v8, v36 offset:1564
    ds_read_b64 v[112:113], v10 offset:1048
    ds_read_b32 v16, v9
    s_waitcnt lgkmcnt(1)
    v_mul_f32 v114, v112, v112
    v_mul_f32 v113, 0x3acccd53, v113
    v_and_b32 v115, s73, v112
    v_fmac_f32 v113, 0xb623d776, v114
    v_sub_f32 v112, v112, v115
    v_add_f32_e64 v113, |v113|, s74
    v_cvt_pk_bf16_f32 v124, v115, v112
    v_rsq_f32 v114, v113
    s_nop 0
    v_mul_f32 v112, v113, v114
    v_mul_f32 v113, 0xc0135761, v114
    v_and_b32 v115, s73, v112
    v_mul_f32 v114, v114, v114
    v_sub_f32 v125, v112, v115
    v_mul_f32 v114, v114, v113
    v_cvt_pk_bf16_f32 v125, v115, v125
    v_mul_f32 v114, 0x3d372713, v114
    ds_write_b64 v10, v[124:125] offset:1040
    ds_write_b128 v10, v[112:115] offset:1024
    ds_read_b32 v16, v9
    s_waitcnt lgkmcnt(1)
    s_waitcnt vmcnt(20)
    s_barrier
    s_mov_b64 s[16:17], 0
    s_load_dword s16, s[32:33], s89 offset:0
    s_cmp_lg_u32 s56, 0
    s_cbranch_scc1 L_nosig39
    s_atomic_add s19, s[32:33], s88 offset:512
L_nosig39:
    ds_read_b64 v[104:105], v6 offset:1040
    ds_read_b64 v[108:109], v6 offset:1552
    ds_read_b128 v[28:31], v6 offset:1024
    ds_read_b128 v[36:39], v6 offset:1536
    ds_read_b32 v16, v9
    ds_read_b32 v16, v9
    ds_read_b32 v16, v9
    v_pk_mul_f32 v[116:117], v[56:57], v[56:57]
    v_pk_mul_f32 v[118:119], v[58:59], v[58:59]
    v_pk_fma_f32 v[116:117], v[116:117], v[62:63], v[60:61] op_sel:[0,0,1] op_sel_hi:[1,0,1]
    v_pk_fma_f32 v[118:119], v[118:119], v[62:63], v[60:61] op_sel:[0,0,1] op_sel_hi:[1,0,1]
    v_pk_mul_f32 v[116:117], v[116:117], v[56:57]
    v_pk_mul_f32 v[118:119], v[118:119], v[58:59]
    v_exp_f32 v116, v116
    v_exp_f32 v117, v117
    v_exp_f32 v118, v118
    v_exp_f32 v119, v119
    v_pk_fma_f32 v[116:117], v[116:117], v[60:61], v[60:61] op_sel_hi:[1,0,0]
    v_pk_fma_f32 v[118:119], v[118:119], v[60:61], v[60:61] op_sel_hi:[1,0,0]
    v_rcp_f32 v116, v116
    v_rcp_f32 v117, v117
    v_rcp_f32 v118, v118
    v_rcp_f32 v119, v119
    v_pk_mul_f32 v[116:117], v[116:117], v[56:57]
    v_pk_mul_f32 v[118:119], v[118:119], v[58:59]
    v_cvt_pk_bf16_f32 v56, v116, v117
    v_cvt_pk_bf16_f32 v57, v118, v119
    v_cndmask_b32 v56, v56, v5, s[82:83]
    v_cndmask_b32 v57, v57, 0, s[82:83]
    s_add_u32 s65, s90, 229376
    buffer_store_dwordx2 v[56:57], v9, s[32:35], s65 offen sc1
    s_waitcnt lgkmcnt(3)
    v_mfma_f32_16x16x32_bf16 v[24:27], a[160:163], v[104:107], v[24:27]
    s_waitcnt lgkmcnt(3)
    v_mfma_f32_16x16x32_bf16 v[32:35], a[160:163], v[108:111], v[32:35]
    v_pk_mul_f32 v[116:117], v[64:65], v[64:65]
    v_pk_mul_f32 v[118:119], v[66:67], v[66:67]
    v_pk_fma_f32 v[116:117], v[116:117], v[70:71], v[68:69] op_sel:[0,0,1] op_sel_hi:[1,0,1]
    v_pk_fma_f32 v[118:119], v[118:119], v[70:71], v[68:69] op_sel:[0,0,1] op_sel_hi:[1,0,1]
    v_pk_mul_f32 v[116:117], v[116:117], v[64:65]
    v_pk_mul_f32 v[118:119], v[118:119], v[66:67]
    v_exp_f32 v116, v116
    v_exp_f32 v117, v117
    v_exp_f32 v118, v118
    v_exp_f32 v119, v119
    v_pk_fma_f32 v[116:117], v[116:117], v[68:69], v[68:69] op_sel_hi:[1,0,0]
    v_pk_fma_f32 v[118:119], v[118:119], v[68:69], v[68:69] op_sel_hi:[1,0,0]
    v_rcp_f32 v116, v116
    v_rcp_f32 v117, v117
    v_rcp_f32 v118, v118
    v_rcp_f32 v119, v119
    v_pk_mul_f32 v[116:117], v[116:117], v[64:65]
    v_pk_mul_f32 v[118:119], v[118:119], v[66:67]
    v_cvt_pk_bf16_f32 v64, v116, v117
    v_cvt_pk_bf16_f32 v65, v118, v119
    v_cndmask_b32 v64, v64, v5, s[82:83]
    v_cndmask_b32 v65, v65, 0, s[82:83]
    s_add_u32 s65, s90, 286720
    buffer_store_dwordx2 v[64:65], v9, s[32:35], s65 offen sc1
    v_pk_mul_f32 v[116:117], v[24:25], v[24:25]
    v_pk_mul_f32 v[118:119], v[26:27], v[26:27]
    s_waitcnt lgkmcnt(3)
    v_pk_fma_f32 v[116:117], v[116:117], v[30:31], v[28:29] op_sel:[0,0,1] op_sel_hi:[1,0,1]
    v_pk_fma_f32 v[118:119], v[118:119], v[30:31], v[28:29] op_sel:[0,0,1] op_sel_hi:[1,0,1]
    v_pk_mul_f32 v[116:117], v[116:117], v[24:25]
    v_pk_mul_f32 v[118:119], v[118:119], v[26:27]
    v_exp_f32 v116, v116
    v_exp_f32 v117, v117
    v_exp_f32 v118, v118
    v_exp_f32 v119, v119
    v_pk_fma_f32 v[116:117], v[116:117], v[28:29], v[28:29] op_sel_hi:[1,0,0]
    v_pk_fma_f32 v[118:119], v[118:119], v[28:29], v[28:29] op_sel_hi:[1,0,0]
    v_rcp_f32 v116, v116
    v_rcp_f32 v117, v117
    v_rcp_f32 v118, v118
    v_rcp_f32 v119, v119
    v_pk_mul_f32 v[116:117], v[116:117], v[24:25]
    v_pk_mul_f32 v[118:119], v[118:119], v[26:27]
    v_cvt_pk_bf16_f32 v24, v116, v117
    v_cvt_pk_bf16_f32 v25, v118, v119
    v_cndmask_b32 v24, v24, v5, s[82:83]
    v_cndmask_b32 v25, v25, 0, s[82:83]
    s_add_u32 s65, s90, 344064
    buffer_store_dwordx2 v[24:25], v9, s[32:35], s65 offen sc1
    v_pk_mul_f32 v[116:117], v[32:33], v[32:33]
    v_pk_mul_f32 v[118:119], v[34:35], v[34:35]
    s_waitcnt lgkmcnt(3)
    v_pk_fma_f32 v[116:117], v[116:117], v[38:39], v[36:37] op_sel:[0,0,1] op_sel_hi:[1,0,1]
    v_pk_fma_f32 v[118:119], v[118:119], v[38:39], v[36:37] op_sel:[0,0,1] op_sel_hi:[1,0,1]
    v_pk_mul_f32 v[116:117], v[116:117], v[32:33]
    v_pk_mul_f32 v[118:119], v[118:119], v[34:35]
    v_exp_f32 v116, v116
    v_exp_f32 v117, v117
    v_exp_f32 v118, v118
    v_exp_f32 v119, v119
    v_pk_fma_f32 v[116:117], v[116:117], v[36:37], v[36:37] op_sel_hi:[1,0,0]
    v_pk_fma_f32 v[118:119], v[118:119], v[36:37], v[36:37] op_sel_hi:[1,0,0]
    v_rcp_f32 v116, v116
    v_rcp_f32 v117, v117
    v_rcp_f32 v118, v118
    v_rcp_f32 v119, v119
    v_pk_mul_f32 v[116:117], v[116:117], v[32:33]
    v_pk_mul_f32 v[118:119], v[118:119], v[34:35]
    v_cvt_pk_bf16_f32 v32, v116, v117
    v_cvt_pk_bf16_f32 v33, v118, v119
    v_cndmask_b32 v32, v32, v5, s[82:83]
    v_cndmask_b32 v33, v33, 0, s[82:83]
    s_add_u32 s65, s90, 401408
    buffer_store_dwordx2 v[32:33], v9, s[32:35], s65 offen sc1
    s_branch L_g2
L_slow1:
    s_add_u32 s71, s101, 0
    buffer_load_dword v18, off, s[52:55], s71 sc1
    s_waitcnt vmcnt(0)
    v_cmp_gt_u32 vcc, s100, v18
    s_nop 0
    s_cbranch_vccz L_ret1
    s_sub_u32 s64, s64, 1
    s_cbranch_scc0 L_slow1
    s_mov_b32 s64, 0
    s_branch L_ret1
L_slow3:
    s_add_u32 s71, s24, 44032
    buffer_load_dword v18, off, s[32:35], s71 sc1
    s_waitcnt vmcnt(0)
    v_cmp_gt_u32 vcc, 1, v18
    s_nop 0
    s_cbranch_vccz L_ret3
    s_sub_u32 s64, s64, 1
    s_cbranch_scc0 L_slow3
    s_mov_b32 s64, 0
    s_branch L_ret3
L_slow4:
        s_waitcnt lgkmcnt(0)
    s_cmp_ge_u32 s16, 8
    s_cbranch_scc1 L_ret4
    s_add_u32 s71, s93, 17667072
    buffer_load_dword v18, off, s[32:35], s71 sc1
    s_waitcnt vmcnt(0)
    v_cmp_gt_u32 vcc, 8, v18
    s_nop 0
    s_cbranch_vccz L_ret4
    s_sub_u32 s64, s64, 1
    s_cbranch_scc0 L_slow4
    s_mov_b32 s64, 0
    s_branch L_ret4
L_slow5:
        s_waitcnt lgkmcnt(0)
    s_cmp_ge_u32 s16, 16
    s_cbranch_scc1 L_ret5
    s_add_u32 s71, s93, 17683456
    buffer_load_dword v18, off, s[32:35], s71 sc1
    s_waitcnt vmcnt(0)
    v_cmp_gt_u32 vcc, 16, v18
    s_nop 0
    s_cbranch_vccz L_ret5
    s_sub_u32 s64, s64, 1
    s_cbranch_scc0 L_slow5
    s_mov_b32 s64, 0
    s_branch L_ret5
L_slow6:
        s_waitcnt lgkmcnt(0)
    s_cmp_ge_u32 s16, 8
    s_cbranch_scc1 L_ret6
    s_add_u32 s71, s93, 17694720
    buffer_load_dword v18, off, s[32:35], s71 sc1
    s_waitcnt vmcnt(0)
    v_cmp_gt_u32 vcc, 8, v18
    s_nop 0
    s_cbranch_vccz L_ret6
    s_sub_u32 s64, s64, 1
    s_cbranch_scc0 L_slow6
    s_mov_b32 s64, 0
    s_branch L_ret6
L_slow8:
        s_waitcnt lgkmcnt(0)
    s_min_u32 s72, s16, s17
    s_cmp_ge_u32 s72, 20
    s_cbranch_scc1 L_ret8
    s_mov_b32 s71, 17596416
    buffer_load_dword v18, v17, s[32:35], s71 offen sc1
    s_waitcnt vmcnt(0)
    v_cmp_gt_u32 vcc, 20, v18
    s_nop 0
    s_cbranch_vccz L_ret8
    s_sub_u32 s64, s64, 1
    s_cbranch_scc0 L_slow8
    s_mov_b32 s64, 0
    s_branch L_ret8
L_slow12:
        s_waitcnt lgkmcnt(0)
    s_cmp_ge_u32 s16, 14
    s_cbranch_scc1 L_ret12
    s_add_u32 s71, s93, 17675264
    buffer_load_dword v18, off, s[32:35], s71 sc1
    s_waitcnt vmcnt(0)
    v_cmp_gt_u32 vcc, 14, v18
    s_nop 0
    s_cbranch_vccz L_ret12
    s_sub_u32 s64, s64, 1
    s_cbranch_scc0 L_slow12
    s_mov_b32 s64, 0
    s_branch L_ret12
L_slow13:
        s_waitcnt lgkmcnt(0)
    s_min_u32 s72, s16, s17
    s_cmp_ge_u32 s72, 20
    s_cbranch_scc1 L_ret13
    s_mov_b32 s71, 17612800
    buffer_load_dword v18, v17, s[32:35], s71 offen sc1
    s_waitcnt vmcnt(0)
    v_cmp_gt_u32 vcc, 20, v18
    s_nop 0
    s_cbranch_vccz L_ret13
    s_sub_u32 s64, s64, 1
    s_cbranch_scc0 L_slow13
    s_mov_b32 s64, 0
    s_branch L_ret13
L_slow15:
        s_waitcnt lgkmcnt(0)
    s_cmp_ge_u32 s16, 16
    s_cbranch_scc1 L_ret15
    s_add_u32 s71, s89, 0
    buffer_load_dword v18, off, s[32:35], s71 sc1
    s_waitcnt vmcnt(0)
    v_cmp_gt_u32 vcc, 16, v18
    s_nop 0
    s_cbranch_vccz L_ret15
    s_sub_u32 s64, s64, 1
    s_cbranch_scc0 L_slow15
    s_mov_b32 s64, 0
    s_branch L_ret15
L_slow17:
        s_waitcnt lgkmcnt(0)
    s_cmp_ge_u32 s16, 16
    s_cbranch_scc1 L_ret17
    s_add_u32 s71, s89, 512
    buffer_load_dword v18, off, s[32:35], s71 sc1
    s_waitcnt vmcnt(0)
    v_cmp_gt_u32 vcc, 16, v18
    s_nop 0
    s_cbranch_vccz L_ret17
    s_sub_u32 s64, s64, 1
    s_cbranch_scc0 L_slow17
    s_mov_b32 s64, 0
    s_branch L_ret17
L_slow18:
        s_waitcnt lgkmcnt(0)
    s_cmp_ge_u32 s16, 16
    s_cbranch_scc1 L_ret18
    s_add_u32 s71, s89, 1024
    buffer_load_dword v18, off, s[32:35], s71 sc1
    s_waitcnt vmcnt(0)
    v_cmp_gt_u32 vcc, 16, v18
    s_nop 0
    s_cbranch_vccz L_ret18
    s_sub_u32 s64, s64, 1
    s_cbranch_scc0 L_slow18
    s_mov_b32 s64, 0
    s_branch L_ret18
L_slow19:
    s_add_u32 s71, s101, 0
    buffer_load_dword v18, off, s[52:55], s71 sc1
    s_waitcnt vmcnt(0)
    v_cmp_gt_u32 vcc, s100, v18
    s_nop 0
    s_cbranch_vccz L_ret19
    s_sub_u32 s64, s64, 1
    s_cbranch_scc0 L_slow19
    s_mov_b32 s64, 0
    s_branch L_ret19
L_slow21:
    s_add_u32 s71, s101, 0
    buffer_load_dword v18, off, s[52:55], s71 sc1
    s_waitcnt vmcnt(0)
    v_cmp_gt_u32 vcc, s100, v18
    s_nop 0
    s_cbranch_vccz L_ret21
    s_sub_u32 s64, s64, 1
    s_cbranch_scc0 L_slow21
    s_mov_b32 s64, 0
    s_branch L_ret21
L_slow24:
    s_add_u32 s71, s95, 17667072
    buffer_load_dword v18, v28, s[32:35], s71 offen sc1
    s_waitcnt vmcnt(0)
    v_cmp_gt_u32 vcc, v29, v18
    s_nop 0
    s_cbranch_vccz L_ret24
    s_sub_u32 s64, s64, 1
    s_cbranch_scc0 L_slow24
    s_mov_b32 s64, 0
    s_branch L_ret24
L_slow27:
    s_add_u32 s71, s101, 0
    buffer_load_dword v18, off, s[52:55], s71 sc1
    s_waitcnt vmcnt(0)
    v_cmp_gt_u32 vcc, s100, v18
    s_nop 0
    s_cbranch_vccz L_ret27
    s_sub_u32 s64, s64, 1
    s_cbranch_scc0 L_slow27
    s_mov_b32 s64, 0
    s_branch L_ret27
L_slow29:
    s_add_u32 s71, s42, 140288
    buffer_load_dword v18, off, s[32:35], s71 sc1
    s_waitcnt vmcnt(0)
    v_cmp_gt_u32 vcc, s75, v18
    s_nop 0
    s_cbranch_vccz L_ret29
    s_sub_u32 s64, s64, 1
    s_cbranch_scc0 L_slow29
    s_mov_b32 s64, 0
    s_branch L_ret29
L_slow31:
    s_add_u32 s71, s95, 17667072
    buffer_load_dword v18, v28, s[32:35], s71 offen sc1
    s_waitcnt vmcnt(0)
    v_cmp_gt_u32 vcc, v29, v18
    s_nop 0
    s_cbranch_vccz L_ret31
    s_sub_u32 s64, s64, 1
    s_cbranch_scc0 L_slow31
    s_mov_b32 s64, 0
    s_branch L_ret31
L_slow33:
    s_mov_b32 s71, 17596416
    buffer_load_dword v18, v17, s[32:35], s71 offen sc1
    s_waitcnt vmcnt(0)
    v_cmp_gt_u32 vcc, 20, v18
    s_nop 0
    s_cbranch_vccz L_ret33
    s_sub_u32 s64, s64, 1
    s_cbranch_scc0 L_slow33
    s_mov_b32 s64, 0
    s_branch L_ret33
L_slow37:
        s_waitcnt lgkmcnt(0)
    s_cmp_ge_u32 s16, 14
    s_cbranch_scc1 L_ret37
    s_add_u32 s71, s93, 17675264
    buffer_load_dword v18, off, s[32:35], s71 sc1
    s_waitcnt vmcnt(0)
    v_cmp_gt_u32 vcc, 14, v18
    s_nop 0
    s_cbranch_vccz L_ret37
    s_sub_u32 s64, s64, 1
    s_cbranch_scc0 L_slow37
    s_mov_b32 s64, 0
    s_branch L_ret37
L_slow38:
        s_waitcnt lgkmcnt(0)
    s_min_u32 s72, s16, s17
    s_cmp_ge_u32 s72, 20
    s_cbranch_scc1 L_ret38
    s_mov_b32 s71, 17612800
    buffer_load_dword v18, v17, s[32:35], s71 offen sc1
    s_waitcnt vmcnt(0)
    v_cmp_gt_u32 vcc, 20, v18
    s_nop 0
    s_cbranch_vccz L_ret38
    s_sub_u32 s64, s64, 1
    s_cbranch_scc0 L_slow38
    s_mov_b32 s64, 0
    s_branch L_ret38
L_code_end:
.section .rodata,"a"
.p2align 6
.amdhsa_kernel sequential_preLN__ssm_conv_h3__mixer_channel_mlp__prompt_kernel
  .amdhsa_next_free_vgpr 512
  .amdhsa_next_free_sgpr 102
  .amdhsa_accum_offset 256
  .amdhsa_group_segment_fixed_size 0
  .amdhsa_kernarg_size 112
  .amdhsa_user_sgpr_count 2
  .amdhsa_user_sgpr_kernarg_segment_ptr 1
  .amdhsa_system_sgpr_workgroup_id_x 1
  .amdhsa_float_denorm_mode_32 3
.end_amdhsa_kernel
```
